```python
import torch

def _softmax(x, axis=-1):
    return torch.softmax(x, dim=axis)
def _gelu(x):
    return torch.nn.functional.gelu(x, approximate="tanh")
def _silu(x):
    return torch.nn.functional.silu(x)
def _sigmoid(x):
    return torch.sigmoid(x)
def _layernorm(x, axis=-1, eps=1e-5):
    m = x.mean(dim=axis, keepdim=True)
    v = x.var(dim=axis, keepdim=True, unbiased=False)
    return (x - m) / torch.sqrt(v + eps)
def _scatter_add(tgt, idx, src, axis=0):
    return tgt.clone().index_add_(axis, idx, src)
def _segment_sum(src, seg, n):
    out = torch.zeros((n,) + src.shape[1:], dtype=src.dtype)
    return out.index_add_(0, seg, src)
def _pad(x, pw):
    flat = tuple(v for pair in reversed(pw) for v in pair)
    return torch.nn.functional.pad(x, flat)

kernel_name = 'parallel_sum__linear_attn_block__glu_gated_glu__prompt'

def setup_inputs():

    _w = (lambda a: (lambda t: t.to(torch.bfloat16) if t.is_floating_point() else t)(torch.as_tensor(a)))
    def _A_setup():
        B, S, D = 1, 2048, 640
        return {
            "x": _w((lambda *s: torch.randn(*s, dtype=torch.bfloat16) * 0.05)(B, S, D)),
            "wqkv": _w((lambda *s: torch.randn(*s, dtype=torch.bfloat16) * 0.2)(D, 3 * D)),
            "wo": _w((lambda *s: torch.randn(*s, dtype=torch.bfloat16) * 0.2)(D, D)),
        }
    _A_in = _A_setup()

    def _B_setup():
        B, S, D, F = 1, 2048, 640, 1728
        return {
            "x": _w((lambda *s: torch.randn(*s, dtype=torch.bfloat16) * 0.05)(B, S, D)),
            "w_gate": _w((lambda *s: torch.randn(*s, dtype=torch.bfloat16) * 0.05)(D, F)),
            "w_up": _w((lambda *s: torch.randn(*s, dtype=torch.bfloat16) * 0.05)(D, F)),
            "w_down": _w((lambda *s: torch.randn(*s, dtype=torch.bfloat16) * 0.05)(F, D)),
        }
    _B_in = _B_setup()

    return {
        "A_x": _A_in["x"],
        "A_wqkv": _A_in["wqkv"],
        "A_wo": _A_in["wo"],
        "B_x": _B_in["x"],
        "B_w_gate": _B_in["w_gate"],
        "B_w_up": _B_in["w_up"],
        "B_w_down": _B_in["w_down"],
    }

def reference(A_x, A_wqkv, A_wo, B_x, B_w_gate, B_w_up, B_w_down):
    def _A_ref(x, wqkv, wo):
        B, S, D = x.shape
        H = 32; Dh = D // H
        qkv = (lambda x, *d: x.permute(*d))((x @ wqkv).reshape(B, S, 3, H, Dh), 2, 0, 3, 1, 4)
        q, k, v = qkv[0], qkv[1], qkv[2]
        phi = lambda t: torch.where(t > 0, t + 1, torch.exp(t)) + 1e-6
        pq, pk = phi(q), phi(k)
        kv = torch.einsum("bhsd,bhse->bhde", pk, v)
        z = torch.einsum("bhsd->bhd", pk)
        num = torch.einsum("bhqd,bhde->bhqe", pq, kv)
        den = torch.einsum("bhqd,bhd->bhq", pq, z)[..., None] + 1e-6
        o = num / den
        return (lambda x, *d: x.permute(*d))(o, 0, 2, 1, 3).reshape(B, S, D) @ wo

    def _B_ref(x, w_gate, w_up, w_down):
        g = torch.einsum("bsd,df->bsf", x, w_gate)
        u = torch.einsum("bsd,df->bsf", x, w_up)
        h = _sigmoid(g) * u
        return torch.einsum("bsf,fd->bsd", h, w_down)

    x = A_x
    xn = _layernorm(x, axis=-1)
    return x + _A_ref(xn, A_wqkv, A_wo) + _B_ref(xn, B_w_gate, B_w_up, B_w_down)
```

```asm
; @launch kernel=k0_kernel grid=(733,1,1) block=(256,1,1) lds=16384
; @launch kernel=k1_kernel grid=(256,1,1) block=(512,1,1) lds=162816
; @launch kernel=k2_kernel grid=(256,1,1) block=(512,1,1) lds=161792
.amdgcn_target "amdgcn-amd-amdhsa--gfx950"
.text
.p2align 8
.globl k0_kernel
.type k0_kernel,@function
k0_kernel:
s_cmp_ge_u32 s2, 733
s_cbranch_scc1 k0_kernel_end
s_load_dwordx16 s[8:23], s[0:1], 0
s_load_dwordx2 s[24:25], s[0:1], 72
v_and_b32 v1, 63, v0
v_lshrrev_b32 v2, 6, v0
v_and_b32 v3, 15, v1
v_lshrrev_b32 v4, 4, v1
v_readfirstlane_b32 s3, v2
v_lshlrev_b32 v5, 4, v1
s_waitcnt lgkmcnt(0)
s_lshl_b32 s4, s2, 8
v_add_u32 v6, s4, v0
v_lshlrev_b32 v7, 7, v6
s_cmp_ge_u32 s2, 128
s_cbranch_scc1 k0_kernel_rp
s_mov_b32 s40, s8
s_mov_b32 s41, s9
s_mov_b32 s42, 0x280000
s_mov_b32 s43, 0x20000
s_add_u32 s44, s24, 0x1000000
s_addc_u32 s45, s25, 0
s_mov_b32 s46, 0x280000
s_mov_b32 s47, 0x20000
s_lshl_b32 s4, s2, 4
v_add_u32 v7, s4, v3
s_movk_i32 s5, 1280
v_mul_lo_u32 v7, v7, s5
v_lshl_add_u32 v7, v4, 4, v7
s_mul_i32 s5, s3, 320
buffer_load_dwordx4 v[16:19], v7, s[40:43], s5 offen offset:0
buffer_load_dwordx4 v[20:23], v7, s[40:43], s5 offen offset:64
buffer_load_dwordx4 v[24:27], v7, s[40:43], s5 offen offset:128
buffer_load_dwordx4 v[28:31], v7, s[40:43], s5 offen offset:192
buffer_load_dwordx4 v[32:35], v7, s[40:43], s5 offen offset:256
v_mov_b32 v8, 0
v_mov_b32 v9, 0
s_waitcnt vmcnt(0)
v_lshlrev_b32 v40, 16, v16
v_and_b32 v41, 0xffff0000, v16
v_add_f32 v8, v8, v40
v_add_f32 v8, v8, v41
v_lshlrev_b32 v42, 16, v17
v_and_b32 v43, 0xffff0000, v17
v_add_f32 v8, v8, v42
v_add_f32 v8, v8, v43
v_lshlrev_b32 v44, 16, v18
v_and_b32 v45, 0xffff0000, v18
v_add_f32 v8, v8, v44
v_add_f32 v8, v8, v45
v_lshlrev_b32 v46, 16, v19
v_and_b32 v47, 0xffff0000, v19
v_add_f32 v8, v8, v46
v_add_f32 v8, v8, v47
v_lshlrev_b32 v48, 16, v20
v_and_b32 v49, 0xffff0000, v20
v_add_f32 v8, v8, v48
v_add_f32 v8, v8, v49
v_lshlrev_b32 v50, 16, v21
v_and_b32 v51, 0xffff0000, v21
v_add_f32 v8, v8, v50
v_add_f32 v8, v8, v51
v_lshlrev_b32 v52, 16, v22
v_and_b32 v53, 0xffff0000, v22
v_add_f32 v8, v8, v52
v_add_f32 v8, v8, v53
v_lshlrev_b32 v54, 16, v23
v_and_b32 v55, 0xffff0000, v23
v_add_f32 v8, v8, v54
v_add_f32 v8, v8, v55
v_lshlrev_b32 v56, 16, v24
v_and_b32 v57, 0xffff0000, v24
v_add_f32 v8, v8, v56
v_add_f32 v8, v8, v57
v_lshlrev_b32 v58, 16, v25
v_and_b32 v59, 0xffff0000, v25
v_add_f32 v8, v8, v58
v_add_f32 v8, v8, v59
v_lshlrev_b32 v60, 16, v26
v_and_b32 v61, 0xffff0000, v26
v_add_f32 v8, v8, v60
v_add_f32 v8, v8, v61
v_lshlrev_b32 v62, 16, v27
v_and_b32 v63, 0xffff0000, v27
v_add_f32 v8, v8, v62
v_add_f32 v8, v8, v63
v_lshlrev_b32 v64, 16, v28
v_and_b32 v65, 0xffff0000, v28
v_add_f32 v8, v8, v64
v_add_f32 v8, v8, v65
v_lshlrev_b32 v66, 16, v29
v_and_b32 v67, 0xffff0000, v29
v_add_f32 v8, v8, v66
v_add_f32 v8, v8, v67
v_lshlrev_b32 v68, 16, v30
v_and_b32 v69, 0xffff0000, v30
v_add_f32 v8, v8, v68
v_add_f32 v8, v8, v69
v_lshlrev_b32 v70, 16, v31
v_and_b32 v71, 0xffff0000, v31
v_add_f32 v8, v8, v70
v_add_f32 v8, v8, v71
v_lshlrev_b32 v72, 16, v32
v_and_b32 v73, 0xffff0000, v32
v_add_f32 v8, v8, v72
v_add_f32 v8, v8, v73
v_lshlrev_b32 v74, 16, v33
v_and_b32 v75, 0xffff0000, v33
v_add_f32 v8, v8, v74
v_add_f32 v8, v8, v75
v_lshlrev_b32 v76, 16, v34
v_and_b32 v77, 0xffff0000, v34
v_add_f32 v8, v8, v76
v_add_f32 v8, v8, v77
v_lshlrev_b32 v78, 16, v35
v_and_b32 v79, 0xffff0000, v35
v_add_f32 v8, v8, v78
v_add_f32 v8, v8, v79
v_mov_b32 v10, v8
s_nop 1
v_permlane32_swap_b32 v8, v10
s_nop 1
v_add_f32 v8, v8, v10
v_mov_b32 v10, v8
s_nop 1
v_permlane16_swap_b32 v8, v10
s_nop 1
v_add_f32 v8, v8, v10
v_lshlrev_b32 v11, 2, v3
s_lshl_b32 s4, s3, 6
v_add_u32 v12, s4, v11
ds_write_b32 v12, v8
s_waitcnt lgkmcnt(0)
s_barrier
ds_read_b32 v80, v11 offset:0
ds_read_b32 v81, v11 offset:64
ds_read_b32 v82, v11 offset:128
ds_read_b32 v83, v11 offset:192
s_waitcnt lgkmcnt(0)
v_add_f32 v80, v80, v81
v_add_f32 v82, v82, v83
v_add_f32 v80, v80, v82
v_mul_f32 v80, 0x3acccccd, v80
v_sub_f32 v40, v40, v80
v_fma_f32 v9, v40, v40, v9
v_sub_f32 v41, v41, v80
v_fma_f32 v9, v41, v41, v9
v_sub_f32 v42, v42, v80
v_fma_f32 v9, v42, v42, v9
v_sub_f32 v43, v43, v80
v_fma_f32 v9, v43, v43, v9
v_sub_f32 v44, v44, v80
v_fma_f32 v9, v44, v44, v9
v_sub_f32 v45, v45, v80
v_fma_f32 v9, v45, v45, v9
v_sub_f32 v46, v46, v80
v_fma_f32 v9, v46, v46, v9
v_sub_f32 v47, v47, v80
v_fma_f32 v9, v47, v47, v9
v_sub_f32 v48, v48, v80
v_fma_f32 v9, v48, v48, v9
v_sub_f32 v49, v49, v80
v_fma_f32 v9, v49, v49, v9
v_sub_f32 v50, v50, v80
v_fma_f32 v9, v50, v50, v9
v_sub_f32 v51, v51, v80
v_fma_f32 v9, v51, v51, v9
v_sub_f32 v52, v52, v80
v_fma_f32 v9, v52, v52, v9
v_sub_f32 v53, v53, v80
v_fma_f32 v9, v53, v53, v9
v_sub_f32 v54, v54, v80
v_fma_f32 v9, v54, v54, v9
v_sub_f32 v55, v55, v80
v_fma_f32 v9, v55, v55, v9
v_sub_f32 v56, v56, v80
v_fma_f32 v9, v56, v56, v9
v_sub_f32 v57, v57, v80
v_fma_f32 v9, v57, v57, v9
v_sub_f32 v58, v58, v80
v_fma_f32 v9, v58, v58, v9
v_sub_f32 v59, v59, v80
v_fma_f32 v9, v59, v59, v9
v_sub_f32 v60, v60, v80
v_fma_f32 v9, v60, v60, v9
v_sub_f32 v61, v61, v80
v_fma_f32 v9, v61, v61, v9
v_sub_f32 v62, v62, v80
v_fma_f32 v9, v62, v62, v9
v_sub_f32 v63, v63, v80
v_fma_f32 v9, v63, v63, v9
v_sub_f32 v64, v64, v80
v_fma_f32 v9, v64, v64, v9
v_sub_f32 v65, v65, v80
v_fma_f32 v9, v65, v65, v9
v_sub_f32 v66, v66, v80
v_fma_f32 v9, v66, v66, v9
v_sub_f32 v67, v67, v80
v_fma_f32 v9, v67, v67, v9
v_sub_f32 v68, v68, v80
v_fma_f32 v9, v68, v68, v9
v_sub_f32 v69, v69, v80
v_fma_f32 v9, v69, v69, v9
v_sub_f32 v70, v70, v80
v_fma_f32 v9, v70, v70, v9
v_sub_f32 v71, v71, v80
v_fma_f32 v9, v71, v71, v9
v_sub_f32 v72, v72, v80
v_fma_f32 v9, v72, v72, v9
v_sub_f32 v73, v73, v80
v_fma_f32 v9, v73, v73, v9
v_sub_f32 v74, v74, v80
v_fma_f32 v9, v74, v74, v9
v_sub_f32 v75, v75, v80
v_fma_f32 v9, v75, v75, v9
v_sub_f32 v76, v76, v80
v_fma_f32 v9, v76, v76, v9
v_sub_f32 v77, v77, v80
v_fma_f32 v9, v77, v77, v9
v_sub_f32 v78, v78, v80
v_fma_f32 v9, v78, v78, v9
v_sub_f32 v79, v79, v80
v_fma_f32 v9, v79, v79, v9
v_mov_b32 v10, v9
s_nop 1
v_permlane32_swap_b32 v9, v10
s_nop 1
v_add_f32 v9, v9, v10
v_mov_b32 v10, v9
s_nop 1
v_permlane16_swap_b32 v9, v10
s_nop 1
v_add_f32 v9, v9, v10
ds_write_b32 v12, v9 offset:256
s_waitcnt lgkmcnt(0)
s_barrier
ds_read_b32 v81, v11 offset:256
ds_read_b32 v82, v11 offset:320
ds_read_b32 v83, v11 offset:384
ds_read_b32 v84, v11 offset:448
s_waitcnt lgkmcnt(0)
v_add_f32 v81, v81, v82
v_add_f32 v83, v83, v84
v_add_f32 v81, v81, v83
v_mul_f32 v81, 0x3acccccd, v81
v_add_f32 v81, 0x3727c5ac, v81
v_rsq_f32 v81, v81
s_nop 0
s_lshr_b32 s4, s2, 1
s_mul_i32 s4, s4, 40
s_and_b32 s5, s2, 1
s_add_u32 s4, s4, s5
s_mul_i32 s5, s3, 10
s_add_u32 s4, s4, s5
s_lshl_b32 s4, s4, 10
v_mul_f32 v40, v40, v81
v_mul_f32 v41, v41, v81
v_cvt_pk_bf16_f32 v16, v40, v41
v_mul_f32 v42, v42, v81
v_mul_f32 v43, v43, v81
v_cvt_pk_bf16_f32 v17, v42, v43
v_mul_f32 v44, v44, v81
v_mul_f32 v45, v45, v81
v_cvt_pk_bf16_f32 v18, v44, v45
v_mul_f32 v46, v46, v81
v_mul_f32 v47, v47, v81
v_cvt_pk_bf16_f32 v19, v46, v47
buffer_store_dwordx4 v[16:19], v5, s[44:47], s4 offen
s_add_u32 s4, s4, 2048
v_mul_f32 v48, v48, v81
v_mul_f32 v49, v49, v81
v_cvt_pk_bf16_f32 v20, v48, v49
v_mul_f32 v50, v50, v81
v_mul_f32 v51, v51, v81
v_cvt_pk_bf16_f32 v21, v50, v51
v_mul_f32 v52, v52, v81
v_mul_f32 v53, v53, v81
v_cvt_pk_bf16_f32 v22, v52, v53
v_mul_f32 v54, v54, v81
v_mul_f32 v55, v55, v81
v_cvt_pk_bf16_f32 v23, v54, v55
buffer_store_dwordx4 v[20:23], v5, s[44:47], s4 offen
s_add_u32 s4, s4, 2048
v_mul_f32 v56, v56, v81
v_mul_f32 v57, v57, v81
v_cvt_pk_bf16_f32 v24, v56, v57
v_mul_f32 v58, v58, v81
v_mul_f32 v59, v59, v81
v_cvt_pk_bf16_f32 v25, v58, v59
v_mul_f32 v60, v60, v81
v_mul_f32 v61, v61, v81
v_cvt_pk_bf16_f32 v26, v60, v61
v_mul_f32 v62, v62, v81
v_mul_f32 v63, v63, v81
v_cvt_pk_bf16_f32 v27, v62, v63
buffer_store_dwordx4 v[24:27], v5, s[44:47], s4 offen
s_add_u32 s4, s4, 2048
v_mul_f32 v64, v64, v81
v_mul_f32 v65, v65, v81
v_cvt_pk_bf16_f32 v28, v64, v65
v_mul_f32 v66, v66, v81
v_mul_f32 v67, v67, v81
v_cvt_pk_bf16_f32 v29, v66, v67
v_mul_f32 v68, v68, v81
v_mul_f32 v69, v69, v81
v_cvt_pk_bf16_f32 v30, v68, v69
v_mul_f32 v70, v70, v81
v_mul_f32 v71, v71, v81
v_cvt_pk_bf16_f32 v31, v70, v71
buffer_store_dwordx4 v[28:31], v5, s[44:47], s4 offen
s_add_u32 s4, s4, 2048
v_mul_f32 v72, v72, v81
v_mul_f32 v73, v73, v81
v_cvt_pk_bf16_f32 v32, v72, v73
v_mul_f32 v74, v74, v81
v_mul_f32 v75, v75, v81
v_cvt_pk_bf16_f32 v33, v74, v75
v_mul_f32 v76, v76, v81
v_mul_f32 v77, v77, v81
v_cvt_pk_bf16_f32 v34, v76, v77
v_mul_f32 v78, v78, v81
v_mul_f32 v79, v79, v81
v_cvt_pk_bf16_f32 v35, v78, v79
buffer_store_dwordx4 v[32:35], v5, s[44:47], s4 offen
s_branch k0_kernel_fin
k0_kernel_rp:
s_mov_b32 s40, s12
s_mov_b32 s41, s13
s_mov_b32 s42, 0xc8000
s_mov_b32 s43, 0x20000
s_mov_b32 s44, s20
s_mov_b32 s45, s21
s_mov_b32 s46, 0x21c000
s_mov_b32 s47, 0x20000
s_add_u32 s48, s24, 0xa00000
s_addc_u32 s49, s25, 0
s_mov_b32 s50, 0x30c000
s_mov_b32 s51, 0x20000
s_add_u32 s52, s24, 0xe00000
s_addc_u32 s53, s25, 0
s_mov_b32 s54, 0xe000
s_mov_b32 s55, 0x20000
s_sub_u32 s4, s2, 128
s_lshl_b32 s5, s4, 8
v_add_u32 v7, s5, v0
v_lshlrev_b32 v7, 4, v7
v_mov_b32 v8, 0
v_mov_b32 v9, 0
v_mov_b32 v10, 0
v_mov_b32 v11, 0
buffer_store_dwordx4 v[8:11], v7, s[52:55], 0 offen
s_lshl_b32 s4, s4, 2
s_add_u32 s4, s4, s3
s_cmp_ge_u32 s4, 2420
s_cbranch_scc1 k0_kernel_fin
s_mov_b32 s28, s10
s_mov_b32 s29, s11
s_mov_b32 s30, 0x258000
s_mov_b32 s31, 0x20000
s_mov_b32 s32, s16
s_mov_b32 s33, s17
s_mov_b32 s34, 0x21c000
s_mov_b32 s35, 0x20000
s_mov_b32 s36, s18
s_mov_b32 s37, s19
s_mov_b32 s38, 0x21c000
s_mov_b32 s39, 0x20000
s_add_u32 s64, s24, 0x2000000
s_addc_u32 s65, s25, 0
s_mov_b32 s66, 0x690000
s_mov_b32 s67, 0x20000
s_mov_b32 s78, 0
s_cmp_lt_u32 s4, 740
s_cbranch_scc1 Lw2_1
s_cmp_lt_u32 s4, 1340
s_cbranch_scc1 Lq_2
s_sub_u32 s4, s4, 1340
s_cmp_ge_u32 s4, 540
s_cselect_b32 s27, 1, 0
s_cselect_b32 s56, s36, s32
s_cselect_b32 s57, s37, s33
s_cselect_b32 s58, s38, s34
s_cselect_b32 s5, 540, 0
s_sub_u32 s4, s4, s5
s_mul_i32 s5, s4, 2428
s_lshr_b32 s5, s5, 16
s_mul_i32 s6, s5, 27
s_sub_u32 s6, s4, s6
s_mul_i32 s7, s5, 110592
s_lshl_b32 s26, s6, 7
s_add_u32 s7, s7, s26
s_movk_i32 s26, 3456
s_lshl_b32 s6, s6, 3
s_add_u32 s6, s6, s27
s_add_u32 s6, s6, 120
s_movk_i32 s68, 4096
s_branch Lgo_3_w1
Lq_2:
s_sub_u32 s4, s4, 740
s_mov_b32 s56, s28
s_mov_b32 s57, s29
s_mov_b32 s58, s30
s_mul_i32 s5, s4, 2185
s_lshr_b32 s5, s5, 16
s_mul_i32 s6, s5, 30
s_sub_u32 s6, s4, s6
s_mul_i32 s7, s5, 122880
s_lshl_b32 s26, s6, 7
s_add_u32 s7, s7, s26
s_movk_i32 s26, 3840
s_lshl_b32 s6, s6, 2
s_movk_i32 s68, 2048
s_mov_b32 s78, s6
Lgo_3_w1:
s_lshr_b32 s27, s5, 1
s_mul_i32 s27, s27, 336
s_add_u32 s27, s27, s6
s_lshl_b32 s27, s27, 11
s_and_b32 s5, s5, 1
s_lshl_b32 s5, s5, 10
s_add_u32 s69, s27, s5
s_mov_b32 s48, s64
s_mov_b32 s49, s65
s_mov_b32 s50, 0x690000
s_movk_i32 s5, 20
s_branch Lgo_3
Lw2_1:
s_mul_i32 s5, s4, 205
s_lshr_b32 s5, s5, 11
s_mul_i32 s6, s5, 10
s_sub_u32 s6, s4, s6
s_lshl_b32 s7, s5, 5
s_sub_u32 s26, s5, 20
s_lshl_b32 s26, s26, 5
s_cmp_lt_u32 s5, 20
s_cselect_b32 s56, s40, s44
s_cselect_b32 s57, s41, s45
s_cselect_b32 s58, s42, s46
s_cselect_b32 s7, s7, s26
s_mul_i32 s7, s7, 1280
s_lshl_b32 s26, s6, 7
s_add_u32 s7, s7, s26
s_mul_i32 s69, s5, 40
s_lshl_b32 s27, s6, 2
s_add_u32 s69, s69, s27
s_lshl_b32 s69, s69, 10
s_movk_i32 s68, 1024
s_movk_i32 s26, 1280
Lgo_3:
s_mov_b32 s59, 0x20000
v_lshrrev_b32 v7, 2, v1
v_mul_lo_u32 v8, v7, s26
v_lshrrev_b32 v7, 3, v7
v_lshlrev_b32 v7, 1, v7
v_and_b32 v9, 3, v1
v_xor_b32 v7, v7, v9
v_lshl_add_u32 v8, v7, 4, v8
s_lshl_b32 s28, s26, 4
s_lshl_b32 s26, s3, 12
s_add_u32 m0, s26, 0
s_add_u32 s27, s7, 0
buffer_load_dwordx4 v8, s[56:59], s27 offen lds
s_add_u32 m0, s26, 1024
s_add_u32 s27, s7, 0
s_add_u32 s27, s27, s28
buffer_load_dwordx4 v8, s[56:59], s27 offen lds
s_add_u32 m0, s26, 2048
s_add_u32 s27, s7, 64
buffer_load_dwordx4 v8, s[56:59], s27 offen lds
s_add_u32 m0, s26, 3072
s_add_u32 s27, s7, 64
s_add_u32 s27, s27, s28
buffer_load_dwordx4 v8, s[56:59], s27 offen lds
s_mul_i32 s74, s68, 0
s_add_u32 s74, s74, s69
s_mul_i32 s75, s68, 1
s_add_u32 s75, s75, s69
s_mul_i32 s76, s68, 2
s_add_u32 s76, s76, s69
s_mul_i32 s77, s68, 3
s_add_u32 s77, s77, s69
s_cmp_lt_u32 s78, 40
s_cbranch_scc1 Lnr_4
s_cmp_ge_u32 s78, 120
s_cbranch_scc1 Lnr_4
s_add_u32 s28, s78, 0
s_sub_u32 s29, s28, 40
s_cmp_ge_u32 s29, 40
s_cselect_b32 s30, 1, 0
s_cselect_b32 s31, 40, 0
s_sub_u32 s29, s29, s31
s_mul_i32 s31, s29, 13
s_lshr_b32 s31, s31, 6
s_mul_i32 s79, s31, 5
s_sub_u32 s29, s29, s79
s_mul_i32 s31, s31, 10
s_add_u32 s31, s31, s29
s_add_u32 s31, s31, 40
s_mul_i32 s79, s30, 3
s_add_u32 s31, s31, s79
s_sub_u32 s79, 3, s30
s_cmp_ge_u32 s29, s79
s_cselect_b32 s79, 2, 0
s_add_u32 s31, s31, s79
s_sub_u32 s31, s31, s28
s_lshl_b32 s31, s31, 11
s_add_u32 s74, s74, s31
s_add_u32 s28, s78, 1
s_sub_u32 s29, s28, 40
s_cmp_ge_u32 s29, 40
s_cselect_b32 s30, 1, 0
s_cselect_b32 s31, 40, 0
s_sub_u32 s29, s29, s31
s_mul_i32 s31, s29, 13
s_lshr_b32 s31, s31, 6
s_mul_i32 s79, s31, 5
s_sub_u32 s29, s29, s79
s_mul_i32 s31, s31, 10
s_add_u32 s31, s31, s29
s_add_u32 s31, s31, 40
s_mul_i32 s79, s30, 3
s_add_u32 s31, s31, s79
s_sub_u32 s79, 3, s30
s_cmp_ge_u32 s29, s79
s_cselect_b32 s79, 2, 0
s_add_u32 s31, s31, s79
s_sub_u32 s31, s31, s28
s_lshl_b32 s31, s31, 11
s_add_u32 s75, s75, s31
s_add_u32 s28, s78, 2
s_sub_u32 s29, s28, 40
s_cmp_ge_u32 s29, 40
s_cselect_b32 s30, 1, 0
s_cselect_b32 s31, 40, 0
s_sub_u32 s29, s29, s31
s_mul_i32 s31, s29, 13
s_lshr_b32 s31, s31, 6
s_mul_i32 s79, s31, 5
s_sub_u32 s29, s29, s79
s_mul_i32 s31, s31, 10
s_add_u32 s31, s31, s29
s_add_u32 s31, s31, 40
s_mul_i32 s79, s30, 3
s_add_u32 s31, s31, s79
s_sub_u32 s79, 3, s30
s_cmp_ge_u32 s29, s79
s_cselect_b32 s79, 2, 0
s_add_u32 s31, s31, s79
s_sub_u32 s31, s31, s28
s_lshl_b32 s31, s31, 11
s_add_u32 s76, s76, s31
s_add_u32 s28, s78, 3
s_sub_u32 s29, s28, 40
s_cmp_ge_u32 s29, 40
s_cselect_b32 s30, 1, 0
s_cselect_b32 s31, 40, 0
s_sub_u32 s29, s29, s31
s_mul_i32 s31, s29, 13
s_lshr_b32 s31, s31, 6
s_mul_i32 s79, s31, 5
s_sub_u32 s29, s29, s79
s_mul_i32 s31, s31, 10
s_add_u32 s31, s31, s29
s_add_u32 s31, s31, 40
s_mul_i32 s79, s30, 3
s_add_u32 s31, s31, s79
s_sub_u32 s79, 3, s30
s_cmp_ge_u32 s29, s79
s_cselect_b32 s79, 2, 0
s_add_u32 s31, s31, s79
s_sub_u32 s31, s31, s28
s_lshl_b32 s31, s31, 11
s_add_u32 s77, s77, s31
Lnr_4:
s_getpc_b64 s[84:85]
s_mov_b32 s86, CODE_BYTES_ALL2
s_mov_b32 s87, 0x20000
s_sub_u32 s29, s2, 128
s_lshl_b32 s29, s29, 8
v_add_u32 v20, s29, v0
v_lshlrev_b32 v20, 7, v20
buffer_load_dword v63, v20, s[84:87], 0 offen
v_lshrrev_b32 v9, 2, v3
v_and_b32 v10, 3, v3
v_lshl_add_u32 v11, v4, 3, v9
v_lshlrev_b32 v11, 6, v11
v_and_b32 v12, 1, v4
v_lshl_add_u32 v11, v12, 5, v11
v_lshl_add_u32 v11, v10, 3, v11
v_add_u32 v13, 256, v11
v_lshl_add_u32 v14, v4, 2, v9
v_lshlrev_b32 v14, 6, v14
v_lshrrev_b32 v12, 1, v4
v_lshl_add_u32 v14, v12, 5, v14
v_lshl_add_u32 v14, v10, 3, v14
v_add_u32 v15, 1024, v14
s_cmp_lt_u32 s5, 20
s_cselect_b64 vcc, -1, 0
v_cndmask_b32 v11, v11, v14, vcc
v_cndmask_b32 v13, v13, v15, vcc
v_add_u32 v11, s26, v11
v_add_u32 v13, s26, v13
v_xor_b32 v14, 32, v11
v_xor_b32 v15, 32, v13
s_waitcnt vmcnt(0)
ds_read_b64_tr_b16 v[16:17], v11 offset:0
ds_read_b64_tr_b16 v[18:19], v13 offset:0
ds_read_b64_tr_b16 v[20:21], v14 offset:0
ds_read_b64_tr_b16 v[22:23], v15 offset:0
ds_read_b64_tr_b16 v[24:25], v11 offset:2048
ds_read_b64_tr_b16 v[26:27], v13 offset:2048
ds_read_b64_tr_b16 v[28:29], v14 offset:2048
ds_read_b64_tr_b16 v[30:31], v15 offset:2048
s_waitcnt lgkmcnt(0)
buffer_store_dwordx4 v[16:19], v5, s[48:51], s74 offen
buffer_store_dwordx4 v[20:23], v5, s[48:51], s75 offen
buffer_store_dwordx4 v[24:27], v5, s[48:51], s76 offen
buffer_store_dwordx4 v[28:31], v5, s[48:51], s77 offen
k0_kernel_fin:
k0_kernel_end:
s_endpgm
.p2align 8
.globl k1_kernel
.type k1_kernel,@function
k1_kernel:
s_cmp_ge_u32 s2, 256
s_cbranch_scc1 k1_kernel_end
s_load_dwordx2 s[26:27], s[0:1], 72
s_getpc_b64 s[44:45]
s_mov_b32 s46, CODE_BYTES_K1
s_mov_b32 s47, 0x20000
v_lshlrev_b32 v95, 7, v0
buffer_load_dword v94, v95, s[44:47], 0 offen
v_lshrrev_b32 v48, 6, v0
v_and_b32 v49, 63, v0
v_readfirstlane_b32 s3, v48
v_lshlrev_b32 v3, 4, v49
s_and_b32 s60, s2, 7
s_lshr_b32 s61, s2, 3
s_and_b32 s6, s60, 3
s_lshl_b32 s6, s6, 2
s_and_b32 s62, s61, 3
s_add_u32 s6, s6, s62
s_lshr_b32 s7, s60, 2
s_lshl_b32 s7, s7, 3
s_lshr_b32 s62, s61, 2
s_add_u32 s7, s7, s62
s_and_b32 s4, s3, 3
s_lshr_b32 s5, s3, 2
s_lshl_b32 s48, s4, 12
s_add_u32 s60, s48, 20480
v_add_u32 v2, s60, v3
s_lshl_b32 s60, s6, 2
s_add_u32 s60, s60, s4
s_mul_i32 s49, s60, 40960
s_sub_u32 s49, s49, 4096
s_mul_i32 s54, s60, 151552
s_cmp_lt_u32 s7, 8
s_cbranch_scc1 k1_kernel_A
s_cmp_eq_u32 s5, 0
s_cbranch_scc0 k1_kernel_B1
s_branch k1_kernel_B0
k1_kernel_A:
s_cmp_eq_u32 s5, 0
s_cbranch_scc0 k1_kernel_A1
s_branch k1_kernel_A0
k1_kernel_B0:
s_sub_u32 s60, s7, 8
s_mul_i32 s60, s60, 21
s_lshr_b32 s60, s60, 1
s_add_u32 s60, s60, 24
s_add_u32 s55, s60, 0
s_add_u32 s56, s60, 5
s_lshl_b32 s62, s55, 1
s_add_u32 s62, s62, 120
s_lshl_b32 s63, s56, 1
s_add_u32 s63, s63, 120
s_mul_i32 s64, s4, 3
s_min_u32 s64, s64, 9
s_lshl_b32 s50, s64, 10
s_lshl_b32 s52, s62, 11
s_add_u32 s52, s52, s50
s_sub_u32 s52, s52, 688128
s_mul_i32 s64, s4, 3
s_min_u32 s64, s64, 9
s_lshl_b32 s51, s64, 10
s_lshl_b32 s53, s63, 11
s_add_u32 s53, s53, s51
s_sub_u32 s53, s53, 688128
s_waitcnt lgkmcnt(0)
s_add_u32 s28, s26, 0x1000000
s_addc_u32 s29, s27, 0
s_mov_b32 s30, 0x280000
s_mov_b32 s31, 0x20000
s_add_u32 s32, s26, 0x2000000
s_addc_u32 s33, s27, 0
s_mov_b32 s34, 0x690000
s_mov_b32 s35, 0x20000
s_add_u32 s49, s49, 4096
s_add_u32 m0, s48, 0x5000
s_nop 0
buffer_load_dwordx4 v3, s[28:31], s49 offen offset:0 lds
buffer_load_dwordx4 v3, s[28:31], s49 offen offset:1024 lds
s_add_u32 s52, s52, 688128
s_add_u32 m0, s50, 0x0
s_nop 0
buffer_load_dwordx4 v3, s[32:35], s52 offen offset:0 lds
buffer_load_dwordx4 v3, s[32:35], s52 offen offset:1024 lds
buffer_load_dwordx4 v3, s[32:35], s52 offen offset:2048 lds
s_add_u32 s49, s49, 4096
s_add_u32 m0, s48, 0xe000
s_nop 0
buffer_load_dwordx4 v3, s[28:31], s49 offen offset:0 lds
buffer_load_dwordx4 v3, s[28:31], s49 offen offset:1024 lds
s_add_u32 s52, s52, 688128
s_add_u32 m0, s50, 0x9000
s_nop 0
buffer_load_dwordx4 v3, s[32:35], s52 offen offset:0 lds
buffer_load_dwordx4 v3, s[32:35], s52 offen offset:1024 lds
buffer_load_dwordx4 v3, s[32:35], s52 offen offset:2048 lds
s_add_u32 s49, s49, 4096
s_add_u32 m0, s48, 0x17000
s_nop 0
buffer_load_dwordx4 v3, s[28:31], s49 offen offset:0 lds
buffer_load_dwordx4 v3, s[28:31], s49 offen offset:1024 lds
s_add_u32 s52, s52, 688128
s_add_u32 m0, s50, 0x12000
s_nop 0
buffer_load_dwordx4 v3, s[32:35], s52 offen offset:0 lds
buffer_load_dwordx4 v3, s[32:35], s52 offen offset:1024 lds
buffer_load_dwordx4 v3, s[32:35], s52 offen offset:2048 lds
s_mov_b32 s36, s26
s_mov_b32 s37, s27
s_mov_b32 s38, 0x940000
s_mov_b32 s39, 0x20000
s_add_u32 s40, s26, 0xe00000
s_addc_u32 s41, s27, 0
s_mov_b32 s42, 0xe000
s_mov_b32 s43, 0x20000
s_add_u32 s44, s26, 0x1400000
s_addc_u32 s45, s27, 0
s_mov_b32 s46, 0x100000
s_mov_b32 s47, 0x20000
v_add_u32 v1, 0, v3
s_mov_b32 s80, 0x3fb8aa3b
s_mov_b32 s81, 0x3fb8aa3b
s_mov_b32 s82, 0xbfb8aa3b
s_mov_b32 s83, 0xbfb8aa3b
s_mov_b32 s84, 0x3f800000
s_mov_b32 s85, 0x3f800000
s_mov_b32 s86, 0x358637bd
s_mov_b32 s87, 0x358637bd
s_waitcnt vmcnt(10)
s_barrier
ds_read_b128 a[0:3], v2 offset:0
ds_read_b128 a[4:7], v2 offset:1024
ds_read_b128 a[8:11], v2 offset:2048
ds_read_b128 a[12:15], v2 offset:3072
ds_read_b128 v[16:19], v1 offset:0
ds_read_b128 v[20:23], v1 offset:2048
ds_read_b128 v[24:27], v1 offset:4096
ds_read_b128 v[28:31], v1 offset:6144
ds_read_b128 v[32:35], v1 offset:8192
s_waitcnt lgkmcnt(4)
v_mfma_f32_16x16x32_bf16 v[48:51], v[16:19], a[0:3], 0
s_setprio 1
ds_read_b128 v[36:39], v1 offset:10240
v_mfma_f32_16x16x32_bf16 v[52:55], v[16:19], a[4:7], 0
s_setprio 0
s_waitcnt lgkmcnt(4)
v_mfma_f32_16x16x32_bf16 v[56:59], v[20:23], a[0:3], 0
s_setprio 1
ds_read_b128 v[40:43], v1 offset:1024
v_mfma_f32_16x16x32_bf16 v[60:63], v[20:23], a[4:7], 0
s_setprio 0
s_waitcnt lgkmcnt(4)
v_mfma_f32_16x16x32_bf16 v[64:67], v[24:27], a[0:3], 0
s_setprio 1
ds_read_b128 v[44:47], v1 offset:3072
v_mfma_f32_16x16x32_bf16 v[68:71], v[24:27], a[4:7], 0
s_setprio 0
s_waitcnt lgkmcnt(4)
v_mfma_f32_16x16x32_bf16 v[72:75], v[28:31], a[0:3], 0
s_setprio 1
ds_read_b128 v[16:19], v1 offset:5120
v_mfma_f32_16x16x32_bf16 v[76:79], v[28:31], a[4:7], 0
s_setprio 0
s_waitcnt lgkmcnt(4)
v_mfma_f32_16x16x32_bf16 v[80:83], v[32:35], a[0:3], 0
s_setprio 1
ds_read_b128 v[20:23], v1 offset:7168
v_mfma_f32_16x16x32_bf16 v[84:87], v[32:35], a[4:7], 0
s_setprio 0
s_waitcnt lgkmcnt(4)
v_mfma_f32_16x16x32_bf16 v[88:91], v[36:39], a[0:3], 0
s_setprio 1
ds_read_b128 v[24:27], v1 offset:9216
v_mfma_f32_16x16x32_bf16 v[92:95], v[36:39], a[4:7], 0
s_setprio 0
s_waitcnt vmcnt(5)
s_barrier
s_waitcnt lgkmcnt(4)
v_mfma_f32_16x16x32_bf16 v[48:51], v[40:43], a[8:11], v[48:51]
s_setprio 1
ds_read_b128 v[28:31], v1 offset:11264
ds_read_b128 a[16:19], v2 offset:36864
ds_read_b128 a[20:23], v2 offset:37888
v_mfma_f32_16x16x32_bf16 v[52:55], v[40:43], a[12:15], v[52:55]
s_setprio 0
s_waitcnt lgkmcnt(6)
v_mfma_f32_16x16x32_bf16 v[56:59], v[44:47], a[8:11], v[56:59]
s_setprio 1
ds_read_b128 v[32:35], v1 offset:36864
ds_read_b128 a[24:27], v2 offset:38912
ds_read_b128 a[28:31], v2 offset:39936
v_mfma_f32_16x16x32_bf16 v[60:63], v[44:47], a[12:15], v[60:63]
s_setprio 0
s_add_u32 s49, s49, 4096
s_add_u32 m0, s48, 0x20000
s_nop 0
buffer_load_dwordx4 v3, s[28:31], s49 offen offset:0 lds
buffer_load_dwordx4 v3, s[28:31], s49 offen offset:1024 lds
s_waitcnt lgkmcnt(8)
v_mfma_f32_16x16x32_bf16 v[64:67], v[16:19], a[8:11], v[64:67]
s_setprio 1
ds_read_b128 v[36:39], v1 offset:38912
v_mfma_f32_16x16x32_bf16 v[68:71], v[16:19], a[12:15], v[68:71]
s_setprio 0
s_waitcnt lgkmcnt(8)
v_mfma_f32_16x16x32_bf16 v[72:75], v[20:23], a[8:11], v[72:75]
s_setprio 1
ds_read_b128 v[40:43], v1 offset:40960
v_mfma_f32_16x16x32_bf16 v[76:79], v[20:23], a[12:15], v[76:79]
s_setprio 0
s_waitcnt lgkmcnt(8)
v_mfma_f32_16x16x32_bf16 v[80:83], v[24:27], a[8:11], v[80:83]
s_setprio 1
ds_read_b128 v[44:47], v1 offset:43008
v_mfma_f32_16x16x32_bf16 v[84:87], v[24:27], a[12:15], v[84:87]
s_setprio 0
s_waitcnt lgkmcnt(8)
v_mfma_f32_16x16x32_bf16 v[88:91], v[28:31], a[8:11], v[88:91]
s_setprio 1
ds_read_b128 v[16:19], v1 offset:45056
v_mfma_f32_16x16x32_bf16 v[92:95], v[28:31], a[12:15], v[92:95]
s_setprio 0
s_waitcnt lgkmcnt(6)
v_mfma_f32_16x16x32_bf16 v[48:51], v[32:35], a[16:19], v[48:51]
s_setprio 1
ds_read_b128 v[20:23], v1 offset:47104
v_mfma_f32_16x16x32_bf16 v[52:55], v[32:35], a[20:23], v[52:55]
s_setprio 0
s_waitcnt lgkmcnt(4)
v_mfma_f32_16x16x32_bf16 v[56:59], v[36:39], a[16:19], v[56:59]
s_setprio 1
ds_read_b128 v[24:27], v1 offset:37888
v_mfma_f32_16x16x32_bf16 v[60:63], v[36:39], a[20:23], v[60:63]
s_setprio 0
s_add_u32 s52, s52, 688128
s_add_u32 m0, s50, 0x1b000
s_nop 0
buffer_load_dwordx4 v3, s[32:35], s52 offen offset:0 lds
buffer_load_dwordx4 v3, s[32:35], s52 offen offset:1024 lds
buffer_load_dwordx4 v3, s[32:35], s52 offen offset:2048 lds
s_waitcnt lgkmcnt(4)
v_mfma_f32_16x16x32_bf16 v[64:67], v[40:43], a[16:19], v[64:67]
s_setprio 1
ds_read_b128 v[28:31], v1 offset:39936
v_mfma_f32_16x16x32_bf16 v[68:71], v[40:43], a[20:23], v[68:71]
s_setprio 0
s_waitcnt lgkmcnt(4)
v_mfma_f32_16x16x32_bf16 v[72:75], v[44:47], a[16:19], v[72:75]
s_setprio 1
ds_read_b128 v[32:35], v1 offset:41984
v_mfma_f32_16x16x32_bf16 v[76:79], v[44:47], a[20:23], v[76:79]
s_setprio 0
s_waitcnt lgkmcnt(4)
v_mfma_f32_16x16x32_bf16 v[80:83], v[16:19], a[16:19], v[80:83]
s_setprio 1
ds_read_b128 v[36:39], v1 offset:44032
v_mfma_f32_16x16x32_bf16 v[84:87], v[16:19], a[20:23], v[84:87]
s_setprio 0
s_waitcnt lgkmcnt(4)
v_mfma_f32_16x16x32_bf16 v[88:91], v[20:23], a[16:19], v[88:91]
s_setprio 1
ds_read_b128 v[40:43], v1 offset:46080
v_mfma_f32_16x16x32_bf16 v[92:95], v[20:23], a[20:23], v[92:95]
s_setprio 0
s_waitcnt vmcnt(5)
s_barrier
s_waitcnt lgkmcnt(4)
v_mfma_f32_16x16x32_bf16 v[48:51], v[24:27], a[24:27], v[48:51]
s_setprio 1
ds_read_b128 v[44:47], v1 offset:48128
v_add_u32 v2, 0x12000, v2
ds_read_b128 a[32:35], v2 offset:0
ds_read_b128 a[36:39], v2 offset:1024
v_mfma_f32_16x16x32_bf16 v[52:55], v[24:27], a[28:31], v[52:55]
s_setprio 0
s_waitcnt lgkmcnt(6)
v_mfma_f32_16x16x32_bf16 v[56:59], v[28:31], a[24:27], v[56:59]
s_setprio 1
v_add_u32 v1, 0x12000, v1
ds_read_b128 v[16:19], v1 offset:0
ds_read_b128 a[40:43], v2 offset:2048
ds_read_b128 a[44:47], v2 offset:3072
v_mfma_f32_16x16x32_bf16 v[60:63], v[28:31], a[28:31], v[60:63]
s_setprio 0
s_add_u32 s49, s49, 4096
s_add_u32 m0, s48, 0x5000
s_nop 0
buffer_load_dwordx4 v3, s[28:31], s49 offen offset:0 lds
buffer_load_dwordx4 v3, s[28:31], s49 offen offset:1024 lds
s_waitcnt lgkmcnt(8)
v_mfma_f32_16x16x32_bf16 v[64:67], v[32:35], a[24:27], v[64:67]
s_setprio 1
ds_read_b128 v[20:23], v1 offset:2048
v_mfma_f32_16x16x32_bf16 v[68:71], v[32:35], a[28:31], v[68:71]
s_setprio 0
s_waitcnt lgkmcnt(8)
v_mfma_f32_16x16x32_bf16 v[72:75], v[36:39], a[24:27], v[72:75]
s_setprio 1
ds_read_b128 v[24:27], v1 offset:4096
v_mfma_f32_16x16x32_bf16 v[76:79], v[36:39], a[28:31], v[76:79]
s_setprio 0
s_waitcnt lgkmcnt(8)
v_mfma_f32_16x16x32_bf16 v[80:83], v[40:43], a[24:27], v[80:83]
s_setprio 1
ds_read_b128 v[28:31], v1 offset:6144
v_mfma_f32_16x16x32_bf16 v[84:87], v[40:43], a[28:31], v[84:87]
s_setprio 0
s_waitcnt lgkmcnt(8)
v_mfma_f32_16x16x32_bf16 v[88:91], v[44:47], a[24:27], v[88:91]
s_setprio 1
ds_read_b128 v[32:35], v1 offset:8192
v_mfma_f32_16x16x32_bf16 v[92:95], v[44:47], a[28:31], v[92:95]
s_setprio 0
s_waitcnt lgkmcnt(6)
v_mfma_f32_16x16x32_bf16 v[48:51], v[16:19], a[32:35], v[48:51]
s_setprio 1
ds_read_b128 v[36:39], v1 offset:10240
v_mfma_f32_16x16x32_bf16 v[52:55], v[16:19], a[36:39], v[52:55]
s_setprio 0
s_waitcnt lgkmcnt(4)
v_mfma_f32_16x16x32_bf16 v[56:59], v[20:23], a[32:35], v[56:59]
s_setprio 1
ds_read_b128 v[40:43], v1 offset:1024
v_mfma_f32_16x16x32_bf16 v[60:63], v[20:23], a[36:39], v[60:63]
s_setprio 0
s_add_u32 s52, s52, 688128
s_add_u32 m0, s50, 0x0
s_nop 0
buffer_load_dwordx4 v3, s[32:35], s52 offen offset:0 lds
buffer_load_dwordx4 v3, s[32:35], s52 offen offset:1024 lds
buffer_load_dwordx4 v3, s[32:35], s52 offen offset:2048 lds
s_waitcnt lgkmcnt(4)
v_mfma_f32_16x16x32_bf16 v[64:67], v[24:27], a[32:35], v[64:67]
s_setprio 1
ds_read_b128 v[44:47], v1 offset:3072
v_mfma_f32_16x16x32_bf16 v[68:71], v[24:27], a[36:39], v[68:71]
s_setprio 0
s_waitcnt lgkmcnt(4)
v_mfma_f32_16x16x32_bf16 v[72:75], v[28:31], a[32:35], v[72:75]
s_setprio 1
ds_read_b128 v[16:19], v1 offset:5120
v_mfma_f32_16x16x32_bf16 v[76:79], v[28:31], a[36:39], v[76:79]
s_setprio 0
s_waitcnt lgkmcnt(4)
v_mfma_f32_16x16x32_bf16 v[80:83], v[32:35], a[32:35], v[80:83]
s_setprio 1
ds_read_b128 v[20:23], v1 offset:7168
v_mfma_f32_16x16x32_bf16 v[84:87], v[32:35], a[36:39], v[84:87]
s_setprio 0
s_waitcnt lgkmcnt(4)
v_mfma_f32_16x16x32_bf16 v[88:91], v[36:39], a[32:35], v[88:91]
s_setprio 1
ds_read_b128 v[24:27], v1 offset:9216
v_mfma_f32_16x16x32_bf16 v[92:95], v[36:39], a[36:39], v[92:95]
s_setprio 0
s_waitcnt vmcnt(5)
s_barrier
s_waitcnt lgkmcnt(4)
v_mfma_f32_16x16x32_bf16 v[48:51], v[40:43], a[40:43], v[48:51]
s_setprio 1
ds_read_b128 v[28:31], v1 offset:11264
ds_read_b128 a[48:51], v2 offset:36864
ds_read_b128 a[52:55], v2 offset:37888
v_mfma_f32_16x16x32_bf16 v[52:55], v[40:43], a[44:47], v[52:55]
s_setprio 0
s_waitcnt lgkmcnt(6)
v_mfma_f32_16x16x32_bf16 v[56:59], v[44:47], a[40:43], v[56:59]
s_setprio 1
ds_read_b128 v[32:35], v1 offset:36864
ds_read_b128 a[56:59], v2 offset:38912
ds_read_b128 a[60:63], v2 offset:39936
v_mfma_f32_16x16x32_bf16 v[60:63], v[44:47], a[44:47], v[60:63]
s_setprio 0
s_add_u32 s49, s49, 4096
s_add_u32 m0, s48, 0xe000
s_nop 0
buffer_load_dwordx4 v3, s[28:31], s49 offen offset:0 lds
buffer_load_dwordx4 v3, s[28:31], s49 offen offset:1024 lds
s_waitcnt lgkmcnt(8)
v_mfma_f32_16x16x32_bf16 v[64:67], v[16:19], a[40:43], v[64:67]
s_setprio 1
ds_read_b128 v[36:39], v1 offset:38912
v_mfma_f32_16x16x32_bf16 v[68:71], v[16:19], a[44:47], v[68:71]
s_setprio 0
s_waitcnt lgkmcnt(8)
v_mfma_f32_16x16x32_bf16 v[72:75], v[20:23], a[40:43], v[72:75]
s_setprio 1
ds_read_b128 v[40:43], v1 offset:40960
v_mfma_f32_16x16x32_bf16 v[76:79], v[20:23], a[44:47], v[76:79]
s_setprio 0
s_waitcnt lgkmcnt(8)
v_mfma_f32_16x16x32_bf16 v[80:83], v[24:27], a[40:43], v[80:83]
s_setprio 1
ds_read_b128 v[44:47], v1 offset:43008
v_mfma_f32_16x16x32_bf16 v[84:87], v[24:27], a[44:47], v[84:87]
s_setprio 0
s_waitcnt lgkmcnt(8)
v_mfma_f32_16x16x32_bf16 v[88:91], v[28:31], a[40:43], v[88:91]
s_setprio 1
ds_read_b128 v[16:19], v1 offset:45056
v_mfma_f32_16x16x32_bf16 v[92:95], v[28:31], a[44:47], v[92:95]
s_setprio 0
s_waitcnt lgkmcnt(6)
v_mfma_f32_16x16x32_bf16 v[48:51], v[32:35], a[48:51], v[48:51]
s_setprio 1
ds_read_b128 v[20:23], v1 offset:47104
v_mfma_f32_16x16x32_bf16 v[52:55], v[32:35], a[52:55], v[52:55]
s_setprio 0
s_waitcnt lgkmcnt(4)
v_mfma_f32_16x16x32_bf16 v[56:59], v[36:39], a[48:51], v[56:59]
s_setprio 1
ds_read_b128 v[24:27], v1 offset:37888
v_mfma_f32_16x16x32_bf16 v[60:63], v[36:39], a[52:55], v[60:63]
s_setprio 0
s_add_u32 s52, s52, 688128
s_add_u32 m0, s50, 0x9000
s_nop 0
buffer_load_dwordx4 v3, s[32:35], s52 offen offset:0 lds
buffer_load_dwordx4 v3, s[32:35], s52 offen offset:1024 lds
buffer_load_dwordx4 v3, s[32:35], s52 offen offset:2048 lds
s_waitcnt lgkmcnt(4)
v_mfma_f32_16x16x32_bf16 v[64:67], v[40:43], a[48:51], v[64:67]
s_setprio 1
ds_read_b128 v[28:31], v1 offset:39936
v_mfma_f32_16x16x32_bf16 v[68:71], v[40:43], a[52:55], v[68:71]
s_setprio 0
s_waitcnt lgkmcnt(4)
v_mfma_f32_16x16x32_bf16 v[72:75], v[44:47], a[48:51], v[72:75]
s_setprio 1
ds_read_b128 v[32:35], v1 offset:41984
v_mfma_f32_16x16x32_bf16 v[76:79], v[44:47], a[52:55], v[76:79]
s_setprio 0
s_waitcnt lgkmcnt(4)
v_mfma_f32_16x16x32_bf16 v[80:83], v[16:19], a[48:51], v[80:83]
s_setprio 1
ds_read_b128 v[36:39], v1 offset:44032
v_mfma_f32_16x16x32_bf16 v[84:87], v[16:19], a[52:55], v[84:87]
s_setprio 0
s_waitcnt lgkmcnt(4)
v_mfma_f32_16x16x32_bf16 v[88:91], v[20:23], a[48:51], v[88:91]
s_setprio 1
ds_read_b128 v[40:43], v1 offset:46080
v_mfma_f32_16x16x32_bf16 v[92:95], v[20:23], a[52:55], v[92:95]
s_setprio 0
s_waitcnt vmcnt(5)
s_barrier
s_waitcnt lgkmcnt(4)
v_mfma_f32_16x16x32_bf16 v[48:51], v[24:27], a[56:59], v[48:51]
s_setprio 1
ds_read_b128 v[44:47], v1 offset:48128
v_add_u32 v2, 0xfffee000, v2
ds_read_b128 a[64:67], v2 offset:0
ds_read_b128 a[68:71], v2 offset:1024
v_mfma_f32_16x16x32_bf16 v[52:55], v[24:27], a[60:63], v[52:55]
s_setprio 0
s_waitcnt lgkmcnt(6)
v_mfma_f32_16x16x32_bf16 v[56:59], v[28:31], a[56:59], v[56:59]
s_setprio 1
v_add_u32 v1, 0xfffee000, v1
ds_read_b128 v[16:19], v1 offset:0
ds_read_b128 a[72:75], v2 offset:2048
ds_read_b128 a[76:79], v2 offset:3072
v_mfma_f32_16x16x32_bf16 v[60:63], v[28:31], a[60:63], v[60:63]
s_setprio 0
s_add_u32 s49, s49, 4096
s_add_u32 m0, s48, 0x17000
s_nop 0
buffer_load_dwordx4 v3, s[28:31], s49 offen offset:0 lds
buffer_load_dwordx4 v3, s[28:31], s49 offen offset:1024 lds
s_waitcnt lgkmcnt(8)
v_mfma_f32_16x16x32_bf16 v[64:67], v[32:35], a[56:59], v[64:67]
s_setprio 1
ds_read_b128 v[20:23], v1 offset:2048
v_mfma_f32_16x16x32_bf16 v[68:71], v[32:35], a[60:63], v[68:71]
s_setprio 0
s_waitcnt lgkmcnt(8)
v_mfma_f32_16x16x32_bf16 v[72:75], v[36:39], a[56:59], v[72:75]
s_setprio 1
ds_read_b128 v[24:27], v1 offset:4096
v_mfma_f32_16x16x32_bf16 v[76:79], v[36:39], a[60:63], v[76:79]
s_setprio 0
s_waitcnt lgkmcnt(8)
v_mfma_f32_16x16x32_bf16 v[80:83], v[40:43], a[56:59], v[80:83]
s_setprio 1
ds_read_b128 v[28:31], v1 offset:6144
v_mfma_f32_16x16x32_bf16 v[84:87], v[40:43], a[60:63], v[84:87]
s_setprio 0
s_waitcnt lgkmcnt(8)
v_mfma_f32_16x16x32_bf16 v[88:91], v[44:47], a[56:59], v[88:91]
s_setprio 1
ds_read_b128 v[32:35], v1 offset:8192
v_mfma_f32_16x16x32_bf16 v[92:95], v[44:47], a[60:63], v[92:95]
s_setprio 0
s_waitcnt lgkmcnt(6)
v_mfma_f32_16x16x32_bf16 v[48:51], v[16:19], a[64:67], v[48:51]
s_setprio 1
ds_read_b128 v[36:39], v1 offset:10240
v_mfma_f32_16x16x32_bf16 v[52:55], v[16:19], a[68:71], v[52:55]
s_setprio 0
s_waitcnt lgkmcnt(4)
v_mfma_f32_16x16x32_bf16 v[56:59], v[20:23], a[64:67], v[56:59]
s_setprio 1
ds_read_b128 v[40:43], v1 offset:1024
v_mfma_f32_16x16x32_bf16 v[60:63], v[20:23], a[68:71], v[60:63]
s_setprio 0
s_add_u32 s52, s52, 688128
s_add_u32 m0, s50, 0x12000
s_nop 0
buffer_load_dwordx4 v3, s[32:35], s52 offen offset:0 lds
buffer_load_dwordx4 v3, s[32:35], s52 offen offset:1024 lds
buffer_load_dwordx4 v3, s[32:35], s52 offen offset:2048 lds
s_waitcnt lgkmcnt(4)
v_mfma_f32_16x16x32_bf16 v[64:67], v[24:27], a[64:67], v[64:67]
s_setprio 1
ds_read_b128 v[44:47], v1 offset:3072
v_mfma_f32_16x16x32_bf16 v[68:71], v[24:27], a[68:71], v[68:71]
s_setprio 0
s_waitcnt lgkmcnt(4)
v_mfma_f32_16x16x32_bf16 v[72:75], v[28:31], a[64:67], v[72:75]
s_setprio 1
ds_read_b128 v[16:19], v1 offset:5120
v_mfma_f32_16x16x32_bf16 v[76:79], v[28:31], a[68:71], v[76:79]
s_setprio 0
s_waitcnt lgkmcnt(4)
v_mfma_f32_16x16x32_bf16 v[80:83], v[32:35], a[64:67], v[80:83]
s_setprio 1
ds_read_b128 v[20:23], v1 offset:7168
v_mfma_f32_16x16x32_bf16 v[84:87], v[32:35], a[68:71], v[84:87]
s_setprio 0
s_waitcnt lgkmcnt(4)
v_mfma_f32_16x16x32_bf16 v[88:91], v[36:39], a[64:67], v[88:91]
s_setprio 1
ds_read_b128 v[24:27], v1 offset:9216
v_mfma_f32_16x16x32_bf16 v[92:95], v[36:39], a[68:71], v[92:95]
s_setprio 0
s_waitcnt vmcnt(5)
s_barrier
s_waitcnt lgkmcnt(4)
v_mfma_f32_16x16x32_bf16 v[48:51], v[40:43], a[72:75], v[48:51]
s_setprio 1
ds_read_b128 v[28:31], v1 offset:11264
ds_read_b128 a[80:83], v2 offset:36864
ds_read_b128 a[84:87], v2 offset:37888
v_mfma_f32_16x16x32_bf16 v[52:55], v[40:43], a[76:79], v[52:55]
s_setprio 0
s_waitcnt lgkmcnt(6)
v_mfma_f32_16x16x32_bf16 v[56:59], v[44:47], a[72:75], v[56:59]
s_setprio 1
ds_read_b128 v[32:35], v1 offset:36864
ds_read_b128 a[88:91], v2 offset:38912
ds_read_b128 a[92:95], v2 offset:39936
v_mfma_f32_16x16x32_bf16 v[60:63], v[44:47], a[76:79], v[60:63]
s_setprio 0
s_add_u32 s49, s49, 4096
s_add_u32 m0, s48, 0x20000
s_nop 0
buffer_load_dwordx4 v3, s[28:31], s49 offen offset:0 lds
buffer_load_dwordx4 v3, s[28:31], s49 offen offset:1024 lds
s_waitcnt lgkmcnt(8)
v_mfma_f32_16x16x32_bf16 v[64:67], v[16:19], a[72:75], v[64:67]
s_setprio 1
ds_read_b128 v[36:39], v1 offset:38912
v_mfma_f32_16x16x32_bf16 v[68:71], v[16:19], a[76:79], v[68:71]
s_setprio 0
s_waitcnt lgkmcnt(8)
v_mfma_f32_16x16x32_bf16 v[72:75], v[20:23], a[72:75], v[72:75]
s_setprio 1
ds_read_b128 v[40:43], v1 offset:40960
v_mfma_f32_16x16x32_bf16 v[76:79], v[20:23], a[76:79], v[76:79]
s_setprio 0
s_waitcnt lgkmcnt(8)
v_mfma_f32_16x16x32_bf16 v[80:83], v[24:27], a[72:75], v[80:83]
s_setprio 1
ds_read_b128 v[44:47], v1 offset:43008
v_mfma_f32_16x16x32_bf16 v[84:87], v[24:27], a[76:79], v[84:87]
s_setprio 0
s_waitcnt lgkmcnt(8)
v_mfma_f32_16x16x32_bf16 v[88:91], v[28:31], a[72:75], v[88:91]
s_setprio 1
ds_read_b128 v[16:19], v1 offset:45056
v_mfma_f32_16x16x32_bf16 v[92:95], v[28:31], a[76:79], v[92:95]
s_setprio 0
s_waitcnt lgkmcnt(6)
v_mfma_f32_16x16x32_bf16 v[48:51], v[32:35], a[80:83], v[48:51]
s_setprio 1
ds_read_b128 v[20:23], v1 offset:47104
v_mfma_f32_16x16x32_bf16 v[52:55], v[32:35], a[84:87], v[52:55]
s_setprio 0
s_waitcnt lgkmcnt(4)
v_mfma_f32_16x16x32_bf16 v[56:59], v[36:39], a[80:83], v[56:59]
s_setprio 1
ds_read_b128 v[24:27], v1 offset:37888
v_mfma_f32_16x16x32_bf16 v[60:63], v[36:39], a[84:87], v[60:63]
s_setprio 0
s_add_u32 s52, s52, 688128
s_add_u32 m0, s50, 0x1b000
s_nop 0
buffer_load_dwordx4 v3, s[32:35], s52 offen offset:0 lds
buffer_load_dwordx4 v3, s[32:35], s52 offen offset:1024 lds
buffer_load_dwordx4 v3, s[32:35], s52 offen offset:2048 lds
s_waitcnt lgkmcnt(4)
v_mfma_f32_16x16x32_bf16 v[64:67], v[40:43], a[80:83], v[64:67]
s_setprio 1
ds_read_b128 v[28:31], v1 offset:39936
v_mfma_f32_16x16x32_bf16 v[68:71], v[40:43], a[84:87], v[68:71]
s_setprio 0
s_waitcnt lgkmcnt(4)
v_mfma_f32_16x16x32_bf16 v[72:75], v[44:47], a[80:83], v[72:75]
s_setprio 1
ds_read_b128 v[32:35], v1 offset:41984
v_mfma_f32_16x16x32_bf16 v[76:79], v[44:47], a[84:87], v[76:79]
s_setprio 0
s_waitcnt lgkmcnt(4)
v_mfma_f32_16x16x32_bf16 v[80:83], v[16:19], a[80:83], v[80:83]
s_setprio 1
ds_read_b128 v[36:39], v1 offset:44032
v_mfma_f32_16x16x32_bf16 v[84:87], v[16:19], a[84:87], v[84:87]
s_setprio 0
s_waitcnt lgkmcnt(4)
v_mfma_f32_16x16x32_bf16 v[88:91], v[20:23], a[80:83], v[88:91]
s_setprio 1
ds_read_b128 v[40:43], v1 offset:46080
v_mfma_f32_16x16x32_bf16 v[92:95], v[20:23], a[84:87], v[92:95]
s_setprio 0
s_waitcnt vmcnt(5)
s_barrier
s_waitcnt lgkmcnt(4)
v_mfma_f32_16x16x32_bf16 v[48:51], v[24:27], a[88:91], v[48:51]
s_setprio 1
ds_read_b128 v[44:47], v1 offset:48128
v_add_u32 v2, 0x12000, v2
ds_read_b128 a[96:99], v2 offset:0
ds_read_b128 a[100:103], v2 offset:1024
v_mfma_f32_16x16x32_bf16 v[52:55], v[24:27], a[92:95], v[52:55]
s_setprio 0
s_waitcnt lgkmcnt(6)
v_mfma_f32_16x16x32_bf16 v[56:59], v[28:31], a[88:91], v[56:59]
s_setprio 1
v_add_u32 v1, 0x12000, v1
ds_read_b128 v[16:19], v1 offset:0
ds_read_b128 a[104:107], v2 offset:2048
ds_read_b128 a[108:111], v2 offset:3072
v_mfma_f32_16x16x32_bf16 v[60:63], v[28:31], a[92:95], v[60:63]
s_setprio 0
s_add_u32 s49, s49, 4096
s_add_u32 m0, s48, 0x5000
s_nop 0
buffer_load_dwordx4 v3, s[28:31], s49 offen offset:0 lds
buffer_load_dwordx4 v3, s[28:31], s49 offen offset:1024 lds
s_waitcnt lgkmcnt(8)
v_mfma_f32_16x16x32_bf16 v[64:67], v[32:35], a[88:91], v[64:67]
s_setprio 1
ds_read_b128 v[20:23], v1 offset:2048
v_mfma_f32_16x16x32_bf16 v[68:71], v[32:35], a[92:95], v[68:71]
s_setprio 0
s_waitcnt lgkmcnt(8)
v_mfma_f32_16x16x32_bf16 v[72:75], v[36:39], a[88:91], v[72:75]
s_setprio 1
ds_read_b128 v[24:27], v1 offset:4096
v_mfma_f32_16x16x32_bf16 v[76:79], v[36:39], a[92:95], v[76:79]
s_setprio 0
s_waitcnt lgkmcnt(8)
v_mfma_f32_16x16x32_bf16 v[80:83], v[40:43], a[88:91], v[80:83]
s_setprio 1
ds_read_b128 v[28:31], v1 offset:6144
v_mfma_f32_16x16x32_bf16 v[84:87], v[40:43], a[92:95], v[84:87]
s_setprio 0
s_waitcnt lgkmcnt(8)
v_mfma_f32_16x16x32_bf16 v[88:91], v[44:47], a[88:91], v[88:91]
s_setprio 1
ds_read_b128 v[32:35], v1 offset:8192
v_mfma_f32_16x16x32_bf16 v[92:95], v[44:47], a[92:95], v[92:95]
s_setprio 0
s_waitcnt lgkmcnt(6)
v_mfma_f32_16x16x32_bf16 v[48:51], v[16:19], a[96:99], v[48:51]
s_setprio 1
ds_read_b128 v[36:39], v1 offset:10240
v_mfma_f32_16x16x32_bf16 v[52:55], v[16:19], a[100:103], v[52:55]
s_setprio 0
s_waitcnt lgkmcnt(4)
v_mfma_f32_16x16x32_bf16 v[56:59], v[20:23], a[96:99], v[56:59]
s_setprio 1
ds_read_b128 v[40:43], v1 offset:1024
v_mfma_f32_16x16x32_bf16 v[60:63], v[20:23], a[100:103], v[60:63]
s_setprio 0
s_add_u32 s52, s52, 688128
s_add_u32 m0, s50, 0x0
s_nop 0
buffer_load_dwordx4 v3, s[32:35], s52 offen offset:0 lds
buffer_load_dwordx4 v3, s[32:35], s52 offen offset:1024 lds
buffer_load_dwordx4 v3, s[32:35], s52 offen offset:2048 lds
s_waitcnt lgkmcnt(4)
v_mfma_f32_16x16x32_bf16 v[64:67], v[24:27], a[96:99], v[64:67]
s_setprio 1
ds_read_b128 v[44:47], v1 offset:3072
v_mfma_f32_16x16x32_bf16 v[68:71], v[24:27], a[100:103], v[68:71]
s_setprio 0
s_waitcnt lgkmcnt(4)
v_mfma_f32_16x16x32_bf16 v[72:75], v[28:31], a[96:99], v[72:75]
s_setprio 1
ds_read_b128 v[16:19], v1 offset:5120
v_mfma_f32_16x16x32_bf16 v[76:79], v[28:31], a[100:103], v[76:79]
s_setprio 0
s_waitcnt lgkmcnt(4)
v_mfma_f32_16x16x32_bf16 v[80:83], v[32:35], a[96:99], v[80:83]
s_setprio 1
ds_read_b128 v[20:23], v1 offset:7168
v_mfma_f32_16x16x32_bf16 v[84:87], v[32:35], a[100:103], v[84:87]
s_setprio 0
s_waitcnt lgkmcnt(4)
v_mfma_f32_16x16x32_bf16 v[88:91], v[36:39], a[96:99], v[88:91]
s_setprio 1
ds_read_b128 v[24:27], v1 offset:9216
v_mfma_f32_16x16x32_bf16 v[92:95], v[36:39], a[100:103], v[92:95]
s_setprio 0
s_waitcnt vmcnt(5)
s_barrier
s_waitcnt lgkmcnt(4)
v_mfma_f32_16x16x32_bf16 v[48:51], v[40:43], a[104:107], v[48:51]
s_setprio 1
ds_read_b128 v[28:31], v1 offset:11264
ds_read_b128 a[112:115], v2 offset:36864
ds_read_b128 a[116:119], v2 offset:37888
v_mfma_f32_16x16x32_bf16 v[52:55], v[40:43], a[108:111], v[52:55]
s_setprio 0
s_waitcnt lgkmcnt(6)
v_mfma_f32_16x16x32_bf16 v[56:59], v[44:47], a[104:107], v[56:59]
s_setprio 1
ds_read_b128 v[32:35], v1 offset:36864
ds_read_b128 a[120:123], v2 offset:38912
ds_read_b128 a[124:127], v2 offset:39936
v_mfma_f32_16x16x32_bf16 v[60:63], v[44:47], a[108:111], v[60:63]
s_setprio 0
s_add_u32 s49, s49, 4096
s_add_u32 m0, s48, 0xe000
s_nop 0
buffer_load_dwordx4 v3, s[28:31], s49 offen offset:0 lds
buffer_load_dwordx4 v3, s[28:31], s49 offen offset:1024 lds
s_waitcnt lgkmcnt(8)
v_mfma_f32_16x16x32_bf16 v[64:67], v[16:19], a[104:107], v[64:67]
s_setprio 1
ds_read_b128 v[36:39], v1 offset:38912
v_mfma_f32_16x16x32_bf16 v[68:71], v[16:19], a[108:111], v[68:71]
s_setprio 0
s_waitcnt lgkmcnt(8)
v_mfma_f32_16x16x32_bf16 v[72:75], v[20:23], a[104:107], v[72:75]
s_setprio 1
ds_read_b128 v[40:43], v1 offset:40960
v_mfma_f32_16x16x32_bf16 v[76:79], v[20:23], a[108:111], v[76:79]
s_setprio 0
s_waitcnt lgkmcnt(8)
v_mfma_f32_16x16x32_bf16 v[80:83], v[24:27], a[104:107], v[80:83]
s_setprio 1
ds_read_b128 v[44:47], v1 offset:43008
v_mfma_f32_16x16x32_bf16 v[84:87], v[24:27], a[108:111], v[84:87]
s_setprio 0
s_waitcnt lgkmcnt(8)
v_mfma_f32_16x16x32_bf16 v[88:91], v[28:31], a[104:107], v[88:91]
s_setprio 1
ds_read_b128 v[16:19], v1 offset:45056
v_mfma_f32_16x16x32_bf16 v[92:95], v[28:31], a[108:111], v[92:95]
s_setprio 0
s_waitcnt lgkmcnt(6)
v_mfma_f32_16x16x32_bf16 v[48:51], v[32:35], a[112:115], v[48:51]
s_setprio 1
ds_read_b128 v[20:23], v1 offset:47104
v_mfma_f32_16x16x32_bf16 v[52:55], v[32:35], a[116:119], v[52:55]
s_setprio 0
s_waitcnt lgkmcnt(4)
v_mfma_f32_16x16x32_bf16 v[56:59], v[36:39], a[112:115], v[56:59]
s_setprio 1
ds_read_b128 v[24:27], v1 offset:37888
v_mfma_f32_16x16x32_bf16 v[60:63], v[36:39], a[116:119], v[60:63]
s_setprio 0
s_add_u32 s52, s52, 688128
s_add_u32 m0, s50, 0x9000
s_nop 0
buffer_load_dwordx4 v3, s[32:35], s52 offen offset:0 lds
buffer_load_dwordx4 v3, s[32:35], s52 offen offset:1024 lds
buffer_load_dwordx4 v3, s[32:35], s52 offen offset:2048 lds
s_waitcnt lgkmcnt(4)
v_mfma_f32_16x16x32_bf16 v[64:67], v[40:43], a[112:115], v[64:67]
s_setprio 1
ds_read_b128 v[28:31], v1 offset:39936
v_mfma_f32_16x16x32_bf16 v[68:71], v[40:43], a[116:119], v[68:71]
s_setprio 0
s_waitcnt lgkmcnt(4)
v_mfma_f32_16x16x32_bf16 v[72:75], v[44:47], a[112:115], v[72:75]
s_setprio 1
ds_read_b128 v[32:35], v1 offset:41984
v_mfma_f32_16x16x32_bf16 v[76:79], v[44:47], a[116:119], v[76:79]
s_setprio 0
s_waitcnt lgkmcnt(4)
v_mfma_f32_16x16x32_bf16 v[80:83], v[16:19], a[112:115], v[80:83]
s_setprio 1
ds_read_b128 v[36:39], v1 offset:44032
v_mfma_f32_16x16x32_bf16 v[84:87], v[16:19], a[116:119], v[84:87]
s_setprio 0
s_waitcnt lgkmcnt(4)
v_mfma_f32_16x16x32_bf16 v[88:91], v[20:23], a[112:115], v[88:91]
s_setprio 1
ds_read_b128 v[40:43], v1 offset:46080
v_mfma_f32_16x16x32_bf16 v[92:95], v[20:23], a[116:119], v[92:95]
s_setprio 0
s_waitcnt vmcnt(5)
s_barrier
s_waitcnt lgkmcnt(4)
v_mfma_f32_16x16x32_bf16 v[48:51], v[24:27], a[120:123], v[48:51]
s_setprio 1
ds_read_b128 v[44:47], v1 offset:48128
v_add_u32 v2, 0xfffee000, v2
ds_read_b128 a[128:131], v2 offset:0
ds_read_b128 a[132:135], v2 offset:1024
v_mfma_f32_16x16x32_bf16 v[52:55], v[24:27], a[124:127], v[52:55]
s_setprio 0
s_waitcnt lgkmcnt(6)
v_mfma_f32_16x16x32_bf16 v[56:59], v[28:31], a[120:123], v[56:59]
s_setprio 1
v_add_u32 v1, 0xfffee000, v1
ds_read_b128 v[16:19], v1 offset:0
ds_read_b128 a[136:139], v2 offset:2048
ds_read_b128 a[140:143], v2 offset:3072
v_mfma_f32_16x16x32_bf16 v[60:63], v[28:31], a[124:127], v[60:63]
s_setprio 0
s_add_u32 s53, s53, 688128
s_add_u32 m0, s51, 0x12000
s_nop 0
buffer_load_dwordx4 v3, s[32:35], s53 offen offset:0 lds
buffer_load_dwordx4 v3, s[32:35], s53 offen offset:1024 lds
buffer_load_dwordx4 v3, s[32:35], s53 offen offset:2048 lds
s_waitcnt lgkmcnt(8)
v_mfma_f32_16x16x32_bf16 v[64:67], v[32:35], a[120:123], v[64:67]
s_setprio 1
ds_read_b128 v[20:23], v1 offset:2048
v_mfma_f32_16x16x32_bf16 v[68:71], v[32:35], a[124:127], v[68:71]
s_setprio 0
s_waitcnt lgkmcnt(8)
v_mfma_f32_16x16x32_bf16 v[72:75], v[36:39], a[120:123], v[72:75]
s_setprio 1
ds_read_b128 v[24:27], v1 offset:4096
v_mfma_f32_16x16x32_bf16 v[76:79], v[36:39], a[124:127], v[76:79]
s_setprio 0
s_waitcnt lgkmcnt(8)
v_mfma_f32_16x16x32_bf16 v[80:83], v[40:43], a[120:123], v[80:83]
s_setprio 1
ds_read_b128 v[28:31], v1 offset:6144
v_mfma_f32_16x16x32_bf16 v[84:87], v[40:43], a[124:127], v[84:87]
s_setprio 0
s_waitcnt lgkmcnt(8)
v_mfma_f32_16x16x32_bf16 v[88:91], v[44:47], a[120:123], v[88:91]
s_setprio 1
ds_read_b128 v[32:35], v1 offset:8192
v_mfma_f32_16x16x32_bf16 v[92:95], v[44:47], a[124:127], v[92:95]
s_setprio 0
s_waitcnt lgkmcnt(6)
v_mfma_f32_16x16x32_bf16 v[48:51], v[16:19], a[128:131], v[48:51]
s_setprio 1
ds_read_b128 v[36:39], v1 offset:10240
v_mfma_f32_16x16x32_bf16 v[52:55], v[16:19], a[132:135], v[52:55]
s_setprio 0
s_waitcnt lgkmcnt(4)
v_mfma_f32_16x16x32_bf16 v[56:59], v[20:23], a[128:131], v[56:59]
s_setprio 1
ds_read_b128 v[40:43], v1 offset:1024
v_mfma_f32_16x16x32_bf16 v[60:63], v[20:23], a[132:135], v[60:63]
s_setprio 0
s_waitcnt lgkmcnt(4)
v_mfma_f32_16x16x32_bf16 v[64:67], v[24:27], a[128:131], v[64:67]
s_setprio 1
ds_read_b128 v[44:47], v1 offset:3072
v_mfma_f32_16x16x32_bf16 v[68:71], v[24:27], a[132:135], v[68:71]
s_setprio 0
s_waitcnt lgkmcnt(4)
v_mfma_f32_16x16x32_bf16 v[72:75], v[28:31], a[128:131], v[72:75]
s_setprio 1
ds_read_b128 v[16:19], v1 offset:5120
v_mfma_f32_16x16x32_bf16 v[76:79], v[28:31], a[132:135], v[76:79]
s_setprio 0
s_waitcnt lgkmcnt(4)
v_mfma_f32_16x16x32_bf16 v[80:83], v[32:35], a[128:131], v[80:83]
s_setprio 1
ds_read_b128 v[20:23], v1 offset:7168
v_mfma_f32_16x16x32_bf16 v[84:87], v[32:35], a[132:135], v[84:87]
s_setprio 0
s_waitcnt lgkmcnt(4)
v_mfma_f32_16x16x32_bf16 v[88:91], v[36:39], a[128:131], v[88:91]
s_setprio 1
ds_read_b128 v[24:27], v1 offset:9216
v_mfma_f32_16x16x32_bf16 v[92:95], v[36:39], a[132:135], v[92:95]
s_setprio 0
s_waitcnt vmcnt(3)
s_barrier
s_waitcnt lgkmcnt(4)
v_mfma_f32_16x16x32_bf16 v[48:51], v[40:43], a[136:139], v[48:51]
s_setprio 1
ds_read_b128 v[28:31], v1 offset:11264
ds_read_b128 a[144:147], v2 offset:36864
ds_read_b128 a[148:151], v2 offset:37888
v_mfma_f32_16x16x32_bf16 v[52:55], v[40:43], a[140:143], v[52:55]
s_setprio 0
s_waitcnt lgkmcnt(6)
v_mfma_f32_16x16x32_bf16 v[56:59], v[44:47], a[136:139], v[56:59]
s_setprio 1
ds_read_b128 v[32:35], v1 offset:36864
ds_read_b128 a[152:155], v2 offset:38912
ds_read_b128 a[156:159], v2 offset:39936
v_mfma_f32_16x16x32_bf16 v[60:63], v[44:47], a[140:143], v[60:63]
s_setprio 0
s_add_u32 s53, s53, 688128
s_add_u32 m0, s51, 0x1e000
s_nop 0
buffer_load_dwordx4 v3, s[32:35], s53 offen offset:0 lds
buffer_load_dwordx4 v3, s[32:35], s53 offen offset:1024 lds
buffer_load_dwordx4 v3, s[32:35], s53 offen offset:2048 lds
s_waitcnt lgkmcnt(8)
v_mfma_f32_16x16x32_bf16 v[64:67], v[16:19], a[136:139], v[64:67]
s_setprio 1
ds_read_b128 v[36:39], v1 offset:38912
v_mfma_f32_16x16x32_bf16 v[68:71], v[16:19], a[140:143], v[68:71]
s_setprio 0
s_waitcnt lgkmcnt(8)
v_mfma_f32_16x16x32_bf16 v[72:75], v[20:23], a[136:139], v[72:75]
s_setprio 1
ds_read_b128 v[40:43], v1 offset:40960
v_mfma_f32_16x16x32_bf16 v[76:79], v[20:23], a[140:143], v[76:79]
s_setprio 0
s_waitcnt lgkmcnt(8)
v_mfma_f32_16x16x32_bf16 v[80:83], v[24:27], a[136:139], v[80:83]
s_setprio 1
ds_read_b128 v[44:47], v1 offset:43008
v_mfma_f32_16x16x32_bf16 v[84:87], v[24:27], a[140:143], v[84:87]
s_setprio 0
s_waitcnt lgkmcnt(8)
v_mfma_f32_16x16x32_bf16 v[88:91], v[28:31], a[136:139], v[88:91]
s_setprio 1
ds_read_b128 v[16:19], v1 offset:45056
v_mfma_f32_16x16x32_bf16 v[92:95], v[28:31], a[140:143], v[92:95]
s_setprio 0
s_waitcnt lgkmcnt(6)
v_mfma_f32_16x16x32_bf16 v[48:51], v[32:35], a[144:147], v[48:51]
s_setprio 1
ds_read_b128 v[20:23], v1 offset:47104
v_mfma_f32_16x16x32_bf16 v[52:55], v[32:35], a[148:151], v[52:55]
s_setprio 0
s_waitcnt lgkmcnt(4)
v_mfma_f32_16x16x32_bf16 v[56:59], v[36:39], a[144:147], v[56:59]
s_setprio 1
ds_read_b128 v[24:27], v1 offset:37888
v_mfma_f32_16x16x32_bf16 v[60:63], v[36:39], a[148:151], v[60:63]
s_setprio 0
s_waitcnt lgkmcnt(4)
v_mfma_f32_16x16x32_bf16 v[64:67], v[40:43], a[144:147], v[64:67]
s_setprio 1
ds_read_b128 v[28:31], v1 offset:39936
v_mfma_f32_16x16x32_bf16 v[68:71], v[40:43], a[148:151], v[68:71]
s_setprio 0
s_waitcnt lgkmcnt(4)
v_mfma_f32_16x16x32_bf16 v[72:75], v[44:47], a[144:147], v[72:75]
s_setprio 1
ds_read_b128 v[32:35], v1 offset:41984
v_mfma_f32_16x16x32_bf16 v[76:79], v[44:47], a[148:151], v[76:79]
s_setprio 0
s_waitcnt lgkmcnt(4)
v_mfma_f32_16x16x32_bf16 v[80:83], v[16:19], a[144:147], v[80:83]
s_setprio 1
ds_read_b128 v[36:39], v1 offset:44032
v_mfma_f32_16x16x32_bf16 v[84:87], v[16:19], a[148:151], v[84:87]
s_setprio 0
s_waitcnt lgkmcnt(4)
v_mfma_f32_16x16x32_bf16 v[88:91], v[20:23], a[144:147], v[88:91]
s_setprio 1
ds_read_b128 v[40:43], v1 offset:46080
v_mfma_f32_16x16x32_bf16 v[92:95], v[20:23], a[148:151], v[92:95]
s_setprio 0
s_waitcnt vmcnt(3)
s_barrier
s_waitcnt lgkmcnt(4)
v_mfma_f32_16x16x32_bf16 v[48:51], v[24:27], a[152:155], v[48:51]
s_setprio 1
ds_read_b128 v[44:47], v1 offset:48128
v_mfma_f32_16x16x32_bf16 v[52:55], v[24:27], a[156:159], v[52:55]
s_setprio 0
s_waitcnt lgkmcnt(4)
v_mfma_f32_16x16x32_bf16 v[56:59], v[28:31], a[152:155], v[56:59]
s_setprio 1
v_mfma_f32_16x16x32_bf16 v[60:63], v[28:31], a[156:159], v[60:63]
s_setprio 0
s_add_u32 s53, s53, 688128
s_add_u32 m0, s51, 0x0
s_nop 0
buffer_load_dwordx4 v3, s[32:35], s53 offen offset:0 lds
buffer_load_dwordx4 v3, s[32:35], s53 offen offset:1024 lds
buffer_load_dwordx4 v3, s[32:35], s53 offen offset:2048 lds
s_waitcnt lgkmcnt(3)
v_mfma_f32_16x16x32_bf16 v[64:67], v[32:35], a[152:155], v[64:67]
s_setprio 1
v_mfma_f32_16x16x32_bf16 v[68:71], v[32:35], a[156:159], v[68:71]
s_setprio 0
s_waitcnt lgkmcnt(2)
v_mfma_f32_16x16x32_bf16 v[72:75], v[36:39], a[152:155], v[72:75]
s_setprio 1
v_mfma_f32_16x16x32_bf16 v[76:79], v[36:39], a[156:159], v[76:79]
s_setprio 0
s_waitcnt lgkmcnt(1)
v_mfma_f32_16x16x32_bf16 v[80:83], v[40:43], a[152:155], v[80:83]
s_setprio 1
v_mfma_f32_16x16x32_bf16 v[84:87], v[40:43], a[156:159], v[84:87]
s_setprio 0
s_waitcnt lgkmcnt(0)
v_mfma_f32_16x16x32_bf16 v[88:91], v[44:47], a[152:155], v[88:91]
s_setprio 1
v_mfma_f32_16x16x32_bf16 v[92:95], v[44:47], a[156:159], v[92:95]
s_setprio 0
s_nop 5
s_lshl_b32 s60, s55, 10
s_add_u32 s60, s60, s54
s_add_u32 s60, s60, 40960
v_pk_mul_f32 v[48:49], v[48:49], s[82:83]
v_pk_mul_f32 v[50:51], v[50:51], s[82:83]
v_exp_f32 v48, v48
v_exp_f32 v49, v49
v_exp_f32 v50, v50
v_exp_f32 v51, v51
s_nop 0
v_pk_add_f32 v[48:49], v[48:49], s[84:85]
v_pk_add_f32 v[50:51], v[50:51], s[84:85]
v_rcp_f32 v48, v48
v_rcp_f32 v49, v49
v_rcp_f32 v50, v50
v_rcp_f32 v51, v51
s_nop 0
v_pk_mul_f32 v[56:57], v[56:57], v[48:49]
v_pk_mul_f32 v[58:59], v[58:59], v[50:51]
v_pk_mul_f32 v[52:53], v[52:53], s[82:83]
v_pk_mul_f32 v[54:55], v[54:55], s[82:83]
v_exp_f32 v52, v52
v_exp_f32 v53, v53
v_exp_f32 v54, v54
v_exp_f32 v55, v55
s_nop 0
v_pk_add_f32 v[52:53], v[52:53], s[84:85]
v_pk_add_f32 v[54:55], v[54:55], s[84:85]
v_rcp_f32 v52, v52
v_rcp_f32 v53, v53
v_rcp_f32 v54, v54
v_rcp_f32 v55, v55
s_nop 0
v_pk_mul_f32 v[60:61], v[60:61], v[52:53]
v_pk_mul_f32 v[62:63], v[62:63], v[54:55]
v_cvt_pk_bf16_f32 v20, v56, v57
v_cvt_pk_bf16_f32 v21, v58, v59
v_cvt_pk_bf16_f32 v22, v60, v61
v_cvt_pk_bf16_f32 v23, v62, v63
s_nop 1
v_permlane16_swap_b32 v20, v22
v_permlane16_swap_b32 v21, v23
s_nop 0
buffer_store_dwordx4 v[20:23], v3, s[36:39], s60 offen offset:0
v_pk_mul_f32 v[64:65], v[64:65], s[82:83]
v_pk_mul_f32 v[66:67], v[66:67], s[82:83]
v_exp_f32 v64, v64
v_exp_f32 v65, v65
v_exp_f32 v66, v66
v_exp_f32 v67, v67
s_nop 0
v_pk_add_f32 v[64:65], v[64:65], s[84:85]
v_pk_add_f32 v[66:67], v[66:67], s[84:85]
v_rcp_f32 v64, v64
v_rcp_f32 v65, v65
v_rcp_f32 v66, v66
v_rcp_f32 v67, v67
s_nop 0
v_pk_mul_f32 v[72:73], v[72:73], v[64:65]
v_pk_mul_f32 v[74:75], v[74:75], v[66:67]
v_pk_mul_f32 v[68:69], v[68:69], s[82:83]
v_pk_mul_f32 v[70:71], v[70:71], s[82:83]
v_exp_f32 v68, v68
v_exp_f32 v69, v69
v_exp_f32 v70, v70
v_exp_f32 v71, v71
s_nop 0
v_pk_add_f32 v[68:69], v[68:69], s[84:85]
v_pk_add_f32 v[70:71], v[70:71], s[84:85]
v_rcp_f32 v68, v68
v_rcp_f32 v69, v69
v_rcp_f32 v70, v70
v_rcp_f32 v71, v71
s_nop 0
v_pk_mul_f32 v[76:77], v[76:77], v[68:69]
v_pk_mul_f32 v[78:79], v[78:79], v[70:71]
v_cvt_pk_bf16_f32 v24, v72, v73
v_cvt_pk_bf16_f32 v25, v74, v75
v_cvt_pk_bf16_f32 v26, v76, v77
v_cvt_pk_bf16_f32 v27, v78, v79
s_nop 1
v_permlane16_swap_b32 v24, v26
v_permlane16_swap_b32 v25, v27
s_nop 0
buffer_store_dwordx4 v[24:27], v3, s[36:39], s60 offen offset:1024
v_pk_mul_f32 v[80:81], v[80:81], s[82:83]
v_pk_mul_f32 v[82:83], v[82:83], s[82:83]
v_exp_f32 v80, v80
v_exp_f32 v81, v81
v_exp_f32 v82, v82
v_exp_f32 v83, v83
s_nop 0
v_pk_add_f32 v[80:81], v[80:81], s[84:85]
v_pk_add_f32 v[82:83], v[82:83], s[84:85]
v_rcp_f32 v80, v80
v_rcp_f32 v81, v81
v_rcp_f32 v82, v82
v_rcp_f32 v83, v83
s_nop 0
v_pk_mul_f32 v[88:89], v[88:89], v[80:81]
v_pk_mul_f32 v[90:91], v[90:91], v[82:83]
v_pk_mul_f32 v[84:85], v[84:85], s[82:83]
v_pk_mul_f32 v[86:87], v[86:87], s[82:83]
v_exp_f32 v84, v84
v_exp_f32 v85, v85
v_exp_f32 v86, v86
v_exp_f32 v87, v87
s_nop 0
v_pk_add_f32 v[84:85], v[84:85], s[84:85]
v_pk_add_f32 v[86:87], v[86:87], s[84:85]
v_rcp_f32 v84, v84
v_rcp_f32 v85, v85
v_rcp_f32 v86, v86
v_rcp_f32 v87, v87
s_nop 0
v_pk_mul_f32 v[92:93], v[92:93], v[84:85]
v_pk_mul_f32 v[94:95], v[94:95], v[86:87]
v_cvt_pk_bf16_f32 v20, v88, v89
v_cvt_pk_bf16_f32 v21, v90, v91
v_cvt_pk_bf16_f32 v22, v92, v93
v_cvt_pk_bf16_f32 v23, v94, v95
s_nop 1
v_permlane16_swap_b32 v20, v22
v_permlane16_swap_b32 v21, v23
s_nop 0
buffer_store_dwordx4 v[20:23], v3, s[36:39], s60 offen offset:2048
v_add_u32 v1, 0x12000, v1
ds_read_b128 v[16:19], v1 offset:0
ds_read_b128 v[20:23], v1 offset:2048
ds_read_b128 v[24:27], v1 offset:4096
ds_read_b128 v[28:31], v1 offset:6144
ds_read_b128 v[32:35], v1 offset:8192
s_waitcnt lgkmcnt(4)
v_mfma_f32_16x16x32_bf16 v[48:51], v[16:19], a[0:3], 0
s_setprio 1
ds_read_b128 v[36:39], v1 offset:10240
v_mfma_f32_16x16x32_bf16 v[52:55], v[16:19], a[4:7], 0
s_setprio 0
s_waitcnt lgkmcnt(4)
v_mfma_f32_16x16x32_bf16 v[56:59], v[20:23], a[0:3], 0
s_setprio 1
ds_read_b128 v[40:43], v1 offset:1024
v_mfma_f32_16x16x32_bf16 v[60:63], v[20:23], a[4:7], 0
s_setprio 0
s_waitcnt lgkmcnt(4)
v_mfma_f32_16x16x32_bf16 v[64:67], v[24:27], a[0:3], 0
s_setprio 1
ds_read_b128 v[44:47], v1 offset:3072
v_mfma_f32_16x16x32_bf16 v[68:71], v[24:27], a[4:7], 0
s_setprio 0
s_waitcnt lgkmcnt(4)
v_mfma_f32_16x16x32_bf16 v[72:75], v[28:31], a[0:3], 0
s_setprio 1
ds_read_b128 v[16:19], v1 offset:5120
v_mfma_f32_16x16x32_bf16 v[76:79], v[28:31], a[4:7], 0
s_setprio 0
s_waitcnt lgkmcnt(4)
v_mfma_f32_16x16x32_bf16 v[80:83], v[32:35], a[0:3], 0
s_setprio 1
ds_read_b128 v[20:23], v1 offset:7168
v_mfma_f32_16x16x32_bf16 v[84:87], v[32:35], a[4:7], 0
s_setprio 0
s_waitcnt lgkmcnt(4)
v_mfma_f32_16x16x32_bf16 v[88:91], v[36:39], a[0:3], 0
s_setprio 1
ds_read_b128 v[24:27], v1 offset:9216
v_mfma_f32_16x16x32_bf16 v[92:95], v[36:39], a[4:7], 0
s_setprio 0
s_waitcnt vmcnt(6)
s_barrier
s_waitcnt lgkmcnt(4)
v_mfma_f32_16x16x32_bf16 v[48:51], v[40:43], a[8:11], v[48:51]
s_setprio 1
ds_read_b128 v[28:31], v1 offset:11264
v_mfma_f32_16x16x32_bf16 v[52:55], v[40:43], a[12:15], v[52:55]
s_setprio 0
s_waitcnt lgkmcnt(4)
v_mfma_f32_16x16x32_bf16 v[56:59], v[44:47], a[8:11], v[56:59]
s_setprio 1
ds_read_b128 v[32:35], v1 offset:49152
v_mfma_f32_16x16x32_bf16 v[60:63], v[44:47], a[12:15], v[60:63]
s_setprio 0
s_add_u32 s53, s53, 688128
s_add_u32 m0, s51, 0x18000
s_nop 0
buffer_load_dwordx4 v3, s[32:35], s53 offen offset:0 lds
buffer_load_dwordx4 v3, s[32:35], s53 offen offset:1024 lds
buffer_load_dwordx4 v3, s[32:35], s53 offen offset:2048 lds
s_waitcnt lgkmcnt(4)
v_mfma_f32_16x16x32_bf16 v[64:67], v[16:19], a[8:11], v[64:67]
s_setprio 1
ds_read_b128 v[36:39], v1 offset:51200
v_mfma_f32_16x16x32_bf16 v[68:71], v[16:19], a[12:15], v[68:71]
s_setprio 0
s_waitcnt lgkmcnt(4)
v_mfma_f32_16x16x32_bf16 v[72:75], v[20:23], a[8:11], v[72:75]
s_setprio 1
ds_read_b128 v[40:43], v1 offset:53248
v_mfma_f32_16x16x32_bf16 v[76:79], v[20:23], a[12:15], v[76:79]
s_setprio 0
s_waitcnt lgkmcnt(4)
v_mfma_f32_16x16x32_bf16 v[80:83], v[24:27], a[8:11], v[80:83]
s_setprio 1
ds_read_b128 v[44:47], v1 offset:55296
v_mfma_f32_16x16x32_bf16 v[84:87], v[24:27], a[12:15], v[84:87]
s_setprio 0
s_waitcnt lgkmcnt(4)
v_mfma_f32_16x16x32_bf16 v[88:91], v[28:31], a[8:11], v[88:91]
s_setprio 1
ds_read_b128 v[16:19], v1 offset:57344
v_mfma_f32_16x16x32_bf16 v[92:95], v[28:31], a[12:15], v[92:95]
s_setprio 0
s_waitcnt lgkmcnt(4)
v_mfma_f32_16x16x32_bf16 v[48:51], v[32:35], a[16:19], v[48:51]
s_setprio 1
ds_read_b128 v[20:23], v1 offset:59392
v_mfma_f32_16x16x32_bf16 v[52:55], v[32:35], a[20:23], v[52:55]
s_setprio 0
s_waitcnt lgkmcnt(4)
v_mfma_f32_16x16x32_bf16 v[56:59], v[36:39], a[16:19], v[56:59]
s_setprio 1
ds_read_b128 v[24:27], v1 offset:50176
v_mfma_f32_16x16x32_bf16 v[60:63], v[36:39], a[20:23], v[60:63]
s_setprio 0
s_waitcnt lgkmcnt(4)
v_mfma_f32_16x16x32_bf16 v[64:67], v[40:43], a[16:19], v[64:67]
s_setprio 1
ds_read_b128 v[28:31], v1 offset:52224
v_mfma_f32_16x16x32_bf16 v[68:71], v[40:43], a[20:23], v[68:71]
s_setprio 0
s_waitcnt lgkmcnt(4)
v_mfma_f32_16x16x32_bf16 v[72:75], v[44:47], a[16:19], v[72:75]
s_setprio 1
ds_read_b128 v[32:35], v1 offset:54272
v_mfma_f32_16x16x32_bf16 v[76:79], v[44:47], a[20:23], v[76:79]
s_setprio 0
s_waitcnt lgkmcnt(4)
v_mfma_f32_16x16x32_bf16 v[80:83], v[16:19], a[16:19], v[80:83]
s_setprio 1
ds_read_b128 v[36:39], v1 offset:56320
v_mfma_f32_16x16x32_bf16 v[84:87], v[16:19], a[20:23], v[84:87]
s_setprio 0
s_waitcnt lgkmcnt(4)
v_mfma_f32_16x16x32_bf16 v[88:91], v[20:23], a[16:19], v[88:91]
s_setprio 1
ds_read_b128 v[40:43], v1 offset:58368
v_mfma_f32_16x16x32_bf16 v[92:95], v[20:23], a[20:23], v[92:95]
s_setprio 0
s_waitcnt vmcnt(6)
s_barrier
s_waitcnt lgkmcnt(4)
v_mfma_f32_16x16x32_bf16 v[48:51], v[24:27], a[24:27], v[48:51]
s_setprio 1
ds_read_b128 v[44:47], v1 offset:60416
v_mfma_f32_16x16x32_bf16 v[52:55], v[24:27], a[28:31], v[52:55]
s_setprio 0
s_waitcnt lgkmcnt(4)
v_mfma_f32_16x16x32_bf16 v[56:59], v[28:31], a[24:27], v[56:59]
s_setprio 1
v_add_u32 v1, 0xfffee000, v1
ds_read_b128 v[16:19], v1 offset:0
v_mfma_f32_16x16x32_bf16 v[60:63], v[28:31], a[28:31], v[60:63]
s_setprio 0
s_add_u32 s53, s53, 688128
s_add_u32 m0, s51, 0x12000
s_nop 0
buffer_load_dwordx4 v3, s[32:35], s53 offen offset:0 lds
buffer_load_dwordx4 v3, s[32:35], s53 offen offset:1024 lds
buffer_load_dwordx4 v3, s[32:35], s53 offen offset:2048 lds
s_waitcnt lgkmcnt(4)
v_mfma_f32_16x16x32_bf16 v[64:67], v[32:35], a[24:27], v[64:67]
s_setprio 1
ds_read_b128 v[20:23], v1 offset:2048
v_mfma_f32_16x16x32_bf16 v[68:71], v[32:35], a[28:31], v[68:71]
s_setprio 0
s_waitcnt lgkmcnt(4)
v_mfma_f32_16x16x32_bf16 v[72:75], v[36:39], a[24:27], v[72:75]
s_setprio 1
ds_read_b128 v[24:27], v1 offset:4096
v_mfma_f32_16x16x32_bf16 v[76:79], v[36:39], a[28:31], v[76:79]
s_setprio 0
s_waitcnt lgkmcnt(4)
v_mfma_f32_16x16x32_bf16 v[80:83], v[40:43], a[24:27], v[80:83]
s_setprio 1
ds_read_b128 v[28:31], v1 offset:6144
v_mfma_f32_16x16x32_bf16 v[84:87], v[40:43], a[28:31], v[84:87]
s_setprio 0
s_waitcnt lgkmcnt(4)
v_mfma_f32_16x16x32_bf16 v[88:91], v[44:47], a[24:27], v[88:91]
s_setprio 1
ds_read_b128 v[32:35], v1 offset:8192
v_mfma_f32_16x16x32_bf16 v[92:95], v[44:47], a[28:31], v[92:95]
s_setprio 0
s_waitcnt lgkmcnt(4)
v_mfma_f32_16x16x32_bf16 v[48:51], v[16:19], a[32:35], v[48:51]
s_setprio 1
ds_read_b128 v[36:39], v1 offset:10240
v_mfma_f32_16x16x32_bf16 v[52:55], v[16:19], a[36:39], v[52:55]
s_setprio 0
s_waitcnt lgkmcnt(4)
v_mfma_f32_16x16x32_bf16 v[56:59], v[20:23], a[32:35], v[56:59]
s_setprio 1
ds_read_b128 v[40:43], v1 offset:1024
v_mfma_f32_16x16x32_bf16 v[60:63], v[20:23], a[36:39], v[60:63]
s_setprio 0
s_waitcnt lgkmcnt(4)
v_mfma_f32_16x16x32_bf16 v[64:67], v[24:27], a[32:35], v[64:67]
s_setprio 1
ds_read_b128 v[44:47], v1 offset:3072
v_mfma_f32_16x16x32_bf16 v[68:71], v[24:27], a[36:39], v[68:71]
s_setprio 0
s_waitcnt lgkmcnt(4)
v_mfma_f32_16x16x32_bf16 v[72:75], v[28:31], a[32:35], v[72:75]
s_setprio 1
ds_read_b128 v[16:19], v1 offset:5120
v_mfma_f32_16x16x32_bf16 v[76:79], v[28:31], a[36:39], v[76:79]
s_setprio 0
s_waitcnt lgkmcnt(4)
v_mfma_f32_16x16x32_bf16 v[80:83], v[32:35], a[32:35], v[80:83]
s_setprio 1
ds_read_b128 v[20:23], v1 offset:7168
v_mfma_f32_16x16x32_bf16 v[84:87], v[32:35], a[36:39], v[84:87]
s_setprio 0
s_waitcnt lgkmcnt(4)
v_mfma_f32_16x16x32_bf16 v[88:91], v[36:39], a[32:35], v[88:91]
s_setprio 1
ds_read_b128 v[24:27], v1 offset:9216
v_mfma_f32_16x16x32_bf16 v[92:95], v[36:39], a[36:39], v[92:95]
s_setprio 0
s_waitcnt vmcnt(3)
s_barrier
s_waitcnt lgkmcnt(4)
v_mfma_f32_16x16x32_bf16 v[48:51], v[40:43], a[40:43], v[48:51]
s_setprio 1
ds_read_b128 v[28:31], v1 offset:11264
v_mfma_f32_16x16x32_bf16 v[52:55], v[40:43], a[44:47], v[52:55]
s_setprio 0
s_waitcnt lgkmcnt(4)
v_mfma_f32_16x16x32_bf16 v[56:59], v[44:47], a[40:43], v[56:59]
s_setprio 1
v_add_u32 v1, 0x18000, v1
ds_read_b128 v[32:35], v1 offset:0
v_mfma_f32_16x16x32_bf16 v[60:63], v[44:47], a[44:47], v[60:63]
s_setprio 0
s_add_u32 s53, s53, 688128
s_add_u32 m0, s51, 0x1e000
s_nop 0
buffer_load_dwordx4 v3, s[32:35], s53 offen offset:0 lds
buffer_load_dwordx4 v3, s[32:35], s53 offen offset:1024 lds
buffer_load_dwordx4 v3, s[32:35], s53 offen offset:2048 lds
s_waitcnt lgkmcnt(4)
v_mfma_f32_16x16x32_bf16 v[64:67], v[16:19], a[40:43], v[64:67]
s_setprio 1
ds_read_b128 v[36:39], v1 offset:2048
v_mfma_f32_16x16x32_bf16 v[68:71], v[16:19], a[44:47], v[68:71]
s_setprio 0
s_waitcnt lgkmcnt(4)
v_mfma_f32_16x16x32_bf16 v[72:75], v[20:23], a[40:43], v[72:75]
s_setprio 1
ds_read_b128 v[40:43], v1 offset:4096
v_mfma_f32_16x16x32_bf16 v[76:79], v[20:23], a[44:47], v[76:79]
s_setprio 0
s_waitcnt lgkmcnt(4)
v_mfma_f32_16x16x32_bf16 v[80:83], v[24:27], a[40:43], v[80:83]
s_setprio 1
ds_read_b128 v[44:47], v1 offset:6144
v_mfma_f32_16x16x32_bf16 v[84:87], v[24:27], a[44:47], v[84:87]
s_setprio 0
s_waitcnt lgkmcnt(4)
v_mfma_f32_16x16x32_bf16 v[88:91], v[28:31], a[40:43], v[88:91]
s_setprio 1
ds_read_b128 v[16:19], v1 offset:8192
v_mfma_f32_16x16x32_bf16 v[92:95], v[28:31], a[44:47], v[92:95]
s_setprio 0
s_waitcnt lgkmcnt(4)
v_mfma_f32_16x16x32_bf16 v[48:51], v[32:35], a[48:51], v[48:51]
s_setprio 1
ds_read_b128 v[20:23], v1 offset:10240
v_mfma_f32_16x16x32_bf16 v[52:55], v[32:35], a[52:55], v[52:55]
s_setprio 0
s_waitcnt lgkmcnt(4)
v_mfma_f32_16x16x32_bf16 v[56:59], v[36:39], a[48:51], v[56:59]
s_setprio 1
ds_read_b128 v[24:27], v1 offset:1024
v_mfma_f32_16x16x32_bf16 v[60:63], v[36:39], a[52:55], v[60:63]
s_setprio 0
s_waitcnt lgkmcnt(4)
v_mfma_f32_16x16x32_bf16 v[64:67], v[40:43], a[48:51], v[64:67]
s_setprio 1
ds_read_b128 v[28:31], v1 offset:3072
v_mfma_f32_16x16x32_bf16 v[68:71], v[40:43], a[52:55], v[68:71]
s_setprio 0
s_waitcnt lgkmcnt(4)
v_mfma_f32_16x16x32_bf16 v[72:75], v[44:47], a[48:51], v[72:75]
s_setprio 1
ds_read_b128 v[32:35], v1 offset:5120
v_mfma_f32_16x16x32_bf16 v[76:79], v[44:47], a[52:55], v[76:79]
s_setprio 0
s_waitcnt lgkmcnt(4)
v_mfma_f32_16x16x32_bf16 v[80:83], v[16:19], a[48:51], v[80:83]
s_setprio 1
ds_read_b128 v[36:39], v1 offset:7168
v_mfma_f32_16x16x32_bf16 v[84:87], v[16:19], a[52:55], v[84:87]
s_setprio 0
s_waitcnt lgkmcnt(4)
v_mfma_f32_16x16x32_bf16 v[88:91], v[20:23], a[48:51], v[88:91]
s_setprio 1
ds_read_b128 v[40:43], v1 offset:9216
v_mfma_f32_16x16x32_bf16 v[92:95], v[20:23], a[52:55], v[92:95]
s_setprio 0
s_waitcnt vmcnt(3)
s_barrier
s_waitcnt lgkmcnt(4)
v_mfma_f32_16x16x32_bf16 v[48:51], v[24:27], a[56:59], v[48:51]
s_setprio 1
ds_read_b128 v[44:47], v1 offset:11264
v_mfma_f32_16x16x32_bf16 v[52:55], v[24:27], a[60:63], v[52:55]
s_setprio 0
s_waitcnt lgkmcnt(4)
v_mfma_f32_16x16x32_bf16 v[56:59], v[28:31], a[56:59], v[56:59]
s_setprio 1
v_add_u32 v1, 0xffffa000, v1
ds_read_b128 v[16:19], v1 offset:0
v_mfma_f32_16x16x32_bf16 v[60:63], v[28:31], a[60:63], v[60:63]
s_setprio 0
s_add_u32 s53, s53, 688128
s_add_u32 m0, s51, 0x0
s_nop 0
buffer_load_dwordx4 v3, s[32:35], s53 offen offset:0 lds
buffer_load_dwordx4 v3, s[32:35], s53 offen offset:1024 lds
buffer_load_dwordx4 v3, s[32:35], s53 offen offset:2048 lds
s_waitcnt lgkmcnt(4)
v_mfma_f32_16x16x32_bf16 v[64:67], v[32:35], a[56:59], v[64:67]
s_setprio 1
ds_read_b128 v[20:23], v1 offset:2048
v_mfma_f32_16x16x32_bf16 v[68:71], v[32:35], a[60:63], v[68:71]
s_setprio 0
s_waitcnt lgkmcnt(4)
v_mfma_f32_16x16x32_bf16 v[72:75], v[36:39], a[56:59], v[72:75]
s_setprio 1
ds_read_b128 v[24:27], v1 offset:4096
v_mfma_f32_16x16x32_bf16 v[76:79], v[36:39], a[60:63], v[76:79]
s_setprio 0
s_waitcnt lgkmcnt(4)
v_mfma_f32_16x16x32_bf16 v[80:83], v[40:43], a[56:59], v[80:83]
s_setprio 1
ds_read_b128 v[28:31], v1 offset:6144
v_mfma_f32_16x16x32_bf16 v[84:87], v[40:43], a[60:63], v[84:87]
s_setprio 0
s_waitcnt lgkmcnt(4)
v_mfma_f32_16x16x32_bf16 v[88:91], v[44:47], a[56:59], v[88:91]
s_setprio 1
ds_read_b128 v[32:35], v1 offset:8192
v_mfma_f32_16x16x32_bf16 v[92:95], v[44:47], a[60:63], v[92:95]
s_setprio 0
s_waitcnt lgkmcnt(4)
v_mfma_f32_16x16x32_bf16 v[48:51], v[16:19], a[64:67], v[48:51]
s_setprio 1
ds_read_b128 v[36:39], v1 offset:10240
v_mfma_f32_16x16x32_bf16 v[52:55], v[16:19], a[68:71], v[52:55]
s_setprio 0
s_waitcnt lgkmcnt(4)
v_mfma_f32_16x16x32_bf16 v[56:59], v[20:23], a[64:67], v[56:59]
s_setprio 1
ds_read_b128 v[40:43], v1 offset:1024
v_mfma_f32_16x16x32_bf16 v[60:63], v[20:23], a[68:71], v[60:63]
s_setprio 0
s_waitcnt lgkmcnt(4)
v_mfma_f32_16x16x32_bf16 v[64:67], v[24:27], a[64:67], v[64:67]
s_setprio 1
ds_read_b128 v[44:47], v1 offset:3072
v_mfma_f32_16x16x32_bf16 v[68:71], v[24:27], a[68:71], v[68:71]
s_setprio 0
s_waitcnt lgkmcnt(4)
v_mfma_f32_16x16x32_bf16 v[72:75], v[28:31], a[64:67], v[72:75]
s_setprio 1
ds_read_b128 v[16:19], v1 offset:5120
v_mfma_f32_16x16x32_bf16 v[76:79], v[28:31], a[68:71], v[76:79]
s_setprio 0
s_waitcnt lgkmcnt(4)
v_mfma_f32_16x16x32_bf16 v[80:83], v[32:35], a[64:67], v[80:83]
s_setprio 1
ds_read_b128 v[20:23], v1 offset:7168
v_mfma_f32_16x16x32_bf16 v[84:87], v[32:35], a[68:71], v[84:87]
s_setprio 0
s_waitcnt lgkmcnt(4)
v_mfma_f32_16x16x32_bf16 v[88:91], v[36:39], a[64:67], v[88:91]
s_setprio 1
ds_read_b128 v[24:27], v1 offset:9216
v_mfma_f32_16x16x32_bf16 v[92:95], v[36:39], a[68:71], v[92:95]
s_setprio 0
s_waitcnt vmcnt(3)
s_barrier
s_waitcnt lgkmcnt(4)
v_mfma_f32_16x16x32_bf16 v[48:51], v[40:43], a[72:75], v[48:51]
s_setprio 1
ds_read_b128 v[28:31], v1 offset:11264
v_mfma_f32_16x16x32_bf16 v[52:55], v[40:43], a[76:79], v[52:55]
s_setprio 0
s_waitcnt lgkmcnt(4)
v_mfma_f32_16x16x32_bf16 v[56:59], v[44:47], a[72:75], v[56:59]
s_setprio 1
ds_read_b128 v[32:35], v1 offset:49152
v_mfma_f32_16x16x32_bf16 v[60:63], v[44:47], a[76:79], v[60:63]
s_setprio 0
s_add_u32 s53, s53, 688128
s_add_u32 m0, s51, 0x18000
s_nop 0
buffer_load_dwordx4 v3, s[32:35], s53 offen offset:0 lds
buffer_load_dwordx4 v3, s[32:35], s53 offen offset:1024 lds
buffer_load_dwordx4 v3, s[32:35], s53 offen offset:2048 lds
s_waitcnt lgkmcnt(4)
v_mfma_f32_16x16x32_bf16 v[64:67], v[16:19], a[72:75], v[64:67]
s_setprio 1
ds_read_b128 v[36:39], v1 offset:51200
v_mfma_f32_16x16x32_bf16 v[68:71], v[16:19], a[76:79], v[68:71]
s_setprio 0
s_waitcnt lgkmcnt(4)
v_mfma_f32_16x16x32_bf16 v[72:75], v[20:23], a[72:75], v[72:75]
s_setprio 1
ds_read_b128 v[40:43], v1 offset:53248
v_mfma_f32_16x16x32_bf16 v[76:79], v[20:23], a[76:79], v[76:79]
s_setprio 0
s_waitcnt lgkmcnt(4)
v_mfma_f32_16x16x32_bf16 v[80:83], v[24:27], a[72:75], v[80:83]
s_setprio 1
ds_read_b128 v[44:47], v1 offset:55296
v_mfma_f32_16x16x32_bf16 v[84:87], v[24:27], a[76:79], v[84:87]
s_setprio 0
s_waitcnt lgkmcnt(4)
v_mfma_f32_16x16x32_bf16 v[88:91], v[28:31], a[72:75], v[88:91]
s_setprio 1
ds_read_b128 v[16:19], v1 offset:57344
v_mfma_f32_16x16x32_bf16 v[92:95], v[28:31], a[76:79], v[92:95]
s_setprio 0
s_waitcnt lgkmcnt(4)
v_mfma_f32_16x16x32_bf16 v[48:51], v[32:35], a[80:83], v[48:51]
s_setprio 1
ds_read_b128 v[20:23], v1 offset:59392
v_mfma_f32_16x16x32_bf16 v[52:55], v[32:35], a[84:87], v[52:55]
s_setprio 0
s_waitcnt lgkmcnt(4)
v_mfma_f32_16x16x32_bf16 v[56:59], v[36:39], a[80:83], v[56:59]
s_setprio 1
ds_read_b128 v[24:27], v1 offset:50176
v_mfma_f32_16x16x32_bf16 v[60:63], v[36:39], a[84:87], v[60:63]
s_setprio 0
s_waitcnt lgkmcnt(4)
v_mfma_f32_16x16x32_bf16 v[64:67], v[40:43], a[80:83], v[64:67]
s_setprio 1
ds_read_b128 v[28:31], v1 offset:52224
v_mfma_f32_16x16x32_bf16 v[68:71], v[40:43], a[84:87], v[68:71]
s_setprio 0
s_waitcnt lgkmcnt(4)
v_mfma_f32_16x16x32_bf16 v[72:75], v[44:47], a[80:83], v[72:75]
s_setprio 1
ds_read_b128 v[32:35], v1 offset:54272
v_mfma_f32_16x16x32_bf16 v[76:79], v[44:47], a[84:87], v[76:79]
s_setprio 0
s_waitcnt lgkmcnt(4)
v_mfma_f32_16x16x32_bf16 v[80:83], v[16:19], a[80:83], v[80:83]
s_setprio 1
ds_read_b128 v[36:39], v1 offset:56320
v_mfma_f32_16x16x32_bf16 v[84:87], v[16:19], a[84:87], v[84:87]
s_setprio 0
s_waitcnt lgkmcnt(4)
v_mfma_f32_16x16x32_bf16 v[88:91], v[20:23], a[80:83], v[88:91]
s_setprio 1
ds_read_b128 v[40:43], v1 offset:58368
v_mfma_f32_16x16x32_bf16 v[92:95], v[20:23], a[84:87], v[92:95]
s_setprio 0
s_waitcnt vmcnt(3)
s_barrier
s_waitcnt lgkmcnt(4)
v_mfma_f32_16x16x32_bf16 v[48:51], v[24:27], a[88:91], v[48:51]
s_setprio 1
ds_read_b128 v[44:47], v1 offset:60416
v_mfma_f32_16x16x32_bf16 v[52:55], v[24:27], a[92:95], v[52:55]
s_setprio 0
s_waitcnt lgkmcnt(4)
v_mfma_f32_16x16x32_bf16 v[56:59], v[28:31], a[88:91], v[56:59]
s_setprio 1
v_add_u32 v1, 0xfffee000, v1
ds_read_b128 v[16:19], v1 offset:0
v_mfma_f32_16x16x32_bf16 v[60:63], v[28:31], a[92:95], v[60:63]
s_setprio 0
s_add_u32 s53, s53, 688128
s_add_u32 m0, s51, 0x12000
s_nop 0
buffer_load_dwordx4 v3, s[32:35], s53 offen offset:0 lds
buffer_load_dwordx4 v3, s[32:35], s53 offen offset:1024 lds
buffer_load_dwordx4 v3, s[32:35], s53 offen offset:2048 lds
s_waitcnt lgkmcnt(4)
v_mfma_f32_16x16x32_bf16 v[64:67], v[32:35], a[88:91], v[64:67]
s_setprio 1
ds_read_b128 v[20:23], v1 offset:2048
v_mfma_f32_16x16x32_bf16 v[68:71], v[32:35], a[92:95], v[68:71]
s_setprio 0
s_waitcnt lgkmcnt(4)
v_mfma_f32_16x16x32_bf16 v[72:75], v[36:39], a[88:91], v[72:75]
s_setprio 1
ds_read_b128 v[24:27], v1 offset:4096
v_mfma_f32_16x16x32_bf16 v[76:79], v[36:39], a[92:95], v[76:79]
s_setprio 0
s_waitcnt lgkmcnt(4)
v_mfma_f32_16x16x32_bf16 v[80:83], v[40:43], a[88:91], v[80:83]
s_setprio 1
ds_read_b128 v[28:31], v1 offset:6144
v_mfma_f32_16x16x32_bf16 v[84:87], v[40:43], a[92:95], v[84:87]
s_setprio 0
s_waitcnt lgkmcnt(4)
v_mfma_f32_16x16x32_bf16 v[88:91], v[44:47], a[88:91], v[88:91]
s_setprio 1
ds_read_b128 v[32:35], v1 offset:8192
v_mfma_f32_16x16x32_bf16 v[92:95], v[44:47], a[92:95], v[92:95]
s_setprio 0
s_waitcnt lgkmcnt(4)
v_mfma_f32_16x16x32_bf16 v[48:51], v[16:19], a[96:99], v[48:51]
s_setprio 1
ds_read_b128 v[36:39], v1 offset:10240
v_mfma_f32_16x16x32_bf16 v[52:55], v[16:19], a[100:103], v[52:55]
s_setprio 0
s_waitcnt lgkmcnt(4)
v_mfma_f32_16x16x32_bf16 v[56:59], v[20:23], a[96:99], v[56:59]
s_setprio 1
ds_read_b128 v[40:43], v1 offset:1024
v_mfma_f32_16x16x32_bf16 v[60:63], v[20:23], a[100:103], v[60:63]
s_setprio 0
s_waitcnt lgkmcnt(4)
v_mfma_f32_16x16x32_bf16 v[64:67], v[24:27], a[96:99], v[64:67]
s_setprio 1
ds_read_b128 v[44:47], v1 offset:3072
v_mfma_f32_16x16x32_bf16 v[68:71], v[24:27], a[100:103], v[68:71]
s_setprio 0
s_waitcnt lgkmcnt(4)
v_mfma_f32_16x16x32_bf16 v[72:75], v[28:31], a[96:99], v[72:75]
s_setprio 1
ds_read_b128 v[16:19], v1 offset:5120
v_mfma_f32_16x16x32_bf16 v[76:79], v[28:31], a[100:103], v[76:79]
s_setprio 0
s_waitcnt lgkmcnt(4)
v_mfma_f32_16x16x32_bf16 v[80:83], v[32:35], a[96:99], v[80:83]
s_setprio 1
ds_read_b128 v[20:23], v1 offset:7168
v_mfma_f32_16x16x32_bf16 v[84:87], v[32:35], a[100:103], v[84:87]
s_setprio 0
s_waitcnt lgkmcnt(4)
v_mfma_f32_16x16x32_bf16 v[88:91], v[36:39], a[96:99], v[88:91]
s_setprio 1
ds_read_b128 v[24:27], v1 offset:9216
v_mfma_f32_16x16x32_bf16 v[92:95], v[36:39], a[100:103], v[92:95]
s_setprio 0
s_waitcnt vmcnt(3)
s_barrier
s_waitcnt lgkmcnt(4)
v_mfma_f32_16x16x32_bf16 v[48:51], v[40:43], a[104:107], v[48:51]
s_setprio 1
ds_read_b128 v[28:31], v1 offset:11264
v_mfma_f32_16x16x32_bf16 v[52:55], v[40:43], a[108:111], v[52:55]
s_setprio 0
s_waitcnt lgkmcnt(4)
v_mfma_f32_16x16x32_bf16 v[56:59], v[44:47], a[104:107], v[56:59]
s_setprio 1
v_add_u32 v1, 0x18000, v1
ds_read_b128 v[32:35], v1 offset:0
v_mfma_f32_16x16x32_bf16 v[60:63], v[44:47], a[108:111], v[60:63]
s_setprio 0
s_add_u32 s53, s53, 688128
s_add_u32 m0, s51, 0x1e000
s_nop 0
buffer_load_dwordx4 v3, s[32:35], s53 offen offset:0 lds
buffer_load_dwordx4 v3, s[32:35], s53 offen offset:1024 lds
buffer_load_dwordx4 v3, s[32:35], s53 offen offset:2048 lds
s_waitcnt lgkmcnt(4)
v_mfma_f32_16x16x32_bf16 v[64:67], v[16:19], a[104:107], v[64:67]
s_setprio 1
ds_read_b128 v[36:39], v1 offset:2048
v_mfma_f32_16x16x32_bf16 v[68:71], v[16:19], a[108:111], v[68:71]
s_setprio 0
s_waitcnt lgkmcnt(4)
v_mfma_f32_16x16x32_bf16 v[72:75], v[20:23], a[104:107], v[72:75]
s_setprio 1
ds_read_b128 v[40:43], v1 offset:4096
v_mfma_f32_16x16x32_bf16 v[76:79], v[20:23], a[108:111], v[76:79]
s_setprio 0
s_waitcnt lgkmcnt(4)
v_mfma_f32_16x16x32_bf16 v[80:83], v[24:27], a[104:107], v[80:83]
s_setprio 1
ds_read_b128 v[44:47], v1 offset:6144
v_mfma_f32_16x16x32_bf16 v[84:87], v[24:27], a[108:111], v[84:87]
s_setprio 0
s_waitcnt lgkmcnt(4)
v_mfma_f32_16x16x32_bf16 v[88:91], v[28:31], a[104:107], v[88:91]
s_setprio 1
ds_read_b128 v[16:19], v1 offset:8192
v_mfma_f32_16x16x32_bf16 v[92:95], v[28:31], a[108:111], v[92:95]
s_setprio 0
s_waitcnt lgkmcnt(4)
v_mfma_f32_16x16x32_bf16 v[48:51], v[32:35], a[112:115], v[48:51]
s_setprio 1
ds_read_b128 v[20:23], v1 offset:10240
v_mfma_f32_16x16x32_bf16 v[52:55], v[32:35], a[116:119], v[52:55]
s_setprio 0
s_waitcnt lgkmcnt(4)
v_mfma_f32_16x16x32_bf16 v[56:59], v[36:39], a[112:115], v[56:59]
s_setprio 1
ds_read_b128 v[24:27], v1 offset:1024
v_mfma_f32_16x16x32_bf16 v[60:63], v[36:39], a[116:119], v[60:63]
s_setprio 0
s_waitcnt lgkmcnt(4)
v_mfma_f32_16x16x32_bf16 v[64:67], v[40:43], a[112:115], v[64:67]
s_setprio 1
ds_read_b128 v[28:31], v1 offset:3072
v_mfma_f32_16x16x32_bf16 v[68:71], v[40:43], a[116:119], v[68:71]
s_setprio 0
s_waitcnt lgkmcnt(4)
v_mfma_f32_16x16x32_bf16 v[72:75], v[44:47], a[112:115], v[72:75]
s_setprio 1
ds_read_b128 v[32:35], v1 offset:5120
v_mfma_f32_16x16x32_bf16 v[76:79], v[44:47], a[116:119], v[76:79]
s_setprio 0
s_waitcnt lgkmcnt(4)
v_mfma_f32_16x16x32_bf16 v[80:83], v[16:19], a[112:115], v[80:83]
s_setprio 1
ds_read_b128 v[36:39], v1 offset:7168
v_mfma_f32_16x16x32_bf16 v[84:87], v[16:19], a[116:119], v[84:87]
s_setprio 0
s_waitcnt lgkmcnt(4)
v_mfma_f32_16x16x32_bf16 v[88:91], v[20:23], a[112:115], v[88:91]
s_setprio 1
ds_read_b128 v[40:43], v1 offset:9216
v_mfma_f32_16x16x32_bf16 v[92:95], v[20:23], a[116:119], v[92:95]
s_setprio 0
s_waitcnt vmcnt(3)
s_barrier
s_waitcnt lgkmcnt(4)
v_mfma_f32_16x16x32_bf16 v[48:51], v[24:27], a[120:123], v[48:51]
s_setprio 1
ds_read_b128 v[44:47], v1 offset:11264
v_mfma_f32_16x16x32_bf16 v[52:55], v[24:27], a[124:127], v[52:55]
s_setprio 0
s_waitcnt lgkmcnt(4)
v_mfma_f32_16x16x32_bf16 v[56:59], v[28:31], a[120:123], v[56:59]
s_setprio 1
v_add_u32 v1, 0xffffa000, v1
ds_read_b128 v[16:19], v1 offset:0
v_mfma_f32_16x16x32_bf16 v[60:63], v[28:31], a[124:127], v[60:63]
s_setprio 0
s_waitcnt lgkmcnt(4)
v_mfma_f32_16x16x32_bf16 v[64:67], v[32:35], a[120:123], v[64:67]
s_setprio 1
ds_read_b128 v[20:23], v1 offset:2048
v_mfma_f32_16x16x32_bf16 v[68:71], v[32:35], a[124:127], v[68:71]
s_setprio 0
s_waitcnt lgkmcnt(4)
v_mfma_f32_16x16x32_bf16 v[72:75], v[36:39], a[120:123], v[72:75]
s_setprio 1
ds_read_b128 v[24:27], v1 offset:4096
v_mfma_f32_16x16x32_bf16 v[76:79], v[36:39], a[124:127], v[76:79]
s_setprio 0
s_waitcnt lgkmcnt(4)
v_mfma_f32_16x16x32_bf16 v[80:83], v[40:43], a[120:123], v[80:83]
s_setprio 1
ds_read_b128 v[28:31], v1 offset:6144
v_mfma_f32_16x16x32_bf16 v[84:87], v[40:43], a[124:127], v[84:87]
s_setprio 0
s_waitcnt lgkmcnt(4)
v_mfma_f32_16x16x32_bf16 v[88:91], v[44:47], a[120:123], v[88:91]
s_setprio 1
ds_read_b128 v[32:35], v1 offset:8192
v_mfma_f32_16x16x32_bf16 v[92:95], v[44:47], a[124:127], v[92:95]
s_setprio 0
s_waitcnt lgkmcnt(4)
v_mfma_f32_16x16x32_bf16 v[48:51], v[16:19], a[128:131], v[48:51]
s_setprio 1
ds_read_b128 v[36:39], v1 offset:10240
v_mfma_f32_16x16x32_bf16 v[52:55], v[16:19], a[132:135], v[52:55]
s_setprio 0
s_waitcnt lgkmcnt(4)
v_mfma_f32_16x16x32_bf16 v[56:59], v[20:23], a[128:131], v[56:59]
s_setprio 1
ds_read_b128 v[40:43], v1 offset:1024
v_mfma_f32_16x16x32_bf16 v[60:63], v[20:23], a[132:135], v[60:63]
s_setprio 0
s_waitcnt lgkmcnt(4)
v_mfma_f32_16x16x32_bf16 v[64:67], v[24:27], a[128:131], v[64:67]
s_setprio 1
ds_read_b128 v[44:47], v1 offset:3072
v_mfma_f32_16x16x32_bf16 v[68:71], v[24:27], a[132:135], v[68:71]
s_setprio 0
s_waitcnt lgkmcnt(4)
v_mfma_f32_16x16x32_bf16 v[72:75], v[28:31], a[128:131], v[72:75]
s_setprio 1
ds_read_b128 v[16:19], v1 offset:5120
v_mfma_f32_16x16x32_bf16 v[76:79], v[28:31], a[132:135], v[76:79]
s_setprio 0
s_waitcnt lgkmcnt(4)
v_mfma_f32_16x16x32_bf16 v[80:83], v[32:35], a[128:131], v[80:83]
s_setprio 1
ds_read_b128 v[20:23], v1 offset:7168
v_mfma_f32_16x16x32_bf16 v[84:87], v[32:35], a[132:135], v[84:87]
s_setprio 0
s_waitcnt lgkmcnt(4)
v_mfma_f32_16x16x32_bf16 v[88:91], v[36:39], a[128:131], v[88:91]
s_setprio 1
ds_read_b128 v[24:27], v1 offset:9216
v_mfma_f32_16x16x32_bf16 v[92:95], v[36:39], a[132:135], v[92:95]
s_setprio 0
s_waitcnt vmcnt(0)
s_barrier
s_waitcnt lgkmcnt(4)
v_mfma_f32_16x16x32_bf16 v[48:51], v[40:43], a[136:139], v[48:51]
s_setprio 1
ds_read_b128 v[28:31], v1 offset:11264
v_mfma_f32_16x16x32_bf16 v[52:55], v[40:43], a[140:143], v[52:55]
s_setprio 0
s_waitcnt lgkmcnt(4)
v_mfma_f32_16x16x32_bf16 v[56:59], v[44:47], a[136:139], v[56:59]
s_setprio 1
ds_read_b128 v[32:35], v1 offset:49152
v_mfma_f32_16x16x32_bf16 v[60:63], v[44:47], a[140:143], v[60:63]
s_setprio 0
s_waitcnt lgkmcnt(4)
v_mfma_f32_16x16x32_bf16 v[64:67], v[16:19], a[136:139], v[64:67]
s_setprio 1
ds_read_b128 v[36:39], v1 offset:51200
v_mfma_f32_16x16x32_bf16 v[68:71], v[16:19], a[140:143], v[68:71]
s_setprio 0
s_waitcnt lgkmcnt(4)
v_mfma_f32_16x16x32_bf16 v[72:75], v[20:23], a[136:139], v[72:75]
s_setprio 1
ds_read_b128 v[40:43], v1 offset:53248
v_mfma_f32_16x16x32_bf16 v[76:79], v[20:23], a[140:143], v[76:79]
s_setprio 0
s_waitcnt lgkmcnt(4)
v_mfma_f32_16x16x32_bf16 v[80:83], v[24:27], a[136:139], v[80:83]
s_setprio 1
ds_read_b128 v[44:47], v1 offset:55296
v_mfma_f32_16x16x32_bf16 v[84:87], v[24:27], a[140:143], v[84:87]
s_setprio 0
s_waitcnt lgkmcnt(4)
v_mfma_f32_16x16x32_bf16 v[88:91], v[28:31], a[136:139], v[88:91]
s_setprio 1
ds_read_b128 v[16:19], v1 offset:57344
v_mfma_f32_16x16x32_bf16 v[92:95], v[28:31], a[140:143], v[92:95]
s_setprio 0
s_waitcnt lgkmcnt(4)
v_mfma_f32_16x16x32_bf16 v[48:51], v[32:35], a[144:147], v[48:51]
s_setprio 1
ds_read_b128 v[20:23], v1 offset:59392
v_mfma_f32_16x16x32_bf16 v[52:55], v[32:35], a[148:151], v[52:55]
s_setprio 0
s_waitcnt lgkmcnt(4)
v_mfma_f32_16x16x32_bf16 v[56:59], v[36:39], a[144:147], v[56:59]
s_setprio 1
ds_read_b128 v[24:27], v1 offset:50176
v_mfma_f32_16x16x32_bf16 v[60:63], v[36:39], a[148:151], v[60:63]
s_setprio 0
s_waitcnt lgkmcnt(4)
v_mfma_f32_16x16x32_bf16 v[64:67], v[40:43], a[144:147], v[64:67]
s_setprio 1
ds_read_b128 v[28:31], v1 offset:52224
v_mfma_f32_16x16x32_bf16 v[68:71], v[40:43], a[148:151], v[68:71]
s_setprio 0
s_waitcnt lgkmcnt(4)
v_mfma_f32_16x16x32_bf16 v[72:75], v[44:47], a[144:147], v[72:75]
s_setprio 1
ds_read_b128 v[32:35], v1 offset:54272
v_mfma_f32_16x16x32_bf16 v[76:79], v[44:47], a[148:151], v[76:79]
s_setprio 0
s_waitcnt lgkmcnt(4)
v_mfma_f32_16x16x32_bf16 v[80:83], v[16:19], a[144:147], v[80:83]
s_setprio 1
ds_read_b128 v[36:39], v1 offset:56320
v_mfma_f32_16x16x32_bf16 v[84:87], v[16:19], a[148:151], v[84:87]
s_setprio 0
s_waitcnt lgkmcnt(4)
v_mfma_f32_16x16x32_bf16 v[88:91], v[20:23], a[144:147], v[88:91]
s_setprio 1
ds_read_b128 v[40:43], v1 offset:58368
v_mfma_f32_16x16x32_bf16 v[92:95], v[20:23], a[148:151], v[92:95]
s_setprio 0
s_waitcnt lgkmcnt(4)
v_mfma_f32_16x16x32_bf16 v[48:51], v[24:27], a[152:155], v[48:51]
s_setprio 1
ds_read_b128 v[44:47], v1 offset:60416
v_mfma_f32_16x16x32_bf16 v[52:55], v[24:27], a[156:159], v[52:55]
s_setprio 0
s_waitcnt lgkmcnt(4)
v_mfma_f32_16x16x32_bf16 v[56:59], v[28:31], a[152:155], v[56:59]
s_setprio 1
v_mfma_f32_16x16x32_bf16 v[60:63], v[28:31], a[156:159], v[60:63]
s_setprio 0
s_waitcnt lgkmcnt(3)
v_mfma_f32_16x16x32_bf16 v[64:67], v[32:35], a[152:155], v[64:67]
s_setprio 1
v_mfma_f32_16x16x32_bf16 v[68:71], v[32:35], a[156:159], v[68:71]
s_setprio 0
s_waitcnt lgkmcnt(2)
v_mfma_f32_16x16x32_bf16 v[72:75], v[36:39], a[152:155], v[72:75]
s_setprio 1
v_mfma_f32_16x16x32_bf16 v[76:79], v[36:39], a[156:159], v[76:79]
s_setprio 0
s_waitcnt lgkmcnt(1)
v_mfma_f32_16x16x32_bf16 v[80:83], v[40:43], a[152:155], v[80:83]
s_setprio 1
v_mfma_f32_16x16x32_bf16 v[84:87], v[40:43], a[156:159], v[84:87]
s_setprio 0
s_waitcnt lgkmcnt(0)
v_mfma_f32_16x16x32_bf16 v[88:91], v[44:47], a[152:155], v[88:91]
s_setprio 1
v_mfma_f32_16x16x32_bf16 v[92:95], v[44:47], a[156:159], v[92:95]
s_setprio 0
s_nop 5
s_lshl_b32 s60, s56, 10
s_add_u32 s60, s60, s54
s_add_u32 s60, s60, 40960
v_pk_mul_f32 v[48:49], v[48:49], s[82:83]
v_pk_mul_f32 v[50:51], v[50:51], s[82:83]
v_exp_f32 v48, v48
v_exp_f32 v49, v49
v_exp_f32 v50, v50
v_exp_f32 v51, v51
s_nop 0
v_pk_add_f32 v[48:49], v[48:49], s[84:85]
v_pk_add_f32 v[50:51], v[50:51], s[84:85]
v_rcp_f32 v48, v48
v_rcp_f32 v49, v49
v_rcp_f32 v50, v50
v_rcp_f32 v51, v51
s_nop 0
v_pk_mul_f32 v[56:57], v[56:57], v[48:49]
v_pk_mul_f32 v[58:59], v[58:59], v[50:51]
v_pk_mul_f32 v[52:53], v[52:53], s[82:83]
v_pk_mul_f32 v[54:55], v[54:55], s[82:83]
v_exp_f32 v52, v52
v_exp_f32 v53, v53
v_exp_f32 v54, v54
v_exp_f32 v55, v55
s_nop 0
v_pk_add_f32 v[52:53], v[52:53], s[84:85]
v_pk_add_f32 v[54:55], v[54:55], s[84:85]
v_rcp_f32 v52, v52
v_rcp_f32 v53, v53
v_rcp_f32 v54, v54
v_rcp_f32 v55, v55
s_nop 0
v_pk_mul_f32 v[60:61], v[60:61], v[52:53]
v_pk_mul_f32 v[62:63], v[62:63], v[54:55]
v_cvt_pk_bf16_f32 v20, v56, v57
v_cvt_pk_bf16_f32 v21, v58, v59
v_cvt_pk_bf16_f32 v22, v60, v61
v_cvt_pk_bf16_f32 v23, v62, v63
s_nop 1
v_permlane16_swap_b32 v20, v22
v_permlane16_swap_b32 v21, v23
s_nop 0
buffer_store_dwordx4 v[20:23], v3, s[36:39], s60 offen offset:0 sc1
v_pk_mul_f32 v[64:65], v[64:65], s[82:83]
v_pk_mul_f32 v[66:67], v[66:67], s[82:83]
v_exp_f32 v64, v64
v_exp_f32 v65, v65
v_exp_f32 v66, v66
v_exp_f32 v67, v67
s_nop 0
v_pk_add_f32 v[64:65], v[64:65], s[84:85]
v_pk_add_f32 v[66:67], v[66:67], s[84:85]
v_rcp_f32 v64, v64
v_rcp_f32 v65, v65
v_rcp_f32 v66, v66
v_rcp_f32 v67, v67
s_nop 0
v_pk_mul_f32 v[72:73], v[72:73], v[64:65]
v_pk_mul_f32 v[74:75], v[74:75], v[66:67]
v_pk_mul_f32 v[68:69], v[68:69], s[82:83]
v_pk_mul_f32 v[70:71], v[70:71], s[82:83]
v_exp_f32 v68, v68
v_exp_f32 v69, v69
v_exp_f32 v70, v70
v_exp_f32 v71, v71
s_nop 0
v_pk_add_f32 v[68:69], v[68:69], s[84:85]
v_pk_add_f32 v[70:71], v[70:71], s[84:85]
v_rcp_f32 v68, v68
v_rcp_f32 v69, v69
v_rcp_f32 v70, v70
v_rcp_f32 v71, v71
s_nop 0
v_pk_mul_f32 v[76:77], v[76:77], v[68:69]
v_pk_mul_f32 v[78:79], v[78:79], v[70:71]
v_cvt_pk_bf16_f32 v24, v72, v73
v_cvt_pk_bf16_f32 v25, v74, v75
v_cvt_pk_bf16_f32 v26, v76, v77
v_cvt_pk_bf16_f32 v27, v78, v79
s_nop 1
v_permlane16_swap_b32 v24, v26
v_permlane16_swap_b32 v25, v27
s_nop 0
buffer_store_dwordx4 v[24:27], v3, s[36:39], s60 offen offset:1024 sc1
v_pk_mul_f32 v[80:81], v[80:81], s[82:83]
v_pk_mul_f32 v[82:83], v[82:83], s[82:83]
v_exp_f32 v80, v80
v_exp_f32 v81, v81
v_exp_f32 v82, v82
v_exp_f32 v83, v83
s_nop 0
v_pk_add_f32 v[80:81], v[80:81], s[84:85]
v_pk_add_f32 v[82:83], v[82:83], s[84:85]
v_rcp_f32 v80, v80
v_rcp_f32 v81, v81
v_rcp_f32 v82, v82
v_rcp_f32 v83, v83
s_nop 0
v_pk_mul_f32 v[88:89], v[88:89], v[80:81]
v_pk_mul_f32 v[90:91], v[90:91], v[82:83]
v_pk_mul_f32 v[84:85], v[84:85], s[82:83]
v_pk_mul_f32 v[86:87], v[86:87], s[82:83]
v_exp_f32 v84, v84
v_exp_f32 v85, v85
v_exp_f32 v86, v86
v_exp_f32 v87, v87
s_nop 0
v_pk_add_f32 v[84:85], v[84:85], s[84:85]
v_pk_add_f32 v[86:87], v[86:87], s[84:85]
v_rcp_f32 v84, v84
v_rcp_f32 v85, v85
v_rcp_f32 v86, v86
v_rcp_f32 v87, v87
s_nop 0
v_pk_mul_f32 v[92:93], v[92:93], v[84:85]
v_pk_mul_f32 v[94:95], v[94:95], v[86:87]
v_cvt_pk_bf16_f32 v20, v88, v89
v_cvt_pk_bf16_f32 v21, v90, v91
v_cvt_pk_bf16_f32 v22, v92, v93
v_cvt_pk_bf16_f32 v23, v94, v95
s_nop 1
v_permlane16_swap_b32 v20, v22
v_permlane16_swap_b32 v21, v23
s_nop 0
buffer_store_dwordx4 v[20:23], v3, s[36:39], s60 offen offset:2048 sc1
s_branch k1_kernel_end
k1_kernel_B1:
s_sub_u32 s60, s7, 8
s_mul_i32 s60, s60, 21
s_lshr_b32 s60, s60, 1
s_add_u32 s60, s60, 24
s_add_u32 s55, s60, 3
s_add_u32 s56, s60, 8
s_lshl_b32 s62, s55, 1
s_add_u32 s62, s62, 120
s_lshl_b32 s63, s56, 1
s_add_u32 s63, s63, 120
s_mul_i32 s64, s4, 2
s_min_u32 s64, s64, 6
s_lshl_b32 s50, s64, 10
s_lshl_b32 s52, s62, 11
s_add_u32 s52, s52, s50
s_sub_u32 s52, s52, 688128
s_mul_i32 s64, s4, 3
s_min_u32 s64, s64, 9
s_lshl_b32 s51, s64, 10
s_lshl_b32 s53, s63, 11
s_add_u32 s53, s53, s51
s_sub_u32 s53, s53, 688128
s_waitcnt lgkmcnt(0)
s_add_u32 s28, s26, 0x1000000
s_addc_u32 s29, s27, 0
s_mov_b32 s30, 0x280000
s_mov_b32 s31, 0x20000
s_add_u32 s32, s26, 0x2000000
s_addc_u32 s33, s27, 0
s_mov_b32 s34, 0x690000
s_mov_b32 s35, 0x20000
s_add_u32 s49, s49, 4096
s_add_u32 m0, s48, 0x5000
s_nop 0
buffer_load_dwordx4 v3, s[28:31], s49 offen offset:2048 lds
buffer_load_dwordx4 v3, s[28:31], s49 offen offset:3072 lds
s_add_u32 s52, s52, 688128
s_add_u32 m0, s50, 0x3000
s_nop 0
buffer_load_dwordx4 v3, s[32:35], s52 offen offset:0 lds
buffer_load_dwordx4 v3, s[32:35], s52 offen offset:1024 lds
s_add_u32 s49, s49, 4096
s_add_u32 m0, s48, 0xe000
s_nop 0
buffer_load_dwordx4 v3, s[28:31], s49 offen offset:2048 lds
buffer_load_dwordx4 v3, s[28:31], s49 offen offset:3072 lds
s_add_u32 s52, s52, 688128
s_add_u32 m0, s50, 0xc000
s_nop 0
buffer_load_dwordx4 v3, s[32:35], s52 offen offset:0 lds
buffer_load_dwordx4 v3, s[32:35], s52 offen offset:1024 lds
s_add_u32 s49, s49, 4096
s_add_u32 m0, s48, 0x17000
s_nop 0
buffer_load_dwordx4 v3, s[28:31], s49 offen offset:2048 lds
buffer_load_dwordx4 v3, s[28:31], s49 offen offset:3072 lds
s_add_u32 s52, s52, 688128
s_add_u32 m0, s50, 0x15000
s_nop 0
buffer_load_dwordx4 v3, s[32:35], s52 offen offset:0 lds
buffer_load_dwordx4 v3, s[32:35], s52 offen offset:1024 lds
s_mov_b32 s36, s26
s_mov_b32 s37, s27
s_mov_b32 s38, 0x940000
s_mov_b32 s39, 0x20000
s_add_u32 s40, s26, 0xe00000
s_addc_u32 s41, s27, 0
s_mov_b32 s42, 0xe000
s_mov_b32 s43, 0x20000
s_add_u32 s44, s26, 0x1400000
s_addc_u32 s45, s27, 0
s_mov_b32 s46, 0x100000
s_mov_b32 s47, 0x20000
v_add_u32 v1, 12288, v3
s_mov_b32 s80, 0x3fb8aa3b
s_mov_b32 s81, 0x3fb8aa3b
s_mov_b32 s82, 0xbfb8aa3b
s_mov_b32 s83, 0xbfb8aa3b
s_mov_b32 s84, 0x3f800000
s_mov_b32 s85, 0x3f800000
s_mov_b32 s86, 0x358637bd
s_mov_b32 s87, 0x358637bd
s_waitcnt vmcnt(8)
s_barrier
ds_read_b128 a[0:3], v2 offset:0
ds_read_b128 a[4:7], v2 offset:1024
ds_read_b128 a[8:11], v2 offset:2048
ds_read_b128 a[12:15], v2 offset:3072
ds_read_b128 v[16:19], v1 offset:0
ds_read_b128 v[20:23], v1 offset:2048
ds_read_b128 v[24:27], v1 offset:4096
ds_read_b128 v[28:31], v1 offset:6144
ds_read_b128 v[32:35], v1 offset:1024
s_waitcnt lgkmcnt(4)
v_mfma_f32_16x16x32_bf16 v[48:51], v[16:19], a[0:3], 0
s_setprio 1
ds_read_b128 v[36:39], v1 offset:3072
v_mfma_f32_16x16x32_bf16 v[52:55], v[16:19], a[4:7], 0
s_setprio 0
s_waitcnt lgkmcnt(4)
v_mfma_f32_16x16x32_bf16 v[56:59], v[20:23], a[0:3], 0
s_setprio 1
ds_read_b128 v[40:43], v1 offset:5120
v_mfma_f32_16x16x32_bf16 v[60:63], v[20:23], a[4:7], 0
s_setprio 0
s_waitcnt lgkmcnt(4)
v_mfma_f32_16x16x32_bf16 v[64:67], v[24:27], a[0:3], 0
s_setprio 1
ds_read_b128 v[44:47], v1 offset:7168
v_mfma_f32_16x16x32_bf16 v[68:71], v[24:27], a[4:7], 0
s_setprio 0
s_waitcnt lgkmcnt(4)
v_mfma_f32_16x16x32_bf16 v[72:75], v[28:31], a[0:3], 0
s_setprio 1
v_mfma_f32_16x16x32_bf16 v[76:79], v[28:31], a[4:7], 0
s_setprio 0
s_waitcnt vmcnt(4)
s_barrier
ds_read_b128 v[16:19], v1 offset:36864
s_waitcnt lgkmcnt(4)
v_mfma_f32_16x16x32_bf16 v[48:51], v[32:35], a[8:11], v[48:51]
s_setprio 1
ds_read_b128 v[20:23], v1 offset:38912
ds_read_b128 a[16:19], v2 offset:36864
ds_read_b128 a[20:23], v2 offset:37888
v_mfma_f32_16x16x32_bf16 v[52:55], v[32:35], a[12:15], v[52:55]
s_setprio 0
s_waitcnt lgkmcnt(6)
v_mfma_f32_16x16x32_bf16 v[56:59], v[36:39], a[8:11], v[56:59]
s_setprio 1
ds_read_b128 v[24:27], v1 offset:40960
ds_read_b128 a[24:27], v2 offset:38912
ds_read_b128 a[28:31], v2 offset:39936
v_mfma_f32_16x16x32_bf16 v[60:63], v[36:39], a[12:15], v[60:63]
s_setprio 0
s_add_u32 s49, s49, 4096
s_add_u32 m0, s48, 0x20000
s_nop 0
buffer_load_dwordx4 v3, s[28:31], s49 offen offset:2048 lds
buffer_load_dwordx4 v3, s[28:31], s49 offen offset:3072 lds
s_waitcnt lgkmcnt(8)
v_mfma_f32_16x16x32_bf16 v[64:67], v[40:43], a[8:11], v[64:67]
s_setprio 1
ds_read_b128 v[28:31], v1 offset:43008
v_mfma_f32_16x16x32_bf16 v[68:71], v[40:43], a[12:15], v[68:71]
s_setprio 0
s_waitcnt lgkmcnt(8)
v_mfma_f32_16x16x32_bf16 v[72:75], v[44:47], a[8:11], v[72:75]
s_setprio 1
ds_read_b128 v[32:35], v1 offset:37888
v_mfma_f32_16x16x32_bf16 v[76:79], v[44:47], a[12:15], v[76:79]
s_setprio 0
s_waitcnt lgkmcnt(8)
s_waitcnt lgkmcnt(6)
s_waitcnt lgkmcnt(5)
v_mfma_f32_16x16x32_bf16 v[48:51], v[16:19], a[16:19], v[48:51]
s_setprio 1
ds_read_b128 v[36:39], v1 offset:39936
v_mfma_f32_16x16x32_bf16 v[52:55], v[16:19], a[20:23], v[52:55]
s_setprio 0
v_mfma_f32_16x16x32_bf16 v[56:59], v[20:23], a[16:19], v[56:59]
s_setprio 1
ds_read_b128 v[40:43], v1 offset:41984
v_mfma_f32_16x16x32_bf16 v[60:63], v[20:23], a[20:23], v[60:63]
s_setprio 0
s_add_u32 s52, s52, 688128
s_add_u32 m0, s50, 0x1e000
s_nop 0
buffer_load_dwordx4 v3, s[32:35], s52 offen offset:0 lds
buffer_load_dwordx4 v3, s[32:35], s52 offen offset:1024 lds
s_waitcnt lgkmcnt(6)
v_mfma_f32_16x16x32_bf16 v[64:67], v[24:27], a[16:19], v[64:67]
s_setprio 1
ds_read_b128 v[44:47], v1 offset:44032
v_mfma_f32_16x16x32_bf16 v[68:71], v[24:27], a[20:23], v[68:71]
s_setprio 0
s_waitcnt lgkmcnt(4)
v_mfma_f32_16x16x32_bf16 v[72:75], v[28:31], a[16:19], v[72:75]
s_setprio 1
v_mfma_f32_16x16x32_bf16 v[76:79], v[28:31], a[20:23], v[76:79]
s_setprio 0
s_waitcnt vmcnt(4)
s_barrier
v_add_u32 v1, 0x12000, v1
ds_read_b128 v[16:19], v1 offset:0
s_waitcnt lgkmcnt(4)
v_mfma_f32_16x16x32_bf16 v[48:51], v[32:35], a[24:27], v[48:51]
s_setprio 1
ds_read_b128 v[20:23], v1 offset:2048
v_add_u32 v2, 0x12000, v2
ds_read_b128 a[32:35], v2 offset:0
ds_read_b128 a[36:39], v2 offset:1024
v_mfma_f32_16x16x32_bf16 v[52:55], v[32:35], a[28:31], v[52:55]
s_setprio 0
s_waitcnt lgkmcnt(6)
v_mfma_f32_16x16x32_bf16 v[56:59], v[36:39], a[24:27], v[56:59]
s_setprio 1
ds_read_b128 v[24:27], v1 offset:4096
ds_read_b128 a[40:43], v2 offset:2048
ds_read_b128 a[44:47], v2 offset:3072
v_mfma_f32_16x16x32_bf16 v[60:63], v[36:39], a[28:31], v[60:63]
s_setprio 0
s_add_u32 s49, s49, 4096
s_add_u32 m0, s48, 0x5000
s_nop 0
buffer_load_dwordx4 v3, s[28:31], s49 offen offset:2048 lds
buffer_load_dwordx4 v3, s[28:31], s49 offen offset:3072 lds
s_waitcnt lgkmcnt(8)
v_mfma_f32_16x16x32_bf16 v[64:67], v[40:43], a[24:27], v[64:67]
s_setprio 1
ds_read_b128 v[28:31], v1 offset:6144
v_mfma_f32_16x16x32_bf16 v[68:71], v[40:43], a[28:31], v[68:71]
s_setprio 0
s_waitcnt lgkmcnt(8)
v_mfma_f32_16x16x32_bf16 v[72:75], v[44:47], a[24:27], v[72:75]
s_setprio 1
ds_read_b128 v[32:35], v1 offset:1024
v_mfma_f32_16x16x32_bf16 v[76:79], v[44:47], a[28:31], v[76:79]
s_setprio 0
s_waitcnt lgkmcnt(8)
s_waitcnt lgkmcnt(6)
s_waitcnt lgkmcnt(5)
v_mfma_f32_16x16x32_bf16 v[48:51], v[16:19], a[32:35], v[48:51]
s_setprio 1
ds_read_b128 v[36:39], v1 offset:3072
v_mfma_f32_16x16x32_bf16 v[52:55], v[16:19], a[36:39], v[52:55]
s_setprio 0
v_mfma_f32_16x16x32_bf16 v[56:59], v[20:23], a[32:35], v[56:59]
s_setprio 1
ds_read_b128 v[40:43], v1 offset:5120
v_mfma_f32_16x16x32_bf16 v[60:63], v[20:23], a[36:39], v[60:63]
s_setprio 0
s_add_u32 s52, s52, 688128
s_add_u32 m0, s50, 0x3000
s_nop 0
buffer_load_dwordx4 v3, s[32:35], s52 offen offset:0 lds
buffer_load_dwordx4 v3, s[32:35], s52 offen offset:1024 lds
s_waitcnt lgkmcnt(6)
v_mfma_f32_16x16x32_bf16 v[64:67], v[24:27], a[32:35], v[64:67]
s_setprio 1
ds_read_b128 v[44:47], v1 offset:7168
v_mfma_f32_16x16x32_bf16 v[68:71], v[24:27], a[36:39], v[68:71]
s_setprio 0
s_waitcnt lgkmcnt(4)
v_mfma_f32_16x16x32_bf16 v[72:75], v[28:31], a[32:35], v[72:75]
s_setprio 1
v_mfma_f32_16x16x32_bf16 v[76:79], v[28:31], a[36:39], v[76:79]
s_setprio 0
s_waitcnt vmcnt(4)
s_barrier
ds_read_b128 v[16:19], v1 offset:36864
s_waitcnt lgkmcnt(4)
v_mfma_f32_16x16x32_bf16 v[48:51], v[32:35], a[40:43], v[48:51]
s_setprio 1
ds_read_b128 v[20:23], v1 offset:38912
ds_read_b128 a[48:51], v2 offset:36864
ds_read_b128 a[52:55], v2 offset:37888
v_mfma_f32_16x16x32_bf16 v[52:55], v[32:35], a[44:47], v[52:55]
s_setprio 0
s_waitcnt lgkmcnt(6)
v_mfma_f32_16x16x32_bf16 v[56:59], v[36:39], a[40:43], v[56:59]
s_setprio 1
ds_read_b128 v[24:27], v1 offset:40960
ds_read_b128 a[56:59], v2 offset:38912
ds_read_b128 a[60:63], v2 offset:39936
v_mfma_f32_16x16x32_bf16 v[60:63], v[36:39], a[44:47], v[60:63]
s_setprio 0
s_add_u32 s49, s49, 4096
s_add_u32 m0, s48, 0xe000
s_nop 0
buffer_load_dwordx4 v3, s[28:31], s49 offen offset:2048 lds
buffer_load_dwordx4 v3, s[28:31], s49 offen offset:3072 lds
s_waitcnt lgkmcnt(8)
v_mfma_f32_16x16x32_bf16 v[64:67], v[40:43], a[40:43], v[64:67]
s_setprio 1
ds_read_b128 v[28:31], v1 offset:43008
v_mfma_f32_16x16x32_bf16 v[68:71], v[40:43], a[44:47], v[68:71]
s_setprio 0
s_waitcnt lgkmcnt(8)
v_mfma_f32_16x16x32_bf16 v[72:75], v[44:47], a[40:43], v[72:75]
s_setprio 1
ds_read_b128 v[32:35], v1 offset:37888
v_mfma_f32_16x16x32_bf16 v[76:79], v[44:47], a[44:47], v[76:79]
s_setprio 0
s_waitcnt lgkmcnt(8)
s_waitcnt lgkmcnt(6)
s_waitcnt lgkmcnt(5)
v_mfma_f32_16x16x32_bf16 v[48:51], v[16:19], a[48:51], v[48:51]
s_setprio 1
ds_read_b128 v[36:39], v1 offset:39936
v_mfma_f32_16x16x32_bf16 v[52:55], v[16:19], a[52:55], v[52:55]
s_setprio 0
v_mfma_f32_16x16x32_bf16 v[56:59], v[20:23], a[48:51], v[56:59]
s_setprio 1
ds_read_b128 v[40:43], v1 offset:41984
v_mfma_f32_16x16x32_bf16 v[60:63], v[20:23], a[52:55], v[60:63]
s_setprio 0
s_add_u32 s52, s52, 688128
s_add_u32 m0, s50, 0xc000
s_nop 0
buffer_load_dwordx4 v3, s[32:35], s52 offen offset:0 lds
buffer_load_dwordx4 v3, s[32:35], s52 offen offset:1024 lds
s_waitcnt lgkmcnt(6)
v_mfma_f32_16x16x32_bf16 v[64:67], v[24:27], a[48:51], v[64:67]
s_setprio 1
ds_read_b128 v[44:47], v1 offset:44032
v_mfma_f32_16x16x32_bf16 v[68:71], v[24:27], a[52:55], v[68:71]
s_setprio 0
s_waitcnt lgkmcnt(4)
v_mfma_f32_16x16x32_bf16 v[72:75], v[28:31], a[48:51], v[72:75]
s_setprio 1
v_mfma_f32_16x16x32_bf16 v[76:79], v[28:31], a[52:55], v[76:79]
s_setprio 0
s_waitcnt vmcnt(4)
s_barrier
v_add_u32 v1, 0xfffee000, v1
ds_read_b128 v[16:19], v1 offset:0
s_waitcnt lgkmcnt(4)
v_mfma_f32_16x16x32_bf16 v[48:51], v[32:35], a[56:59], v[48:51]
s_setprio 1
ds_read_b128 v[20:23], v1 offset:2048
v_add_u32 v2, 0xfffee000, v2
ds_read_b128 a[64:67], v2 offset:0
ds_read_b128 a[68:71], v2 offset:1024
v_mfma_f32_16x16x32_bf16 v[52:55], v[32:35], a[60:63], v[52:55]
s_setprio 0
s_waitcnt lgkmcnt(6)
v_mfma_f32_16x16x32_bf16 v[56:59], v[36:39], a[56:59], v[56:59]
s_setprio 1
ds_read_b128 v[24:27], v1 offset:4096
ds_read_b128 a[72:75], v2 offset:2048
ds_read_b128 a[76:79], v2 offset:3072
v_mfma_f32_16x16x32_bf16 v[60:63], v[36:39], a[60:63], v[60:63]
s_setprio 0
s_add_u32 s49, s49, 4096
s_add_u32 m0, s48, 0x17000
s_nop 0
buffer_load_dwordx4 v3, s[28:31], s49 offen offset:2048 lds
buffer_load_dwordx4 v3, s[28:31], s49 offen offset:3072 lds
s_waitcnt lgkmcnt(8)
v_mfma_f32_16x16x32_bf16 v[64:67], v[40:43], a[56:59], v[64:67]
s_setprio 1
ds_read_b128 v[28:31], v1 offset:6144
v_mfma_f32_16x16x32_bf16 v[68:71], v[40:43], a[60:63], v[68:71]
s_setprio 0
s_waitcnt lgkmcnt(8)
v_mfma_f32_16x16x32_bf16 v[72:75], v[44:47], a[56:59], v[72:75]
s_setprio 1
ds_read_b128 v[32:35], v1 offset:1024
v_mfma_f32_16x16x32_bf16 v[76:79], v[44:47], a[60:63], v[76:79]
s_setprio 0
s_waitcnt lgkmcnt(8)
s_waitcnt lgkmcnt(6)
s_waitcnt lgkmcnt(5)
v_mfma_f32_16x16x32_bf16 v[48:51], v[16:19], a[64:67], v[48:51]
s_setprio 1
ds_read_b128 v[36:39], v1 offset:3072
v_mfma_f32_16x16x32_bf16 v[52:55], v[16:19], a[68:71], v[52:55]
s_setprio 0
v_mfma_f32_16x16x32_bf16 v[56:59], v[20:23], a[64:67], v[56:59]
s_setprio 1
ds_read_b128 v[40:43], v1 offset:5120
v_mfma_f32_16x16x32_bf16 v[60:63], v[20:23], a[68:71], v[60:63]
s_setprio 0
s_add_u32 s52, s52, 688128
s_add_u32 m0, s50, 0x15000
s_nop 0
buffer_load_dwordx4 v3, s[32:35], s52 offen offset:0 lds
buffer_load_dwordx4 v3, s[32:35], s52 offen offset:1024 lds
s_waitcnt lgkmcnt(6)
v_mfma_f32_16x16x32_bf16 v[64:67], v[24:27], a[64:67], v[64:67]
s_setprio 1
ds_read_b128 v[44:47], v1 offset:7168
v_mfma_f32_16x16x32_bf16 v[68:71], v[24:27], a[68:71], v[68:71]
s_setprio 0
s_waitcnt lgkmcnt(4)
v_mfma_f32_16x16x32_bf16 v[72:75], v[28:31], a[64:67], v[72:75]
s_setprio 1
v_mfma_f32_16x16x32_bf16 v[76:79], v[28:31], a[68:71], v[76:79]
s_setprio 0
s_waitcnt vmcnt(4)
s_barrier
ds_read_b128 v[16:19], v1 offset:36864
s_waitcnt lgkmcnt(4)
v_mfma_f32_16x16x32_bf16 v[48:51], v[32:35], a[72:75], v[48:51]
s_setprio 1
ds_read_b128 v[20:23], v1 offset:38912
ds_read_b128 a[80:83], v2 offset:36864
ds_read_b128 a[84:87], v2 offset:37888
v_mfma_f32_16x16x32_bf16 v[52:55], v[32:35], a[76:79], v[52:55]
s_setprio 0
s_waitcnt lgkmcnt(6)
v_mfma_f32_16x16x32_bf16 v[56:59], v[36:39], a[72:75], v[56:59]
s_setprio 1
ds_read_b128 v[24:27], v1 offset:40960
ds_read_b128 a[88:91], v2 offset:38912
ds_read_b128 a[92:95], v2 offset:39936
v_mfma_f32_16x16x32_bf16 v[60:63], v[36:39], a[76:79], v[60:63]
s_setprio 0
s_add_u32 s49, s49, 4096
s_add_u32 m0, s48, 0x20000
s_nop 0
buffer_load_dwordx4 v3, s[28:31], s49 offen offset:2048 lds
buffer_load_dwordx4 v3, s[28:31], s49 offen offset:3072 lds
s_waitcnt lgkmcnt(8)
v_mfma_f32_16x16x32_bf16 v[64:67], v[40:43], a[72:75], v[64:67]
s_setprio 1
ds_read_b128 v[28:31], v1 offset:43008
v_mfma_f32_16x16x32_bf16 v[68:71], v[40:43], a[76:79], v[68:71]
s_setprio 0
s_waitcnt lgkmcnt(8)
v_mfma_f32_16x16x32_bf16 v[72:75], v[44:47], a[72:75], v[72:75]
s_setprio 1
ds_read_b128 v[32:35], v1 offset:37888
v_mfma_f32_16x16x32_bf16 v[76:79], v[44:47], a[76:79], v[76:79]
s_setprio 0
s_waitcnt lgkmcnt(8)
s_waitcnt lgkmcnt(6)
s_waitcnt lgkmcnt(5)
v_mfma_f32_16x16x32_bf16 v[48:51], v[16:19], a[80:83], v[48:51]
s_setprio 1
ds_read_b128 v[36:39], v1 offset:39936
v_mfma_f32_16x16x32_bf16 v[52:55], v[16:19], a[84:87], v[52:55]
s_setprio 0
v_mfma_f32_16x16x32_bf16 v[56:59], v[20:23], a[80:83], v[56:59]
s_setprio 1
ds_read_b128 v[40:43], v1 offset:41984
v_mfma_f32_16x16x32_bf16 v[60:63], v[20:23], a[84:87], v[60:63]
s_setprio 0
s_add_u32 s52, s52, 688128
s_add_u32 m0, s50, 0x1e000
s_nop 0
buffer_load_dwordx4 v3, s[32:35], s52 offen offset:0 lds
buffer_load_dwordx4 v3, s[32:35], s52 offen offset:1024 lds
s_waitcnt lgkmcnt(6)
v_mfma_f32_16x16x32_bf16 v[64:67], v[24:27], a[80:83], v[64:67]
s_setprio 1
ds_read_b128 v[44:47], v1 offset:44032
v_mfma_f32_16x16x32_bf16 v[68:71], v[24:27], a[84:87], v[68:71]
s_setprio 0
s_waitcnt lgkmcnt(4)
v_mfma_f32_16x16x32_bf16 v[72:75], v[28:31], a[80:83], v[72:75]
s_setprio 1
v_mfma_f32_16x16x32_bf16 v[76:79], v[28:31], a[84:87], v[76:79]
s_setprio 0
s_waitcnt vmcnt(4)
s_barrier
v_add_u32 v1, 0x12000, v1
ds_read_b128 v[16:19], v1 offset:0
s_waitcnt lgkmcnt(4)
v_mfma_f32_16x16x32_bf16 v[48:51], v[32:35], a[88:91], v[48:51]
s_setprio 1
ds_read_b128 v[20:23], v1 offset:2048
v_add_u32 v2, 0x12000, v2
ds_read_b128 a[96:99], v2 offset:0
ds_read_b128 a[100:103], v2 offset:1024
v_mfma_f32_16x16x32_bf16 v[52:55], v[32:35], a[92:95], v[52:55]
s_setprio 0
s_waitcnt lgkmcnt(6)
v_mfma_f32_16x16x32_bf16 v[56:59], v[36:39], a[88:91], v[56:59]
s_setprio 1
ds_read_b128 v[24:27], v1 offset:4096
ds_read_b128 a[104:107], v2 offset:2048
ds_read_b128 a[108:111], v2 offset:3072
v_mfma_f32_16x16x32_bf16 v[60:63], v[36:39], a[92:95], v[60:63]
s_setprio 0
s_add_u32 s49, s49, 4096
s_add_u32 m0, s48, 0x5000
s_nop 0
buffer_load_dwordx4 v3, s[28:31], s49 offen offset:2048 lds
buffer_load_dwordx4 v3, s[28:31], s49 offen offset:3072 lds
s_waitcnt lgkmcnt(8)
v_mfma_f32_16x16x32_bf16 v[64:67], v[40:43], a[88:91], v[64:67]
s_setprio 1
ds_read_b128 v[28:31], v1 offset:6144
v_mfma_f32_16x16x32_bf16 v[68:71], v[40:43], a[92:95], v[68:71]
s_setprio 0
s_waitcnt lgkmcnt(8)
v_mfma_f32_16x16x32_bf16 v[72:75], v[44:47], a[88:91], v[72:75]
s_setprio 1
ds_read_b128 v[32:35], v1 offset:1024
v_mfma_f32_16x16x32_bf16 v[76:79], v[44:47], a[92:95], v[76:79]
s_setprio 0
s_waitcnt lgkmcnt(8)
s_waitcnt lgkmcnt(6)
s_waitcnt lgkmcnt(5)
v_mfma_f32_16x16x32_bf16 v[48:51], v[16:19], a[96:99], v[48:51]
s_setprio 1
ds_read_b128 v[36:39], v1 offset:3072
v_mfma_f32_16x16x32_bf16 v[52:55], v[16:19], a[100:103], v[52:55]
s_setprio 0
v_mfma_f32_16x16x32_bf16 v[56:59], v[20:23], a[96:99], v[56:59]
s_setprio 1
ds_read_b128 v[40:43], v1 offset:5120
v_mfma_f32_16x16x32_bf16 v[60:63], v[20:23], a[100:103], v[60:63]
s_setprio 0
s_add_u32 s52, s52, 688128
s_add_u32 m0, s50, 0x3000
s_nop 0
buffer_load_dwordx4 v3, s[32:35], s52 offen offset:0 lds
buffer_load_dwordx4 v3, s[32:35], s52 offen offset:1024 lds
s_waitcnt lgkmcnt(6)
v_mfma_f32_16x16x32_bf16 v[64:67], v[24:27], a[96:99], v[64:67]
s_setprio 1
ds_read_b128 v[44:47], v1 offset:7168
v_mfma_f32_16x16x32_bf16 v[68:71], v[24:27], a[100:103], v[68:71]
s_setprio 0
s_waitcnt lgkmcnt(4)
v_mfma_f32_16x16x32_bf16 v[72:75], v[28:31], a[96:99], v[72:75]
s_setprio 1
v_mfma_f32_16x16x32_bf16 v[76:79], v[28:31], a[100:103], v[76:79]
s_setprio 0
s_waitcnt vmcnt(4)
s_barrier
ds_read_b128 v[16:19], v1 offset:36864
s_waitcnt lgkmcnt(4)
v_mfma_f32_16x16x32_bf16 v[48:51], v[32:35], a[104:107], v[48:51]
s_setprio 1
ds_read_b128 v[20:23], v1 offset:38912
ds_read_b128 a[112:115], v2 offset:36864
ds_read_b128 a[116:119], v2 offset:37888
v_mfma_f32_16x16x32_bf16 v[52:55], v[32:35], a[108:111], v[52:55]
s_setprio 0
s_waitcnt lgkmcnt(6)
v_mfma_f32_16x16x32_bf16 v[56:59], v[36:39], a[104:107], v[56:59]
s_setprio 1
ds_read_b128 v[24:27], v1 offset:40960
ds_read_b128 a[120:123], v2 offset:38912
ds_read_b128 a[124:127], v2 offset:39936
v_mfma_f32_16x16x32_bf16 v[60:63], v[36:39], a[108:111], v[60:63]
s_setprio 0
s_add_u32 s49, s49, 4096
s_add_u32 m0, s48, 0xe000
s_nop 0
buffer_load_dwordx4 v3, s[28:31], s49 offen offset:2048 lds
buffer_load_dwordx4 v3, s[28:31], s49 offen offset:3072 lds
s_waitcnt lgkmcnt(8)
v_mfma_f32_16x16x32_bf16 v[64:67], v[40:43], a[104:107], v[64:67]
s_setprio 1
ds_read_b128 v[28:31], v1 offset:43008
v_mfma_f32_16x16x32_bf16 v[68:71], v[40:43], a[108:111], v[68:71]
s_setprio 0
s_waitcnt lgkmcnt(8)
v_mfma_f32_16x16x32_bf16 v[72:75], v[44:47], a[104:107], v[72:75]
s_setprio 1
ds_read_b128 v[32:35], v1 offset:37888
v_mfma_f32_16x16x32_bf16 v[76:79], v[44:47], a[108:111], v[76:79]
s_setprio 0
s_waitcnt lgkmcnt(8)
s_waitcnt lgkmcnt(6)
s_waitcnt lgkmcnt(5)
v_mfma_f32_16x16x32_bf16 v[48:51], v[16:19], a[112:115], v[48:51]
s_setprio 1
ds_read_b128 v[36:39], v1 offset:39936
v_mfma_f32_16x16x32_bf16 v[52:55], v[16:19], a[116:119], v[52:55]
s_setprio 0
v_mfma_f32_16x16x32_bf16 v[56:59], v[20:23], a[112:115], v[56:59]
s_setprio 1
ds_read_b128 v[40:43], v1 offset:41984
v_mfma_f32_16x16x32_bf16 v[60:63], v[20:23], a[116:119], v[60:63]
s_setprio 0
s_add_u32 s52, s52, 688128
s_add_u32 m0, s50, 0xc000
s_nop 0
buffer_load_dwordx4 v3, s[32:35], s52 offen offset:0 lds
buffer_load_dwordx4 v3, s[32:35], s52 offen offset:1024 lds
s_waitcnt lgkmcnt(6)
v_mfma_f32_16x16x32_bf16 v[64:67], v[24:27], a[112:115], v[64:67]
s_setprio 1
ds_read_b128 v[44:47], v1 offset:44032
v_mfma_f32_16x16x32_bf16 v[68:71], v[24:27], a[116:119], v[68:71]
s_setprio 0
s_waitcnt lgkmcnt(4)
v_mfma_f32_16x16x32_bf16 v[72:75], v[28:31], a[112:115], v[72:75]
s_setprio 1
v_mfma_f32_16x16x32_bf16 v[76:79], v[28:31], a[116:119], v[76:79]
s_setprio 0
s_waitcnt vmcnt(4)
s_barrier
v_add_u32 v1, 0xfffee000, v1
ds_read_b128 v[16:19], v1 offset:0
s_waitcnt lgkmcnt(4)
v_mfma_f32_16x16x32_bf16 v[48:51], v[32:35], a[120:123], v[48:51]
s_setprio 1
ds_read_b128 v[20:23], v1 offset:2048
v_add_u32 v2, 0xfffee000, v2
ds_read_b128 a[128:131], v2 offset:0
ds_read_b128 a[132:135], v2 offset:1024
v_mfma_f32_16x16x32_bf16 v[52:55], v[32:35], a[124:127], v[52:55]
s_setprio 0
s_waitcnt lgkmcnt(6)
v_mfma_f32_16x16x32_bf16 v[56:59], v[36:39], a[120:123], v[56:59]
s_setprio 1
ds_read_b128 v[24:27], v1 offset:4096
ds_read_b128 a[136:139], v2 offset:2048
ds_read_b128 a[140:143], v2 offset:3072
v_mfma_f32_16x16x32_bf16 v[60:63], v[36:39], a[124:127], v[60:63]
s_setprio 0
s_add_u32 s53, s53, 688128
s_add_u32 m0, s51, 0x15000
s_nop 0
buffer_load_dwordx4 v3, s[32:35], s53 offen offset:0 lds
buffer_load_dwordx4 v3, s[32:35], s53 offen offset:1024 lds
buffer_load_dwordx4 v3, s[32:35], s53 offen offset:2048 lds
s_waitcnt lgkmcnt(8)
v_mfma_f32_16x16x32_bf16 v[64:67], v[40:43], a[120:123], v[64:67]
s_setprio 1
ds_read_b128 v[28:31], v1 offset:6144
v_mfma_f32_16x16x32_bf16 v[68:71], v[40:43], a[124:127], v[68:71]
s_setprio 0
s_waitcnt lgkmcnt(8)
v_mfma_f32_16x16x32_bf16 v[72:75], v[44:47], a[120:123], v[72:75]
s_setprio 1
ds_read_b128 v[32:35], v1 offset:1024
v_mfma_f32_16x16x32_bf16 v[76:79], v[44:47], a[124:127], v[76:79]
s_setprio 0
s_waitcnt lgkmcnt(8)
s_waitcnt lgkmcnt(6)
s_waitcnt lgkmcnt(5)
v_mfma_f32_16x16x32_bf16 v[48:51], v[16:19], a[128:131], v[48:51]
s_setprio 1
ds_read_b128 v[36:39], v1 offset:3072
v_mfma_f32_16x16x32_bf16 v[52:55], v[16:19], a[132:135], v[52:55]
s_setprio 0
v_mfma_f32_16x16x32_bf16 v[56:59], v[20:23], a[128:131], v[56:59]
s_setprio 1
ds_read_b128 v[40:43], v1 offset:5120
v_mfma_f32_16x16x32_bf16 v[60:63], v[20:23], a[132:135], v[60:63]
s_setprio 0
s_waitcnt lgkmcnt(6)
v_mfma_f32_16x16x32_bf16 v[64:67], v[24:27], a[128:131], v[64:67]
s_setprio 1
ds_read_b128 v[44:47], v1 offset:7168
v_mfma_f32_16x16x32_bf16 v[68:71], v[24:27], a[132:135], v[68:71]
s_setprio 0
s_waitcnt lgkmcnt(4)
v_mfma_f32_16x16x32_bf16 v[72:75], v[28:31], a[128:131], v[72:75]
s_setprio 1
v_mfma_f32_16x16x32_bf16 v[76:79], v[28:31], a[132:135], v[76:79]
s_setprio 0
s_waitcnt vmcnt(3)
s_barrier
ds_read_b128 v[16:19], v1 offset:36864
s_waitcnt lgkmcnt(4)
v_mfma_f32_16x16x32_bf16 v[48:51], v[32:35], a[136:139], v[48:51]
s_setprio 1
ds_read_b128 v[20:23], v1 offset:38912
ds_read_b128 a[144:147], v2 offset:36864
ds_read_b128 a[148:151], v2 offset:37888
v_mfma_f32_16x16x32_bf16 v[52:55], v[32:35], a[140:143], v[52:55]
s_setprio 0
s_waitcnt lgkmcnt(6)
v_mfma_f32_16x16x32_bf16 v[56:59], v[36:39], a[136:139], v[56:59]
s_setprio 1
ds_read_b128 v[24:27], v1 offset:40960
ds_read_b128 a[152:155], v2 offset:38912
ds_read_b128 a[156:159], v2 offset:39936
v_mfma_f32_16x16x32_bf16 v[60:63], v[36:39], a[140:143], v[60:63]
s_setprio 0
s_add_u32 s53, s53, 688128
s_add_u32 m0, s51, 0x21000
s_nop 0
buffer_load_dwordx4 v3, s[32:35], s53 offen offset:0 lds
buffer_load_dwordx4 v3, s[32:35], s53 offen offset:1024 lds
buffer_load_dwordx4 v3, s[32:35], s53 offen offset:2048 lds
s_waitcnt lgkmcnt(8)
v_mfma_f32_16x16x32_bf16 v[64:67], v[40:43], a[136:139], v[64:67]
s_setprio 1
ds_read_b128 v[28:31], v1 offset:43008
v_mfma_f32_16x16x32_bf16 v[68:71], v[40:43], a[140:143], v[68:71]
s_setprio 0
s_waitcnt lgkmcnt(8)
v_mfma_f32_16x16x32_bf16 v[72:75], v[44:47], a[136:139], v[72:75]
s_setprio 1
ds_read_b128 v[32:35], v1 offset:37888
v_mfma_f32_16x16x32_bf16 v[76:79], v[44:47], a[140:143], v[76:79]
s_setprio 0
s_waitcnt lgkmcnt(8)
s_waitcnt lgkmcnt(6)
s_waitcnt lgkmcnt(5)
v_mfma_f32_16x16x32_bf16 v[48:51], v[16:19], a[144:147], v[48:51]
s_setprio 1
ds_read_b128 v[36:39], v1 offset:39936
v_mfma_f32_16x16x32_bf16 v[52:55], v[16:19], a[148:151], v[52:55]
s_setprio 0
v_mfma_f32_16x16x32_bf16 v[56:59], v[20:23], a[144:147], v[56:59]
s_setprio 1
ds_read_b128 v[40:43], v1 offset:41984
v_mfma_f32_16x16x32_bf16 v[60:63], v[20:23], a[148:151], v[60:63]
s_setprio 0
s_waitcnt lgkmcnt(6)
v_mfma_f32_16x16x32_bf16 v[64:67], v[24:27], a[144:147], v[64:67]
s_setprio 1
ds_read_b128 v[44:47], v1 offset:44032
v_mfma_f32_16x16x32_bf16 v[68:71], v[24:27], a[148:151], v[68:71]
s_setprio 0
s_waitcnt lgkmcnt(4)
v_mfma_f32_16x16x32_bf16 v[72:75], v[28:31], a[144:147], v[72:75]
s_setprio 1
v_mfma_f32_16x16x32_bf16 v[76:79], v[28:31], a[148:151], v[76:79]
s_setprio 0
s_waitcnt vmcnt(3)
s_barrier
s_waitcnt lgkmcnt(3)
v_mfma_f32_16x16x32_bf16 v[48:51], v[32:35], a[152:155], v[48:51]
s_setprio 1
v_mfma_f32_16x16x32_bf16 v[52:55], v[32:35], a[156:159], v[52:55]
s_setprio 0
s_waitcnt lgkmcnt(2)
v_mfma_f32_16x16x32_bf16 v[56:59], v[36:39], a[152:155], v[56:59]
s_setprio 1
v_mfma_f32_16x16x32_bf16 v[60:63], v[36:39], a[156:159], v[60:63]
s_setprio 0
s_add_u32 s53, s53, 688128
s_add_u32 m0, s51, 0x3000
s_nop 0
buffer_load_dwordx4 v3, s[32:35], s53 offen offset:0 lds
buffer_load_dwordx4 v3, s[32:35], s53 offen offset:1024 lds
buffer_load_dwordx4 v3, s[32:35], s53 offen offset:2048 lds
s_waitcnt lgkmcnt(1)
v_mfma_f32_16x16x32_bf16 v[64:67], v[40:43], a[152:155], v[64:67]
s_setprio 1
v_mfma_f32_16x16x32_bf16 v[68:71], v[40:43], a[156:159], v[68:71]
s_setprio 0
s_waitcnt lgkmcnt(0)
v_mfma_f32_16x16x32_bf16 v[72:75], v[44:47], a[152:155], v[72:75]
s_setprio 1
v_mfma_f32_16x16x32_bf16 v[76:79], v[44:47], a[156:159], v[76:79]
s_setprio 0
s_nop 5
s_lshl_b32 s60, s55, 10
s_add_u32 s60, s60, s54
s_add_u32 s60, s60, 40960
v_pk_mul_f32 v[48:49], v[48:49], s[82:83]
v_pk_mul_f32 v[50:51], v[50:51], s[82:83]
v_exp_f32 v48, v48
v_exp_f32 v49, v49
v_exp_f32 v50, v50
v_exp_f32 v51, v51
s_nop 0
v_pk_add_f32 v[48:49], v[48:49], s[84:85]
v_pk_add_f32 v[50:51], v[50:51], s[84:85]
v_rcp_f32 v48, v48
v_rcp_f32 v49, v49
v_rcp_f32 v50, v50
v_rcp_f32 v51, v51
s_nop 0
v_pk_mul_f32 v[56:57], v[56:57], v[48:49]
v_pk_mul_f32 v[58:59], v[58:59], v[50:51]
v_pk_mul_f32 v[52:53], v[52:53], s[82:83]
v_pk_mul_f32 v[54:55], v[54:55], s[82:83]
v_exp_f32 v52, v52
v_exp_f32 v53, v53
v_exp_f32 v54, v54
v_exp_f32 v55, v55
s_nop 0
v_pk_add_f32 v[52:53], v[52:53], s[84:85]
v_pk_add_f32 v[54:55], v[54:55], s[84:85]
v_rcp_f32 v52, v52
v_rcp_f32 v53, v53
v_rcp_f32 v54, v54
v_rcp_f32 v55, v55
s_nop 0
v_pk_mul_f32 v[60:61], v[60:61], v[52:53]
v_pk_mul_f32 v[62:63], v[62:63], v[54:55]
v_cvt_pk_bf16_f32 v20, v56, v57
v_cvt_pk_bf16_f32 v21, v58, v59
v_cvt_pk_bf16_f32 v22, v60, v61
v_cvt_pk_bf16_f32 v23, v62, v63
s_nop 1
v_permlane16_swap_b32 v20, v22
v_permlane16_swap_b32 v21, v23
s_nop 0
buffer_store_dwordx4 v[20:23], v3, s[36:39], s60 offen offset:0
v_pk_mul_f32 v[64:65], v[64:65], s[82:83]
v_pk_mul_f32 v[66:67], v[66:67], s[82:83]
v_exp_f32 v64, v64
v_exp_f32 v65, v65
v_exp_f32 v66, v66
v_exp_f32 v67, v67
s_nop 0
v_pk_add_f32 v[64:65], v[64:65], s[84:85]
v_pk_add_f32 v[66:67], v[66:67], s[84:85]
v_rcp_f32 v64, v64
v_rcp_f32 v65, v65
v_rcp_f32 v66, v66
v_rcp_f32 v67, v67
s_nop 0
v_pk_mul_f32 v[72:73], v[72:73], v[64:65]
v_pk_mul_f32 v[74:75], v[74:75], v[66:67]
v_pk_mul_f32 v[68:69], v[68:69], s[82:83]
v_pk_mul_f32 v[70:71], v[70:71], s[82:83]
v_exp_f32 v68, v68
v_exp_f32 v69, v69
v_exp_f32 v70, v70
v_exp_f32 v71, v71
s_nop 0
v_pk_add_f32 v[68:69], v[68:69], s[84:85]
v_pk_add_f32 v[70:71], v[70:71], s[84:85]
v_rcp_f32 v68, v68
v_rcp_f32 v69, v69
v_rcp_f32 v70, v70
v_rcp_f32 v71, v71
s_nop 0
v_pk_mul_f32 v[76:77], v[76:77], v[68:69]
v_pk_mul_f32 v[78:79], v[78:79], v[70:71]
v_cvt_pk_bf16_f32 v24, v72, v73
v_cvt_pk_bf16_f32 v25, v74, v75
v_cvt_pk_bf16_f32 v26, v76, v77
v_cvt_pk_bf16_f32 v27, v78, v79
s_nop 1
v_permlane16_swap_b32 v24, v26
v_permlane16_swap_b32 v25, v27
s_nop 0
buffer_store_dwordx4 v[24:27], v3, s[36:39], s60 offen offset:1024
v_add_u32 v1, 0x12000, v1
ds_read_b128 v[16:19], v1 offset:0
ds_read_b128 v[20:23], v1 offset:2048
ds_read_b128 v[24:27], v1 offset:4096
ds_read_b128 v[28:31], v1 offset:6144
ds_read_b128 v[32:35], v1 offset:8192
s_waitcnt lgkmcnt(4)
v_mfma_f32_16x16x32_bf16 v[48:51], v[16:19], a[0:3], 0
s_setprio 1
ds_read_b128 v[36:39], v1 offset:10240
v_mfma_f32_16x16x32_bf16 v[52:55], v[16:19], a[4:7], 0
s_setprio 0
s_waitcnt lgkmcnt(4)
v_mfma_f32_16x16x32_bf16 v[56:59], v[20:23], a[0:3], 0
s_setprio 1
ds_read_b128 v[40:43], v1 offset:1024
v_mfma_f32_16x16x32_bf16 v[60:63], v[20:23], a[4:7], 0
s_setprio 0
s_waitcnt lgkmcnt(4)
v_mfma_f32_16x16x32_bf16 v[64:67], v[24:27], a[0:3], 0
s_setprio 1
ds_read_b128 v[44:47], v1 offset:3072
v_mfma_f32_16x16x32_bf16 v[68:71], v[24:27], a[4:7], 0
s_setprio 0
s_waitcnt lgkmcnt(4)
v_mfma_f32_16x16x32_bf16 v[72:75], v[28:31], a[0:3], 0
s_setprio 1
ds_read_b128 v[16:19], v1 offset:5120
v_mfma_f32_16x16x32_bf16 v[76:79], v[28:31], a[4:7], 0
s_setprio 0
s_waitcnt lgkmcnt(4)
v_mfma_f32_16x16x32_bf16 v[80:83], v[32:35], a[0:3], 0
s_setprio 1
ds_read_b128 v[20:23], v1 offset:7168
v_mfma_f32_16x16x32_bf16 v[84:87], v[32:35], a[4:7], 0
s_setprio 0
s_waitcnt lgkmcnt(4)
v_mfma_f32_16x16x32_bf16 v[88:91], v[36:39], a[0:3], 0
s_setprio 1
ds_read_b128 v[24:27], v1 offset:9216
v_mfma_f32_16x16x32_bf16 v[92:95], v[36:39], a[4:7], 0
s_setprio 0
s_waitcnt vmcnt(5)
s_barrier
s_waitcnt lgkmcnt(4)
v_mfma_f32_16x16x32_bf16 v[48:51], v[40:43], a[8:11], v[48:51]
s_setprio 1
ds_read_b128 v[28:31], v1 offset:11264
v_mfma_f32_16x16x32_bf16 v[52:55], v[40:43], a[12:15], v[52:55]
s_setprio 0
s_waitcnt lgkmcnt(4)
v_mfma_f32_16x16x32_bf16 v[56:59], v[44:47], a[8:11], v[56:59]
s_setprio 1
ds_read_b128 v[32:35], v1 offset:49152
v_mfma_f32_16x16x32_bf16 v[60:63], v[44:47], a[12:15], v[60:63]
s_setprio 0
s_add_u32 s53, s53, 688128
s_add_u32 m0, s51, 0x1b000
s_nop 0
buffer_load_dwordx4 v3, s[32:35], s53 offen offset:0 lds
buffer_load_dwordx4 v3, s[32:35], s53 offen offset:1024 lds
buffer_load_dwordx4 v3, s[32:35], s53 offen offset:2048 lds
s_waitcnt lgkmcnt(4)
v_mfma_f32_16x16x32_bf16 v[64:67], v[16:19], a[8:11], v[64:67]
s_setprio 1
ds_read_b128 v[36:39], v1 offset:51200
v_mfma_f32_16x16x32_bf16 v[68:71], v[16:19], a[12:15], v[68:71]
s_setprio 0
s_waitcnt lgkmcnt(4)
v_mfma_f32_16x16x32_bf16 v[72:75], v[20:23], a[8:11], v[72:75]
s_setprio 1
ds_read_b128 v[40:43], v1 offset:53248
v_mfma_f32_16x16x32_bf16 v[76:79], v[20:23], a[12:15], v[76:79]
s_setprio 0
s_waitcnt lgkmcnt(4)
v_mfma_f32_16x16x32_bf16 v[80:83], v[24:27], a[8:11], v[80:83]
s_setprio 1
ds_read_b128 v[44:47], v1 offset:55296
v_mfma_f32_16x16x32_bf16 v[84:87], v[24:27], a[12:15], v[84:87]
s_setprio 0
s_waitcnt lgkmcnt(4)
v_mfma_f32_16x16x32_bf16 v[88:91], v[28:31], a[8:11], v[88:91]
s_setprio 1
ds_read_b128 v[16:19], v1 offset:57344
v_mfma_f32_16x16x32_bf16 v[92:95], v[28:31], a[12:15], v[92:95]
s_setprio 0
s_waitcnt lgkmcnt(4)
v_mfma_f32_16x16x32_bf16 v[48:51], v[32:35], a[16:19], v[48:51]
s_setprio 1
ds_read_b128 v[20:23], v1 offset:59392
v_mfma_f32_16x16x32_bf16 v[52:55], v[32:35], a[20:23], v[52:55]
s_setprio 0
s_waitcnt lgkmcnt(4)
v_mfma_f32_16x16x32_bf16 v[56:59], v[36:39], a[16:19], v[56:59]
s_setprio 1
ds_read_b128 v[24:27], v1 offset:50176
v_mfma_f32_16x16x32_bf16 v[60:63], v[36:39], a[20:23], v[60:63]
s_setprio 0
s_waitcnt lgkmcnt(4)
v_mfma_f32_16x16x32_bf16 v[64:67], v[40:43], a[16:19], v[64:67]
s_setprio 1
ds_read_b128 v[28:31], v1 offset:52224
v_mfma_f32_16x16x32_bf16 v[68:71], v[40:43], a[20:23], v[68:71]
s_setprio 0
s_waitcnt lgkmcnt(4)
v_mfma_f32_16x16x32_bf16 v[72:75], v[44:47], a[16:19], v[72:75]
s_setprio 1
ds_read_b128 v[32:35], v1 offset:54272
v_mfma_f32_16x16x32_bf16 v[76:79], v[44:47], a[20:23], v[76:79]
s_setprio 0
s_waitcnt lgkmcnt(4)
v_mfma_f32_16x16x32_bf16 v[80:83], v[16:19], a[16:19], v[80:83]
s_setprio 1
ds_read_b128 v[36:39], v1 offset:56320
v_mfma_f32_16x16x32_bf16 v[84:87], v[16:19], a[20:23], v[84:87]
s_setprio 0
s_waitcnt lgkmcnt(4)
v_mfma_f32_16x16x32_bf16 v[88:91], v[20:23], a[16:19], v[88:91]
s_setprio 1
ds_read_b128 v[40:43], v1 offset:58368
v_mfma_f32_16x16x32_bf16 v[92:95], v[20:23], a[20:23], v[92:95]
s_setprio 0
s_waitcnt vmcnt(5)
s_barrier
s_waitcnt lgkmcnt(4)
v_mfma_f32_16x16x32_bf16 v[48:51], v[24:27], a[24:27], v[48:51]
s_setprio 1
ds_read_b128 v[44:47], v1 offset:60416
v_mfma_f32_16x16x32_bf16 v[52:55], v[24:27], a[28:31], v[52:55]
s_setprio 0
s_waitcnt lgkmcnt(4)
v_mfma_f32_16x16x32_bf16 v[56:59], v[28:31], a[24:27], v[56:59]
s_setprio 1
v_add_u32 v1, 0xfffee000, v1
ds_read_b128 v[16:19], v1 offset:0
v_mfma_f32_16x16x32_bf16 v[60:63], v[28:31], a[28:31], v[60:63]
s_setprio 0
s_add_u32 s53, s53, 688128
s_add_u32 m0, s51, 0x15000
s_nop 0
buffer_load_dwordx4 v3, s[32:35], s53 offen offset:0 lds
buffer_load_dwordx4 v3, s[32:35], s53 offen offset:1024 lds
buffer_load_dwordx4 v3, s[32:35], s53 offen offset:2048 lds
s_waitcnt lgkmcnt(4)
v_mfma_f32_16x16x32_bf16 v[64:67], v[32:35], a[24:27], v[64:67]
s_setprio 1
ds_read_b128 v[20:23], v1 offset:2048
v_mfma_f32_16x16x32_bf16 v[68:71], v[32:35], a[28:31], v[68:71]
s_setprio 0
s_waitcnt lgkmcnt(4)
v_mfma_f32_16x16x32_bf16 v[72:75], v[36:39], a[24:27], v[72:75]
s_setprio 1
ds_read_b128 v[24:27], v1 offset:4096
v_mfma_f32_16x16x32_bf16 v[76:79], v[36:39], a[28:31], v[76:79]
s_setprio 0
s_waitcnt lgkmcnt(4)
v_mfma_f32_16x16x32_bf16 v[80:83], v[40:43], a[24:27], v[80:83]
s_setprio 1
ds_read_b128 v[28:31], v1 offset:6144
v_mfma_f32_16x16x32_bf16 v[84:87], v[40:43], a[28:31], v[84:87]
s_setprio 0
s_waitcnt lgkmcnt(4)
v_mfma_f32_16x16x32_bf16 v[88:91], v[44:47], a[24:27], v[88:91]
s_setprio 1
ds_read_b128 v[32:35], v1 offset:8192
v_mfma_f32_16x16x32_bf16 v[92:95], v[44:47], a[28:31], v[92:95]
s_setprio 0
s_waitcnt lgkmcnt(4)
v_mfma_f32_16x16x32_bf16 v[48:51], v[16:19], a[32:35], v[48:51]
s_setprio 1
ds_read_b128 v[36:39], v1 offset:10240
v_mfma_f32_16x16x32_bf16 v[52:55], v[16:19], a[36:39], v[52:55]
s_setprio 0
s_waitcnt lgkmcnt(4)
v_mfma_f32_16x16x32_bf16 v[56:59], v[20:23], a[32:35], v[56:59]
s_setprio 1
ds_read_b128 v[40:43], v1 offset:1024
v_mfma_f32_16x16x32_bf16 v[60:63], v[20:23], a[36:39], v[60:63]
s_setprio 0
s_waitcnt lgkmcnt(4)
v_mfma_f32_16x16x32_bf16 v[64:67], v[24:27], a[32:35], v[64:67]
s_setprio 1
ds_read_b128 v[44:47], v1 offset:3072
v_mfma_f32_16x16x32_bf16 v[68:71], v[24:27], a[36:39], v[68:71]
s_setprio 0
s_waitcnt lgkmcnt(4)
v_mfma_f32_16x16x32_bf16 v[72:75], v[28:31], a[32:35], v[72:75]
s_setprio 1
ds_read_b128 v[16:19], v1 offset:5120
v_mfma_f32_16x16x32_bf16 v[76:79], v[28:31], a[36:39], v[76:79]
s_setprio 0
s_waitcnt lgkmcnt(4)
v_mfma_f32_16x16x32_bf16 v[80:83], v[32:35], a[32:35], v[80:83]
s_setprio 1
ds_read_b128 v[20:23], v1 offset:7168
v_mfma_f32_16x16x32_bf16 v[84:87], v[32:35], a[36:39], v[84:87]
s_setprio 0
s_waitcnt lgkmcnt(4)
v_mfma_f32_16x16x32_bf16 v[88:91], v[36:39], a[32:35], v[88:91]
s_setprio 1
ds_read_b128 v[24:27], v1 offset:9216
v_mfma_f32_16x16x32_bf16 v[92:95], v[36:39], a[36:39], v[92:95]
s_setprio 0
s_waitcnt vmcnt(3)
s_barrier
s_waitcnt lgkmcnt(4)
v_mfma_f32_16x16x32_bf16 v[48:51], v[40:43], a[40:43], v[48:51]
s_setprio 1
ds_read_b128 v[28:31], v1 offset:11264
v_mfma_f32_16x16x32_bf16 v[52:55], v[40:43], a[44:47], v[52:55]
s_setprio 0
s_waitcnt lgkmcnt(4)
v_mfma_f32_16x16x32_bf16 v[56:59], v[44:47], a[40:43], v[56:59]
s_setprio 1
v_add_u32 v1, 0x18000, v1
ds_read_b128 v[32:35], v1 offset:0
v_mfma_f32_16x16x32_bf16 v[60:63], v[44:47], a[44:47], v[60:63]
s_setprio 0
s_add_u32 s53, s53, 688128
s_add_u32 m0, s51, 0x21000
s_nop 0
buffer_load_dwordx4 v3, s[32:35], s53 offen offset:0 lds
buffer_load_dwordx4 v3, s[32:35], s53 offen offset:1024 lds
buffer_load_dwordx4 v3, s[32:35], s53 offen offset:2048 lds
s_waitcnt lgkmcnt(4)
v_mfma_f32_16x16x32_bf16 v[64:67], v[16:19], a[40:43], v[64:67]
s_setprio 1
ds_read_b128 v[36:39], v1 offset:2048
v_mfma_f32_16x16x32_bf16 v[68:71], v[16:19], a[44:47], v[68:71]
s_setprio 0
s_waitcnt lgkmcnt(4)
v_mfma_f32_16x16x32_bf16 v[72:75], v[20:23], a[40:43], v[72:75]
s_setprio 1
ds_read_b128 v[40:43], v1 offset:4096
v_mfma_f32_16x16x32_bf16 v[76:79], v[20:23], a[44:47], v[76:79]
s_setprio 0
s_waitcnt lgkmcnt(4)
v_mfma_f32_16x16x32_bf16 v[80:83], v[24:27], a[40:43], v[80:83]
s_setprio 1
ds_read_b128 v[44:47], v1 offset:6144
v_mfma_f32_16x16x32_bf16 v[84:87], v[24:27], a[44:47], v[84:87]
s_setprio 0
s_waitcnt lgkmcnt(4)
v_mfma_f32_16x16x32_bf16 v[88:91], v[28:31], a[40:43], v[88:91]
s_setprio 1
ds_read_b128 v[16:19], v1 offset:8192
v_mfma_f32_16x16x32_bf16 v[92:95], v[28:31], a[44:47], v[92:95]
s_setprio 0
s_waitcnt lgkmcnt(4)
v_mfma_f32_16x16x32_bf16 v[48:51], v[32:35], a[48:51], v[48:51]
s_setprio 1
ds_read_b128 v[20:23], v1 offset:10240
v_mfma_f32_16x16x32_bf16 v[52:55], v[32:35], a[52:55], v[52:55]
s_setprio 0
s_waitcnt lgkmcnt(4)
v_mfma_f32_16x16x32_bf16 v[56:59], v[36:39], a[48:51], v[56:59]
s_setprio 1
ds_read_b128 v[24:27], v1 offset:1024
v_mfma_f32_16x16x32_bf16 v[60:63], v[36:39], a[52:55], v[60:63]
s_setprio 0
s_waitcnt lgkmcnt(4)
v_mfma_f32_16x16x32_bf16 v[64:67], v[40:43], a[48:51], v[64:67]
s_setprio 1
ds_read_b128 v[28:31], v1 offset:3072
v_mfma_f32_16x16x32_bf16 v[68:71], v[40:43], a[52:55], v[68:71]
s_setprio 0
s_waitcnt lgkmcnt(4)
v_mfma_f32_16x16x32_bf16 v[72:75], v[44:47], a[48:51], v[72:75]
s_setprio 1
ds_read_b128 v[32:35], v1 offset:5120
v_mfma_f32_16x16x32_bf16 v[76:79], v[44:47], a[52:55], v[76:79]
s_setprio 0
s_waitcnt lgkmcnt(4)
v_mfma_f32_16x16x32_bf16 v[80:83], v[16:19], a[48:51], v[80:83]
s_setprio 1
ds_read_b128 v[36:39], v1 offset:7168
v_mfma_f32_16x16x32_bf16 v[84:87], v[16:19], a[52:55], v[84:87]
s_setprio 0
s_waitcnt lgkmcnt(4)
v_mfma_f32_16x16x32_bf16 v[88:91], v[20:23], a[48:51], v[88:91]
s_setprio 1
ds_read_b128 v[40:43], v1 offset:9216
v_mfma_f32_16x16x32_bf16 v[92:95], v[20:23], a[52:55], v[92:95]
s_setprio 0
s_waitcnt vmcnt(3)
s_barrier
s_waitcnt lgkmcnt(4)
v_mfma_f32_16x16x32_bf16 v[48:51], v[24:27], a[56:59], v[48:51]
s_setprio 1
ds_read_b128 v[44:47], v1 offset:11264
v_mfma_f32_16x16x32_bf16 v[52:55], v[24:27], a[60:63], v[52:55]
s_setprio 0
s_waitcnt lgkmcnt(4)
v_mfma_f32_16x16x32_bf16 v[56:59], v[28:31], a[56:59], v[56:59]
s_setprio 1
v_add_u32 v1, 0xffffa000, v1
ds_read_b128 v[16:19], v1 offset:0
v_mfma_f32_16x16x32_bf16 v[60:63], v[28:31], a[60:63], v[60:63]
s_setprio 0
s_add_u32 s53, s53, 688128
s_add_u32 m0, s51, 0x3000
s_nop 0
buffer_load_dwordx4 v3, s[32:35], s53 offen offset:0 lds
buffer_load_dwordx4 v3, s[32:35], s53 offen offset:1024 lds
buffer_load_dwordx4 v3, s[32:35], s53 offen offset:2048 lds
s_waitcnt lgkmcnt(4)
v_mfma_f32_16x16x32_bf16 v[64:67], v[32:35], a[56:59], v[64:67]
s_setprio 1
ds_read_b128 v[20:23], v1 offset:2048
v_mfma_f32_16x16x32_bf16 v[68:71], v[32:35], a[60:63], v[68:71]
s_setprio 0
s_waitcnt lgkmcnt(4)
v_mfma_f32_16x16x32_bf16 v[72:75], v[36:39], a[56:59], v[72:75]
s_setprio 1
ds_read_b128 v[24:27], v1 offset:4096
v_mfma_f32_16x16x32_bf16 v[76:79], v[36:39], a[60:63], v[76:79]
s_setprio 0
s_waitcnt lgkmcnt(4)
v_mfma_f32_16x16x32_bf16 v[80:83], v[40:43], a[56:59], v[80:83]
s_setprio 1
ds_read_b128 v[28:31], v1 offset:6144
v_mfma_f32_16x16x32_bf16 v[84:87], v[40:43], a[60:63], v[84:87]
s_setprio 0
s_waitcnt lgkmcnt(4)
v_mfma_f32_16x16x32_bf16 v[88:91], v[44:47], a[56:59], v[88:91]
s_setprio 1
ds_read_b128 v[32:35], v1 offset:8192
v_mfma_f32_16x16x32_bf16 v[92:95], v[44:47], a[60:63], v[92:95]
s_setprio 0
s_waitcnt lgkmcnt(4)
v_mfma_f32_16x16x32_bf16 v[48:51], v[16:19], a[64:67], v[48:51]
s_setprio 1
ds_read_b128 v[36:39], v1 offset:10240
v_mfma_f32_16x16x32_bf16 v[52:55], v[16:19], a[68:71], v[52:55]
s_setprio 0
s_waitcnt lgkmcnt(4)
v_mfma_f32_16x16x32_bf16 v[56:59], v[20:23], a[64:67], v[56:59]
s_setprio 1
ds_read_b128 v[40:43], v1 offset:1024
v_mfma_f32_16x16x32_bf16 v[60:63], v[20:23], a[68:71], v[60:63]
s_setprio 0
s_waitcnt lgkmcnt(4)
v_mfma_f32_16x16x32_bf16 v[64:67], v[24:27], a[64:67], v[64:67]
s_setprio 1
ds_read_b128 v[44:47], v1 offset:3072
v_mfma_f32_16x16x32_bf16 v[68:71], v[24:27], a[68:71], v[68:71]
s_setprio 0
s_waitcnt lgkmcnt(4)
v_mfma_f32_16x16x32_bf16 v[72:75], v[28:31], a[64:67], v[72:75]
s_setprio 1
ds_read_b128 v[16:19], v1 offset:5120
v_mfma_f32_16x16x32_bf16 v[76:79], v[28:31], a[68:71], v[76:79]
s_setprio 0
s_waitcnt lgkmcnt(4)
v_mfma_f32_16x16x32_bf16 v[80:83], v[32:35], a[64:67], v[80:83]
s_setprio 1
ds_read_b128 v[20:23], v1 offset:7168
v_mfma_f32_16x16x32_bf16 v[84:87], v[32:35], a[68:71], v[84:87]
s_setprio 0
s_waitcnt lgkmcnt(4)
v_mfma_f32_16x16x32_bf16 v[88:91], v[36:39], a[64:67], v[88:91]
s_setprio 1
ds_read_b128 v[24:27], v1 offset:9216
v_mfma_f32_16x16x32_bf16 v[92:95], v[36:39], a[68:71], v[92:95]
s_setprio 0
s_waitcnt vmcnt(3)
s_barrier
s_waitcnt lgkmcnt(4)
v_mfma_f32_16x16x32_bf16 v[48:51], v[40:43], a[72:75], v[48:51]
s_setprio 1
ds_read_b128 v[28:31], v1 offset:11264
v_mfma_f32_16x16x32_bf16 v[52:55], v[40:43], a[76:79], v[52:55]
s_setprio 0
s_waitcnt lgkmcnt(4)
v_mfma_f32_16x16x32_bf16 v[56:59], v[44:47], a[72:75], v[56:59]
s_setprio 1
ds_read_b128 v[32:35], v1 offset:49152
v_mfma_f32_16x16x32_bf16 v[60:63], v[44:47], a[76:79], v[60:63]
s_setprio 0
s_add_u32 s53, s53, 688128
s_add_u32 m0, s51, 0x1b000
s_nop 0
buffer_load_dwordx4 v3, s[32:35], s53 offen offset:0 lds
buffer_load_dwordx4 v3, s[32:35], s53 offen offset:1024 lds
buffer_load_dwordx4 v3, s[32:35], s53 offen offset:2048 lds
s_waitcnt lgkmcnt(4)
v_mfma_f32_16x16x32_bf16 v[64:67], v[16:19], a[72:75], v[64:67]
s_setprio 1
ds_read_b128 v[36:39], v1 offset:51200
v_mfma_f32_16x16x32_bf16 v[68:71], v[16:19], a[76:79], v[68:71]
s_setprio 0
s_waitcnt lgkmcnt(4)
v_mfma_f32_16x16x32_bf16 v[72:75], v[20:23], a[72:75], v[72:75]
s_setprio 1
ds_read_b128 v[40:43], v1 offset:53248
v_mfma_f32_16x16x32_bf16 v[76:79], v[20:23], a[76:79], v[76:79]
s_setprio 0
s_waitcnt lgkmcnt(4)
v_mfma_f32_16x16x32_bf16 v[80:83], v[24:27], a[72:75], v[80:83]
s_setprio 1
ds_read_b128 v[44:47], v1 offset:55296
v_mfma_f32_16x16x32_bf16 v[84:87], v[24:27], a[76:79], v[84:87]
s_setprio 0
s_waitcnt lgkmcnt(4)
v_mfma_f32_16x16x32_bf16 v[88:91], v[28:31], a[72:75], v[88:91]
s_setprio 1
ds_read_b128 v[16:19], v1 offset:57344
v_mfma_f32_16x16x32_bf16 v[92:95], v[28:31], a[76:79], v[92:95]
s_setprio 0
s_waitcnt lgkmcnt(4)
v_mfma_f32_16x16x32_bf16 v[48:51], v[32:35], a[80:83], v[48:51]
s_setprio 1
ds_read_b128 v[20:23], v1 offset:59392
v_mfma_f32_16x16x32_bf16 v[52:55], v[32:35], a[84:87], v[52:55]
s_setprio 0
s_waitcnt lgkmcnt(4)
v_mfma_f32_16x16x32_bf16 v[56:59], v[36:39], a[80:83], v[56:59]
s_setprio 1
ds_read_b128 v[24:27], v1 offset:50176
v_mfma_f32_16x16x32_bf16 v[60:63], v[36:39], a[84:87], v[60:63]
s_setprio 0
s_waitcnt lgkmcnt(4)
v_mfma_f32_16x16x32_bf16 v[64:67], v[40:43], a[80:83], v[64:67]
s_setprio 1
ds_read_b128 v[28:31], v1 offset:52224
v_mfma_f32_16x16x32_bf16 v[68:71], v[40:43], a[84:87], v[68:71]
s_setprio 0
s_waitcnt lgkmcnt(4)
v_mfma_f32_16x16x32_bf16 v[72:75], v[44:47], a[80:83], v[72:75]
s_setprio 1
ds_read_b128 v[32:35], v1 offset:54272
v_mfma_f32_16x16x32_bf16 v[76:79], v[44:47], a[84:87], v[76:79]
s_setprio 0
s_waitcnt lgkmcnt(4)
v_mfma_f32_16x16x32_bf16 v[80:83], v[16:19], a[80:83], v[80:83]
s_setprio 1
ds_read_b128 v[36:39], v1 offset:56320
v_mfma_f32_16x16x32_bf16 v[84:87], v[16:19], a[84:87], v[84:87]
s_setprio 0
s_waitcnt lgkmcnt(4)
v_mfma_f32_16x16x32_bf16 v[88:91], v[20:23], a[80:83], v[88:91]
s_setprio 1
ds_read_b128 v[40:43], v1 offset:58368
v_mfma_f32_16x16x32_bf16 v[92:95], v[20:23], a[84:87], v[92:95]
s_setprio 0
s_waitcnt vmcnt(3)
s_barrier
s_waitcnt lgkmcnt(4)
v_mfma_f32_16x16x32_bf16 v[48:51], v[24:27], a[88:91], v[48:51]
s_setprio 1
ds_read_b128 v[44:47], v1 offset:60416
v_mfma_f32_16x16x32_bf16 v[52:55], v[24:27], a[92:95], v[52:55]
s_setprio 0
s_waitcnt lgkmcnt(4)
v_mfma_f32_16x16x32_bf16 v[56:59], v[28:31], a[88:91], v[56:59]
s_setprio 1
v_add_u32 v1, 0xfffee000, v1
ds_read_b128 v[16:19], v1 offset:0
v_mfma_f32_16x16x32_bf16 v[60:63], v[28:31], a[92:95], v[60:63]
s_setprio 0
s_add_u32 s53, s53, 688128
s_add_u32 m0, s51, 0x15000
s_nop 0
buffer_load_dwordx4 v3, s[32:35], s53 offen offset:0 lds
buffer_load_dwordx4 v3, s[32:35], s53 offen offset:1024 lds
buffer_load_dwordx4 v3, s[32:35], s53 offen offset:2048 lds
s_waitcnt lgkmcnt(4)
v_mfma_f32_16x16x32_bf16 v[64:67], v[32:35], a[88:91], v[64:67]
s_setprio 1
ds_read_b128 v[20:23], v1 offset:2048
v_mfma_f32_16x16x32_bf16 v[68:71], v[32:35], a[92:95], v[68:71]
s_setprio 0
s_waitcnt lgkmcnt(4)
v_mfma_f32_16x16x32_bf16 v[72:75], v[36:39], a[88:91], v[72:75]
s_setprio 1
ds_read_b128 v[24:27], v1 offset:4096
v_mfma_f32_16x16x32_bf16 v[76:79], v[36:39], a[92:95], v[76:79]
s_setprio 0
s_waitcnt lgkmcnt(4)
v_mfma_f32_16x16x32_bf16 v[80:83], v[40:43], a[88:91], v[80:83]
s_setprio 1
ds_read_b128 v[28:31], v1 offset:6144
v_mfma_f32_16x16x32_bf16 v[84:87], v[40:43], a[92:95], v[84:87]
s_setprio 0
s_waitcnt lgkmcnt(4)
v_mfma_f32_16x16x32_bf16 v[88:91], v[44:47], a[88:91], v[88:91]
s_setprio 1
ds_read_b128 v[32:35], v1 offset:8192
v_mfma_f32_16x16x32_bf16 v[92:95], v[44:47], a[92:95], v[92:95]
s_setprio 0
s_waitcnt lgkmcnt(4)
v_mfma_f32_16x16x32_bf16 v[48:51], v[16:19], a[96:99], v[48:51]
s_setprio 1
ds_read_b128 v[36:39], v1 offset:10240
v_mfma_f32_16x16x32_bf16 v[52:55], v[16:19], a[100:103], v[52:55]
s_setprio 0
s_waitcnt lgkmcnt(4)
v_mfma_f32_16x16x32_bf16 v[56:59], v[20:23], a[96:99], v[56:59]
s_setprio 1
ds_read_b128 v[40:43], v1 offset:1024
v_mfma_f32_16x16x32_bf16 v[60:63], v[20:23], a[100:103], v[60:63]
s_setprio 0
s_waitcnt lgkmcnt(4)
v_mfma_f32_16x16x32_bf16 v[64:67], v[24:27], a[96:99], v[64:67]
s_setprio 1
ds_read_b128 v[44:47], v1 offset:3072
v_mfma_f32_16x16x32_bf16 v[68:71], v[24:27], a[100:103], v[68:71]
s_setprio 0
s_waitcnt lgkmcnt(4)
v_mfma_f32_16x16x32_bf16 v[72:75], v[28:31], a[96:99], v[72:75]
s_setprio 1
ds_read_b128 v[16:19], v1 offset:5120
v_mfma_f32_16x16x32_bf16 v[76:79], v[28:31], a[100:103], v[76:79]
s_setprio 0
s_waitcnt lgkmcnt(4)
v_mfma_f32_16x16x32_bf16 v[80:83], v[32:35], a[96:99], v[80:83]
s_setprio 1
ds_read_b128 v[20:23], v1 offset:7168
v_mfma_f32_16x16x32_bf16 v[84:87], v[32:35], a[100:103], v[84:87]
s_setprio 0
s_waitcnt lgkmcnt(4)
v_mfma_f32_16x16x32_bf16 v[88:91], v[36:39], a[96:99], v[88:91]
s_setprio 1
ds_read_b128 v[24:27], v1 offset:9216
v_mfma_f32_16x16x32_bf16 v[92:95], v[36:39], a[100:103], v[92:95]
s_setprio 0
s_waitcnt vmcnt(3)
s_barrier
s_waitcnt lgkmcnt(4)
v_mfma_f32_16x16x32_bf16 v[48:51], v[40:43], a[104:107], v[48:51]
s_setprio 1
ds_read_b128 v[28:31], v1 offset:11264
v_mfma_f32_16x16x32_bf16 v[52:55], v[40:43], a[108:111], v[52:55]
s_setprio 0
s_waitcnt lgkmcnt(4)
v_mfma_f32_16x16x32_bf16 v[56:59], v[44:47], a[104:107], v[56:59]
s_setprio 1
v_add_u32 v1, 0x18000, v1
ds_read_b128 v[32:35], v1 offset:0
v_mfma_f32_16x16x32_bf16 v[60:63], v[44:47], a[108:111], v[60:63]
s_setprio 0
s_add_u32 s53, s53, 688128
s_add_u32 m0, s51, 0x21000
s_nop 0
buffer_load_dwordx4 v3, s[32:35], s53 offen offset:0 lds
buffer_load_dwordx4 v3, s[32:35], s53 offen offset:1024 lds
buffer_load_dwordx4 v3, s[32:35], s53 offen offset:2048 lds
s_waitcnt lgkmcnt(4)
v_mfma_f32_16x16x32_bf16 v[64:67], v[16:19], a[104:107], v[64:67]
s_setprio 1
ds_read_b128 v[36:39], v1 offset:2048
v_mfma_f32_16x16x32_bf16 v[68:71], v[16:19], a[108:111], v[68:71]
s_setprio 0
s_waitcnt lgkmcnt(4)
v_mfma_f32_16x16x32_bf16 v[72:75], v[20:23], a[104:107], v[72:75]
s_setprio 1
ds_read_b128 v[40:43], v1 offset:4096
v_mfma_f32_16x16x32_bf16 v[76:79], v[20:23], a[108:111], v[76:79]
s_setprio 0
s_waitcnt lgkmcnt(4)
v_mfma_f32_16x16x32_bf16 v[80:83], v[24:27], a[104:107], v[80:83]
s_setprio 1
ds_read_b128 v[44:47], v1 offset:6144
v_mfma_f32_16x16x32_bf16 v[84:87], v[24:27], a[108:111], v[84:87]
s_setprio 0
s_waitcnt lgkmcnt(4)
v_mfma_f32_16x16x32_bf16 v[88:91], v[28:31], a[104:107], v[88:91]
s_setprio 1
ds_read_b128 v[16:19], v1 offset:8192
v_mfma_f32_16x16x32_bf16 v[92:95], v[28:31], a[108:111], v[92:95]
s_setprio 0
s_waitcnt lgkmcnt(4)
v_mfma_f32_16x16x32_bf16 v[48:51], v[32:35], a[112:115], v[48:51]
s_setprio 1
ds_read_b128 v[20:23], v1 offset:10240
v_mfma_f32_16x16x32_bf16 v[52:55], v[32:35], a[116:119], v[52:55]
s_setprio 0
s_waitcnt lgkmcnt(4)
v_mfma_f32_16x16x32_bf16 v[56:59], v[36:39], a[112:115], v[56:59]
s_setprio 1
ds_read_b128 v[24:27], v1 offset:1024
v_mfma_f32_16x16x32_bf16 v[60:63], v[36:39], a[116:119], v[60:63]
s_setprio 0
s_waitcnt lgkmcnt(4)
v_mfma_f32_16x16x32_bf16 v[64:67], v[40:43], a[112:115], v[64:67]
s_setprio 1
ds_read_b128 v[28:31], v1 offset:3072
v_mfma_f32_16x16x32_bf16 v[68:71], v[40:43], a[116:119], v[68:71]
s_setprio 0
s_waitcnt lgkmcnt(4)
v_mfma_f32_16x16x32_bf16 v[72:75], v[44:47], a[112:115], v[72:75]
s_setprio 1
ds_read_b128 v[32:35], v1 offset:5120
v_mfma_f32_16x16x32_bf16 v[76:79], v[44:47], a[116:119], v[76:79]
s_setprio 0
s_waitcnt lgkmcnt(4)
v_mfma_f32_16x16x32_bf16 v[80:83], v[16:19], a[112:115], v[80:83]
s_setprio 1
ds_read_b128 v[36:39], v1 offset:7168
v_mfma_f32_16x16x32_bf16 v[84:87], v[16:19], a[116:119], v[84:87]
s_setprio 0
s_waitcnt lgkmcnt(4)
v_mfma_f32_16x16x32_bf16 v[88:91], v[20:23], a[112:115], v[88:91]
s_setprio 1
ds_read_b128 v[40:43], v1 offset:9216
v_mfma_f32_16x16x32_bf16 v[92:95], v[20:23], a[116:119], v[92:95]
s_setprio 0
s_waitcnt vmcnt(3)
s_barrier
s_waitcnt lgkmcnt(4)
v_mfma_f32_16x16x32_bf16 v[48:51], v[24:27], a[120:123], v[48:51]
s_setprio 1
ds_read_b128 v[44:47], v1 offset:11264
v_mfma_f32_16x16x32_bf16 v[52:55], v[24:27], a[124:127], v[52:55]
s_setprio 0
s_waitcnt lgkmcnt(4)
v_mfma_f32_16x16x32_bf16 v[56:59], v[28:31], a[120:123], v[56:59]
s_setprio 1
v_add_u32 v1, 0xffffa000, v1
ds_read_b128 v[16:19], v1 offset:0
v_mfma_f32_16x16x32_bf16 v[60:63], v[28:31], a[124:127], v[60:63]
s_setprio 0
s_waitcnt lgkmcnt(4)
v_mfma_f32_16x16x32_bf16 v[64:67], v[32:35], a[120:123], v[64:67]
s_setprio 1
ds_read_b128 v[20:23], v1 offset:2048
v_mfma_f32_16x16x32_bf16 v[68:71], v[32:35], a[124:127], v[68:71]
s_setprio 0
s_waitcnt lgkmcnt(4)
v_mfma_f32_16x16x32_bf16 v[72:75], v[36:39], a[120:123], v[72:75]
s_setprio 1
ds_read_b128 v[24:27], v1 offset:4096
v_mfma_f32_16x16x32_bf16 v[76:79], v[36:39], a[124:127], v[76:79]
s_setprio 0
s_waitcnt lgkmcnt(4)
v_mfma_f32_16x16x32_bf16 v[80:83], v[40:43], a[120:123], v[80:83]
s_setprio 1
ds_read_b128 v[28:31], v1 offset:6144
v_mfma_f32_16x16x32_bf16 v[84:87], v[40:43], a[124:127], v[84:87]
s_setprio 0
s_waitcnt lgkmcnt(4)
v_mfma_f32_16x16x32_bf16 v[88:91], v[44:47], a[120:123], v[88:91]
s_setprio 1
ds_read_b128 v[32:35], v1 offset:8192
v_mfma_f32_16x16x32_bf16 v[92:95], v[44:47], a[124:127], v[92:95]
s_setprio 0
s_waitcnt lgkmcnt(4)
v_mfma_f32_16x16x32_bf16 v[48:51], v[16:19], a[128:131], v[48:51]
s_setprio 1
ds_read_b128 v[36:39], v1 offset:10240
v_mfma_f32_16x16x32_bf16 v[52:55], v[16:19], a[132:135], v[52:55]
s_setprio 0
s_waitcnt lgkmcnt(4)
v_mfma_f32_16x16x32_bf16 v[56:59], v[20:23], a[128:131], v[56:59]
s_setprio 1
ds_read_b128 v[40:43], v1 offset:1024
v_mfma_f32_16x16x32_bf16 v[60:63], v[20:23], a[132:135], v[60:63]
s_setprio 0
s_waitcnt lgkmcnt(4)
v_mfma_f32_16x16x32_bf16 v[64:67], v[24:27], a[128:131], v[64:67]
s_setprio 1
ds_read_b128 v[44:47], v1 offset:3072
v_mfma_f32_16x16x32_bf16 v[68:71], v[24:27], a[132:135], v[68:71]
s_setprio 0
s_waitcnt lgkmcnt(4)
v_mfma_f32_16x16x32_bf16 v[72:75], v[28:31], a[128:131], v[72:75]
s_setprio 1
ds_read_b128 v[16:19], v1 offset:5120
v_mfma_f32_16x16x32_bf16 v[76:79], v[28:31], a[132:135], v[76:79]
s_setprio 0
s_waitcnt lgkmcnt(4)
v_mfma_f32_16x16x32_bf16 v[80:83], v[32:35], a[128:131], v[80:83]
s_setprio 1
ds_read_b128 v[20:23], v1 offset:7168
v_mfma_f32_16x16x32_bf16 v[84:87], v[32:35], a[132:135], v[84:87]
s_setprio 0
s_waitcnt lgkmcnt(4)
v_mfma_f32_16x16x32_bf16 v[88:91], v[36:39], a[128:131], v[88:91]
s_setprio 1
ds_read_b128 v[24:27], v1 offset:9216
v_mfma_f32_16x16x32_bf16 v[92:95], v[36:39], a[132:135], v[92:95]
s_setprio 0
s_waitcnt vmcnt(0)
s_barrier
s_waitcnt lgkmcnt(4)
v_mfma_f32_16x16x32_bf16 v[48:51], v[40:43], a[136:139], v[48:51]
s_setprio 1
ds_read_b128 v[28:31], v1 offset:11264
v_mfma_f32_16x16x32_bf16 v[52:55], v[40:43], a[140:143], v[52:55]
s_setprio 0
s_waitcnt lgkmcnt(4)
v_mfma_f32_16x16x32_bf16 v[56:59], v[44:47], a[136:139], v[56:59]
s_setprio 1
ds_read_b128 v[32:35], v1 offset:49152
v_mfma_f32_16x16x32_bf16 v[60:63], v[44:47], a[140:143], v[60:63]
s_setprio 0
s_waitcnt lgkmcnt(4)
v_mfma_f32_16x16x32_bf16 v[64:67], v[16:19], a[136:139], v[64:67]
s_setprio 1
ds_read_b128 v[36:39], v1 offset:51200
v_mfma_f32_16x16x32_bf16 v[68:71], v[16:19], a[140:143], v[68:71]
s_setprio 0
s_waitcnt lgkmcnt(4)
v_mfma_f32_16x16x32_bf16 v[72:75], v[20:23], a[136:139], v[72:75]
s_setprio 1
ds_read_b128 v[40:43], v1 offset:53248
v_mfma_f32_16x16x32_bf16 v[76:79], v[20:23], a[140:143], v[76:79]
s_setprio 0
s_waitcnt lgkmcnt(4)
v_mfma_f32_16x16x32_bf16 v[80:83], v[24:27], a[136:139], v[80:83]
s_setprio 1
ds_read_b128 v[44:47], v1 offset:55296
v_mfma_f32_16x16x32_bf16 v[84:87], v[24:27], a[140:143], v[84:87]
s_setprio 0
s_waitcnt lgkmcnt(4)
v_mfma_f32_16x16x32_bf16 v[88:91], v[28:31], a[136:139], v[88:91]
s_setprio 1
ds_read_b128 v[16:19], v1 offset:57344
v_mfma_f32_16x16x32_bf16 v[92:95], v[28:31], a[140:143], v[92:95]
s_setprio 0
s_waitcnt lgkmcnt(4)
v_mfma_f32_16x16x32_bf16 v[48:51], v[32:35], a[144:147], v[48:51]
s_setprio 1
ds_read_b128 v[20:23], v1 offset:59392
v_mfma_f32_16x16x32_bf16 v[52:55], v[32:35], a[148:151], v[52:55]
s_setprio 0
s_waitcnt lgkmcnt(4)
v_mfma_f32_16x16x32_bf16 v[56:59], v[36:39], a[144:147], v[56:59]
s_setprio 1
ds_read_b128 v[24:27], v1 offset:50176
v_mfma_f32_16x16x32_bf16 v[60:63], v[36:39], a[148:151], v[60:63]
s_setprio 0
s_waitcnt lgkmcnt(4)
v_mfma_f32_16x16x32_bf16 v[64:67], v[40:43], a[144:147], v[64:67]
s_setprio 1
ds_read_b128 v[28:31], v1 offset:52224
v_mfma_f32_16x16x32_bf16 v[68:71], v[40:43], a[148:151], v[68:71]
s_setprio 0
s_waitcnt lgkmcnt(4)
v_mfma_f32_16x16x32_bf16 v[72:75], v[44:47], a[144:147], v[72:75]
s_setprio 1
ds_read_b128 v[32:35], v1 offset:54272
v_mfma_f32_16x16x32_bf16 v[76:79], v[44:47], a[148:151], v[76:79]
s_setprio 0
s_waitcnt lgkmcnt(4)
v_mfma_f32_16x16x32_bf16 v[80:83], v[16:19], a[144:147], v[80:83]
s_setprio 1
ds_read_b128 v[36:39], v1 offset:56320
v_mfma_f32_16x16x32_bf16 v[84:87], v[16:19], a[148:151], v[84:87]
s_setprio 0
s_waitcnt lgkmcnt(4)
v_mfma_f32_16x16x32_bf16 v[88:91], v[20:23], a[144:147], v[88:91]
s_setprio 1
ds_read_b128 v[40:43], v1 offset:58368
v_mfma_f32_16x16x32_bf16 v[92:95], v[20:23], a[148:151], v[92:95]
s_setprio 0
s_waitcnt lgkmcnt(4)
v_mfma_f32_16x16x32_bf16 v[48:51], v[24:27], a[152:155], v[48:51]
s_setprio 1
ds_read_b128 v[44:47], v1 offset:60416
v_mfma_f32_16x16x32_bf16 v[52:55], v[24:27], a[156:159], v[52:55]
s_setprio 0
s_waitcnt lgkmcnt(4)
v_mfma_f32_16x16x32_bf16 v[56:59], v[28:31], a[152:155], v[56:59]
s_setprio 1
v_mfma_f32_16x16x32_bf16 v[60:63], v[28:31], a[156:159], v[60:63]
s_setprio 0
s_waitcnt lgkmcnt(3)
v_mfma_f32_16x16x32_bf16 v[64:67], v[32:35], a[152:155], v[64:67]
s_setprio 1
v_mfma_f32_16x16x32_bf16 v[68:71], v[32:35], a[156:159], v[68:71]
s_setprio 0
s_waitcnt lgkmcnt(2)
v_mfma_f32_16x16x32_bf16 v[72:75], v[36:39], a[152:155], v[72:75]
s_setprio 1
v_mfma_f32_16x16x32_bf16 v[76:79], v[36:39], a[156:159], v[76:79]
s_setprio 0
s_waitcnt lgkmcnt(1)
v_mfma_f32_16x16x32_bf16 v[80:83], v[40:43], a[152:155], v[80:83]
s_setprio 1
v_mfma_f32_16x16x32_bf16 v[84:87], v[40:43], a[156:159], v[84:87]
s_setprio 0
s_waitcnt lgkmcnt(0)
v_mfma_f32_16x16x32_bf16 v[88:91], v[44:47], a[152:155], v[88:91]
s_setprio 1
v_mfma_f32_16x16x32_bf16 v[92:95], v[44:47], a[156:159], v[92:95]
s_setprio 0
s_nop 5
s_lshl_b32 s60, s56, 10
s_add_u32 s60, s60, s54
s_add_u32 s60, s60, 40960
v_pk_mul_f32 v[48:49], v[48:49], s[82:83]
v_pk_mul_f32 v[50:51], v[50:51], s[82:83]
v_exp_f32 v48, v48
v_exp_f32 v49, v49
v_exp_f32 v50, v50
v_exp_f32 v51, v51
s_nop 0
v_pk_add_f32 v[48:49], v[48:49], s[84:85]
v_pk_add_f32 v[50:51], v[50:51], s[84:85]
v_rcp_f32 v48, v48
v_rcp_f32 v49, v49
v_rcp_f32 v50, v50
v_rcp_f32 v51, v51
s_nop 0
v_pk_mul_f32 v[56:57], v[56:57], v[48:49]
v_pk_mul_f32 v[58:59], v[58:59], v[50:51]
v_pk_mul_f32 v[52:53], v[52:53], s[82:83]
v_pk_mul_f32 v[54:55], v[54:55], s[82:83]
v_exp_f32 v52, v52
v_exp_f32 v53, v53
v_exp_f32 v54, v54
v_exp_f32 v55, v55
s_nop 0
v_pk_add_f32 v[52:53], v[52:53], s[84:85]
v_pk_add_f32 v[54:55], v[54:55], s[84:85]
v_rcp_f32 v52, v52
v_rcp_f32 v53, v53
v_rcp_f32 v54, v54
v_rcp_f32 v55, v55
s_nop 0
v_pk_mul_f32 v[60:61], v[60:61], v[52:53]
v_pk_mul_f32 v[62:63], v[62:63], v[54:55]
v_cvt_pk_bf16_f32 v20, v56, v57
v_cvt_pk_bf16_f32 v21, v58, v59
v_cvt_pk_bf16_f32 v22, v60, v61
v_cvt_pk_bf16_f32 v23, v62, v63
s_nop 1
v_permlane16_swap_b32 v20, v22
v_permlane16_swap_b32 v21, v23
s_nop 0
buffer_store_dwordx4 v[20:23], v3, s[36:39], s60 offen offset:0 sc1
v_pk_mul_f32 v[64:65], v[64:65], s[82:83]
v_pk_mul_f32 v[66:67], v[66:67], s[82:83]
v_exp_f32 v64, v64
v_exp_f32 v65, v65
v_exp_f32 v66, v66
v_exp_f32 v67, v67
s_nop 0
v_pk_add_f32 v[64:65], v[64:65], s[84:85]
v_pk_add_f32 v[66:67], v[66:67], s[84:85]
v_rcp_f32 v64, v64
v_rcp_f32 v65, v65
v_rcp_f32 v66, v66
v_rcp_f32 v67, v67
s_nop 0
v_pk_mul_f32 v[72:73], v[72:73], v[64:65]
v_pk_mul_f32 v[74:75], v[74:75], v[66:67]
v_pk_mul_f32 v[68:69], v[68:69], s[82:83]
v_pk_mul_f32 v[70:71], v[70:71], s[82:83]
v_exp_f32 v68, v68
v_exp_f32 v69, v69
v_exp_f32 v70, v70
v_exp_f32 v71, v71
s_nop 0
v_pk_add_f32 v[68:69], v[68:69], s[84:85]
v_pk_add_f32 v[70:71], v[70:71], s[84:85]
v_rcp_f32 v68, v68
v_rcp_f32 v69, v69
v_rcp_f32 v70, v70
v_rcp_f32 v71, v71
s_nop 0
v_pk_mul_f32 v[76:77], v[76:77], v[68:69]
v_pk_mul_f32 v[78:79], v[78:79], v[70:71]
v_cvt_pk_bf16_f32 v24, v72, v73
v_cvt_pk_bf16_f32 v25, v74, v75
v_cvt_pk_bf16_f32 v26, v76, v77
v_cvt_pk_bf16_f32 v27, v78, v79
s_nop 1
v_permlane16_swap_b32 v24, v26
v_permlane16_swap_b32 v25, v27
s_nop 0
buffer_store_dwordx4 v[24:27], v3, s[36:39], s60 offen offset:1024 sc1
v_pk_mul_f32 v[80:81], v[80:81], s[82:83]
v_pk_mul_f32 v[82:83], v[82:83], s[82:83]
v_exp_f32 v80, v80
v_exp_f32 v81, v81
v_exp_f32 v82, v82
v_exp_f32 v83, v83
s_nop 0
v_pk_add_f32 v[80:81], v[80:81], s[84:85]
v_pk_add_f32 v[82:83], v[82:83], s[84:85]
v_rcp_f32 v80, v80
v_rcp_f32 v81, v81
v_rcp_f32 v82, v82
v_rcp_f32 v83, v83
s_nop 0
v_pk_mul_f32 v[88:89], v[88:89], v[80:81]
v_pk_mul_f32 v[90:91], v[90:91], v[82:83]
v_pk_mul_f32 v[84:85], v[84:85], s[82:83]
v_pk_mul_f32 v[86:87], v[86:87], s[82:83]
v_exp_f32 v84, v84
v_exp_f32 v85, v85
v_exp_f32 v86, v86
v_exp_f32 v87, v87
s_nop 0
v_pk_add_f32 v[84:85], v[84:85], s[84:85]
v_pk_add_f32 v[86:87], v[86:87], s[84:85]
v_rcp_f32 v84, v84
v_rcp_f32 v85, v85
v_rcp_f32 v86, v86
v_rcp_f32 v87, v87
s_nop 0
v_pk_mul_f32 v[92:93], v[92:93], v[84:85]
v_pk_mul_f32 v[94:95], v[94:95], v[86:87]
v_cvt_pk_bf16_f32 v20, v88, v89
v_cvt_pk_bf16_f32 v21, v90, v91
v_cvt_pk_bf16_f32 v22, v92, v93
v_cvt_pk_bf16_f32 v23, v94, v95
s_nop 1
v_permlane16_swap_b32 v20, v22
v_permlane16_swap_b32 v21, v23
s_nop 0
buffer_store_dwordx4 v[20:23], v3, s[36:39], s60 offen offset:2048 sc1
s_branch k1_kernel_end
k1_kernel_A0:
s_mul_i32 s60, s7, 5
s_mul_i32 s56, s7, 3
s_lshl_b32 s62, s60, 1
s_add_u32 s62, s62, 40
s_mov_b32 s63, s60
s_mul_i32 s64, s4, 3
s_min_u32 s64, s64, 7
s_lshl_b32 s50, s64, 10
s_lshl_b32 s52, s62, 11
s_add_u32 s52, s52, s50
s_sub_u32 s52, s52, 688128
s_mul_i32 s64, s4, 3
s_min_u32 s64, s64, 7
s_lshl_b32 s51, s64, 10
s_lshl_b32 s53, s63, 11
s_add_u32 s53, s53, s51
s_sub_u32 s53, s53, 688128
s_waitcnt lgkmcnt(0)
s_add_u32 s28, s26, 0x1000000
s_addc_u32 s29, s27, 0
s_mov_b32 s30, 0x280000
s_mov_b32 s31, 0x20000
s_add_u32 s32, s26, 0x2000000
s_addc_u32 s33, s27, 0
s_mov_b32 s34, 0x690000
s_mov_b32 s35, 0x20000
s_add_u32 s49, s49, 4096
s_add_u32 m0, s48, 0x5000
s_nop 0
buffer_load_dwordx4 v3, s[28:31], s49 offen offset:0 lds
buffer_load_dwordx4 v3, s[28:31], s49 offen offset:1024 lds
s_add_u32 s52, s52, 688128
s_add_u32 m0, s50, 0x0
s_nop 0
buffer_load_dwordx4 v3, s[32:35], s52 offen offset:0 lds
buffer_load_dwordx4 v3, s[32:35], s52 offen offset:1024 lds
buffer_load_dwordx4 v3, s[32:35], s52 offen offset:2048 lds
s_add_u32 s49, s49, 4096
s_add_u32 m0, s48, 0xe000
s_nop 0
buffer_load_dwordx4 v3, s[28:31], s49 offen offset:0 lds
buffer_load_dwordx4 v3, s[28:31], s49 offen offset:1024 lds
s_add_u32 s52, s52, 688128
s_add_u32 m0, s50, 0x9000
s_nop 0
buffer_load_dwordx4 v3, s[32:35], s52 offen offset:0 lds
buffer_load_dwordx4 v3, s[32:35], s52 offen offset:1024 lds
buffer_load_dwordx4 v3, s[32:35], s52 offen offset:2048 lds
s_add_u32 s49, s49, 4096
s_add_u32 m0, s48, 0x17000
s_nop 0
buffer_load_dwordx4 v3, s[28:31], s49 offen offset:0 lds
buffer_load_dwordx4 v3, s[28:31], s49 offen offset:1024 lds
s_add_u32 s52, s52, 688128
s_add_u32 m0, s50, 0x12000
s_nop 0
buffer_load_dwordx4 v3, s[32:35], s52 offen offset:0 lds
buffer_load_dwordx4 v3, s[32:35], s52 offen offset:1024 lds
buffer_load_dwordx4 v3, s[32:35], s52 offen offset:2048 lds
s_mov_b32 s36, s26
s_mov_b32 s37, s27
s_mov_b32 s38, 0x940000
s_mov_b32 s39, 0x20000
s_add_u32 s40, s26, 0xe00000
s_addc_u32 s41, s27, 0
s_mov_b32 s42, 0xe000
s_mov_b32 s43, 0x20000
s_add_u32 s44, s26, 0x1400000
s_addc_u32 s45, s27, 0
s_mov_b32 s46, 0x100000
s_mov_b32 s47, 0x20000
v_add_u32 v1, 0, v3
s_mov_b32 s80, 0x3fb8aa3b
s_mov_b32 s81, 0x3fb8aa3b
s_mov_b32 s82, 0xbfb8aa3b
s_mov_b32 s83, 0xbfb8aa3b
s_mov_b32 s84, 0x3f800000
s_mov_b32 s85, 0x3f800000
s_mov_b32 s86, 0x358637bd
s_mov_b32 s87, 0x358637bd
v_mov_b32 v60, 0x3f803f80
v_mov_b32 v61, 0x3f803f80
v_mov_b32 v62, 0x3f803f80
v_mov_b32 v63, 0x3f803f80
v_add_u32 v4, 147456, v3
s_cmp_eq_u32 s4, 0
s_cbranch_scc0 Lz_1
s_mov_b64 exec, 0xffff
ds_write_b128 v4, v[60:63]
s_mov_b64 exec, -1
Lz_1:
s_waitcnt lgkmcnt(0)
s_waitcnt vmcnt(10)
s_barrier
ds_read_b128 a[0:3], v2 offset:0
ds_read_b128 a[4:7], v2 offset:1024
ds_read_b128 a[8:11], v2 offset:2048
ds_read_b128 a[12:15], v2 offset:3072
ds_read_b128 v[16:19], v1 offset:0
ds_read_b128 v[20:23], v1 offset:2048
ds_read_b128 v[24:27], v1 offset:4096
ds_read_b128 v[28:31], v1 offset:6144
ds_read_b128 v[32:35], v1 offset:8192
s_waitcnt lgkmcnt(4)
v_mfma_f32_16x16x32_bf16 v[48:51], a[0:3], v[16:19], 0
s_setprio 1
ds_read_b128 v[36:39], v1 offset:1024
v_mfma_f32_16x16x32_bf16 v[52:55], a[4:7], v[16:19], 0
s_setprio 0
s_waitcnt lgkmcnt(4)
v_mfma_f32_16x16x32_bf16 v[56:59], a[0:3], v[20:23], 0
s_setprio 1
ds_read_b128 v[40:43], v1 offset:3072
v_mfma_f32_16x16x32_bf16 v[60:63], a[4:7], v[20:23], 0
s_setprio 0
s_waitcnt lgkmcnt(4)
v_mfma_f32_16x16x32_bf16 v[64:67], a[0:3], v[24:27], 0
s_setprio 1
ds_read_b128 v[44:47], v1 offset:5120
v_mfma_f32_16x16x32_bf16 v[68:71], a[4:7], v[24:27], 0
s_setprio 0
s_waitcnt lgkmcnt(4)
v_mfma_f32_16x16x32_bf16 v[72:75], a[0:3], v[28:31], 0
s_setprio 1
ds_read_b128 v[16:19], v1 offset:7168
v_mfma_f32_16x16x32_bf16 v[76:79], a[4:7], v[28:31], 0
s_setprio 0
s_waitcnt lgkmcnt(4)
v_mfma_f32_16x16x32_bf16 v[80:83], a[0:3], v[32:35], 0
s_setprio 1
ds_read_b128 v[20:23], v1 offset:9216
v_mfma_f32_16x16x32_bf16 v[84:87], a[4:7], v[32:35], 0
s_setprio 0
s_waitcnt vmcnt(5)
s_barrier
s_waitcnt lgkmcnt(4)
v_mfma_f32_16x16x32_bf16 v[48:51], a[8:11], v[36:39], v[48:51]
s_setprio 1
ds_read_b128 v[24:27], v1 offset:36864
ds_read_b128 a[16:19], v2 offset:36864
ds_read_b128 a[20:23], v2 offset:37888
v_mfma_f32_16x16x32_bf16 v[52:55], a[12:15], v[36:39], v[52:55]
s_setprio 0
s_waitcnt lgkmcnt(6)
v_mfma_f32_16x16x32_bf16 v[56:59], a[8:11], v[40:43], v[56:59]
s_setprio 1
ds_read_b128 v[28:31], v1 offset:38912
ds_read_b128 a[24:27], v2 offset:38912
ds_read_b128 a[28:31], v2 offset:39936
v_mfma_f32_16x16x32_bf16 v[60:63], a[12:15], v[40:43], v[60:63]
s_setprio 0
s_add_u32 s49, s49, 4096
s_add_u32 m0, s48, 0x20000
s_nop 0
buffer_load_dwordx4 v3, s[28:31], s49 offen offset:0 lds
buffer_load_dwordx4 v3, s[28:31], s49 offen offset:1024 lds
s_waitcnt lgkmcnt(8)
v_mfma_f32_16x16x32_bf16 v[64:67], a[8:11], v[44:47], v[64:67]
s_setprio 1
ds_read_b128 v[32:35], v1 offset:40960
v_mfma_f32_16x16x32_bf16 v[68:71], a[12:15], v[44:47], v[68:71]
s_setprio 0
s_waitcnt lgkmcnt(8)
v_mfma_f32_16x16x32_bf16 v[72:75], a[8:11], v[16:19], v[72:75]
s_setprio 1
ds_read_b128 v[36:39], v1 offset:43008
v_mfma_f32_16x16x32_bf16 v[76:79], a[12:15], v[16:19], v[76:79]
s_setprio 0
s_waitcnt lgkmcnt(8)
v_mfma_f32_16x16x32_bf16 v[80:83], a[8:11], v[20:23], v[80:83]
s_setprio 1
ds_read_b128 v[40:43], v1 offset:45056
v_mfma_f32_16x16x32_bf16 v[84:87], a[12:15], v[20:23], v[84:87]
s_setprio 0
s_waitcnt lgkmcnt(8)
s_waitcnt lgkmcnt(7)
s_waitcnt lgkmcnt(6)
v_mfma_f32_16x16x32_bf16 v[48:51], a[16:19], v[24:27], v[48:51]
s_setprio 1
ds_read_b128 v[44:47], v1 offset:37888
v_mfma_f32_16x16x32_bf16 v[52:55], a[20:23], v[24:27], v[52:55]
s_setprio 0
s_waitcnt lgkmcnt(6)
v_mfma_f32_16x16x32_bf16 v[56:59], a[16:19], v[28:31], v[56:59]
s_setprio 1
ds_read_b128 v[16:19], v1 offset:39936
v_mfma_f32_16x16x32_bf16 v[60:63], a[20:23], v[28:31], v[60:63]
s_setprio 0
s_add_u32 s52, s52, 688128
s_add_u32 m0, s50, 0x1b000
s_nop 0
buffer_load_dwordx4 v3, s[32:35], s52 offen offset:0 lds
buffer_load_dwordx4 v3, s[32:35], s52 offen offset:1024 lds
buffer_load_dwordx4 v3, s[32:35], s52 offen offset:2048 lds
s_waitcnt lgkmcnt(4)
v_mfma_f32_16x16x32_bf16 v[64:67], a[16:19], v[32:35], v[64:67]
s_setprio 1
ds_read_b128 v[20:23], v1 offset:41984
v_mfma_f32_16x16x32_bf16 v[68:71], a[20:23], v[32:35], v[68:71]
s_setprio 0
s_waitcnt lgkmcnt(4)
v_mfma_f32_16x16x32_bf16 v[72:75], a[16:19], v[36:39], v[72:75]
s_setprio 1
ds_read_b128 v[24:27], v1 offset:44032
v_mfma_f32_16x16x32_bf16 v[76:79], a[20:23], v[36:39], v[76:79]
s_setprio 0
s_waitcnt lgkmcnt(4)
v_mfma_f32_16x16x32_bf16 v[80:83], a[16:19], v[40:43], v[80:83]
s_setprio 1
ds_read_b128 v[28:31], v1 offset:46080
v_mfma_f32_16x16x32_bf16 v[84:87], a[20:23], v[40:43], v[84:87]
s_setprio 0
s_waitcnt vmcnt(5)
s_barrier
s_waitcnt lgkmcnt(4)
v_mfma_f32_16x16x32_bf16 v[48:51], a[24:27], v[44:47], v[48:51]
s_setprio 1
v_add_u32 v1, 0x12000, v1
ds_read_b128 v[32:35], v1 offset:0
v_add_u32 v2, 0x12000, v2
ds_read_b128 a[32:35], v2 offset:0
ds_read_b128 a[36:39], v2 offset:1024
v_mfma_f32_16x16x32_bf16 v[52:55], a[28:31], v[44:47], v[52:55]
s_setprio 0
s_waitcnt lgkmcnt(6)
v_mfma_f32_16x16x32_bf16 v[56:59], a[24:27], v[16:19], v[56:59]
s_setprio 1
ds_read_b128 v[36:39], v1 offset:2048
ds_read_b128 a[40:43], v2 offset:2048
ds_read_b128 a[44:47], v2 offset:3072
v_mfma_f32_16x16x32_bf16 v[60:63], a[28:31], v[16:19], v[60:63]
s_setprio 0
s_add_u32 s49, s49, 4096
s_add_u32 m0, s48, 0x5000
s_nop 0
buffer_load_dwordx4 v3, s[28:31], s49 offen offset:0 lds
buffer_load_dwordx4 v3, s[28:31], s49 offen offset:1024 lds
s_waitcnt lgkmcnt(8)
v_mfma_f32_16x16x32_bf16 v[64:67], a[24:27], v[20:23], v[64:67]
s_setprio 1
ds_read_b128 v[40:43], v1 offset:4096
v_mfma_f32_16x16x32_bf16 v[68:71], a[28:31], v[20:23], v[68:71]
s_setprio 0
s_waitcnt lgkmcnt(8)
v_mfma_f32_16x16x32_bf16 v[72:75], a[24:27], v[24:27], v[72:75]
s_setprio 1
ds_read_b128 v[44:47], v1 offset:6144
v_mfma_f32_16x16x32_bf16 v[76:79], a[28:31], v[24:27], v[76:79]
s_setprio 0
s_waitcnt lgkmcnt(8)
v_mfma_f32_16x16x32_bf16 v[80:83], a[24:27], v[28:31], v[80:83]
s_setprio 1
ds_read_b128 v[16:19], v1 offset:8192
v_mfma_f32_16x16x32_bf16 v[84:87], a[28:31], v[28:31], v[84:87]
s_setprio 0
s_waitcnt lgkmcnt(8)
s_waitcnt lgkmcnt(7)
s_waitcnt lgkmcnt(6)
v_mfma_f32_16x16x32_bf16 v[48:51], a[32:35], v[32:35], v[48:51]
s_setprio 1
ds_read_b128 v[20:23], v1 offset:1024
v_mfma_f32_16x16x32_bf16 v[52:55], a[36:39], v[32:35], v[52:55]
s_setprio 0
s_waitcnt lgkmcnt(6)
v_mfma_f32_16x16x32_bf16 v[56:59], a[32:35], v[36:39], v[56:59]
s_setprio 1
ds_read_b128 v[24:27], v1 offset:3072
v_mfma_f32_16x16x32_bf16 v[60:63], a[36:39], v[36:39], v[60:63]
s_setprio 0
s_add_u32 s52, s52, 688128
s_add_u32 m0, s50, 0x0
s_nop 0
buffer_load_dwordx4 v3, s[32:35], s52 offen offset:0 lds
buffer_load_dwordx4 v3, s[32:35], s52 offen offset:1024 lds
buffer_load_dwordx4 v3, s[32:35], s52 offen offset:2048 lds
s_waitcnt lgkmcnt(4)
v_mfma_f32_16x16x32_bf16 v[64:67], a[32:35], v[40:43], v[64:67]
s_setprio 1
ds_read_b128 v[28:31], v1 offset:5120
v_mfma_f32_16x16x32_bf16 v[68:71], a[36:39], v[40:43], v[68:71]
s_setprio 0
s_waitcnt lgkmcnt(4)
v_mfma_f32_16x16x32_bf16 v[72:75], a[32:35], v[44:47], v[72:75]
s_setprio 1
ds_read_b128 v[32:35], v1 offset:7168
v_mfma_f32_16x16x32_bf16 v[76:79], a[36:39], v[44:47], v[76:79]
s_setprio 0
s_waitcnt lgkmcnt(4)
v_mfma_f32_16x16x32_bf16 v[80:83], a[32:35], v[16:19], v[80:83]
s_setprio 1
ds_read_b128 v[36:39], v1 offset:9216
v_mfma_f32_16x16x32_bf16 v[84:87], a[36:39], v[16:19], v[84:87]
s_setprio 0
s_waitcnt vmcnt(5)
s_barrier
s_waitcnt lgkmcnt(4)
v_mfma_f32_16x16x32_bf16 v[48:51], a[40:43], v[20:23], v[48:51]
s_setprio 1
ds_read_b128 v[40:43], v1 offset:36864
ds_read_b128 a[48:51], v2 offset:36864
ds_read_b128 a[52:55], v2 offset:37888
v_mfma_f32_16x16x32_bf16 v[52:55], a[44:47], v[20:23], v[52:55]
s_setprio 0
s_waitcnt lgkmcnt(6)
v_mfma_f32_16x16x32_bf16 v[56:59], a[40:43], v[24:27], v[56:59]
s_setprio 1
ds_read_b128 v[44:47], v1 offset:38912
ds_read_b128 a[56:59], v2 offset:38912
ds_read_b128 a[60:63], v2 offset:39936
v_mfma_f32_16x16x32_bf16 v[60:63], a[44:47], v[24:27], v[60:63]
s_setprio 0
s_add_u32 s49, s49, 4096
s_add_u32 m0, s48, 0xe000
s_nop 0
buffer_load_dwordx4 v3, s[28:31], s49 offen offset:0 lds
buffer_load_dwordx4 v3, s[28:31], s49 offen offset:1024 lds
s_waitcnt lgkmcnt(8)
v_mfma_f32_16x16x32_bf16 v[64:67], a[40:43], v[28:31], v[64:67]
s_setprio 1
ds_read_b128 v[16:19], v1 offset:40960
v_mfma_f32_16x16x32_bf16 v[68:71], a[44:47], v[28:31], v[68:71]
s_setprio 0
s_waitcnt lgkmcnt(8)
v_mfma_f32_16x16x32_bf16 v[72:75], a[40:43], v[32:35], v[72:75]
s_setprio 1
ds_read_b128 v[20:23], v1 offset:43008
v_mfma_f32_16x16x32_bf16 v[76:79], a[44:47], v[32:35], v[76:79]
s_setprio 0
s_waitcnt lgkmcnt(8)
v_mfma_f32_16x16x32_bf16 v[80:83], a[40:43], v[36:39], v[80:83]
s_setprio 1
ds_read_b128 v[24:27], v1 offset:45056
v_mfma_f32_16x16x32_bf16 v[84:87], a[44:47], v[36:39], v[84:87]
s_setprio 0
s_waitcnt lgkmcnt(8)
s_waitcnt lgkmcnt(7)
s_waitcnt lgkmcnt(6)
v_mfma_f32_16x16x32_bf16 v[48:51], a[48:51], v[40:43], v[48:51]
s_setprio 1
ds_read_b128 v[28:31], v1 offset:37888
v_mfma_f32_16x16x32_bf16 v[52:55], a[52:55], v[40:43], v[52:55]
s_setprio 0
s_waitcnt lgkmcnt(6)
v_mfma_f32_16x16x32_bf16 v[56:59], a[48:51], v[44:47], v[56:59]
s_setprio 1
ds_read_b128 v[32:35], v1 offset:39936
v_mfma_f32_16x16x32_bf16 v[60:63], a[52:55], v[44:47], v[60:63]
s_setprio 0
s_add_u32 s52, s52, 688128
s_add_u32 m0, s50, 0x9000
s_nop 0
buffer_load_dwordx4 v3, s[32:35], s52 offen offset:0 lds
buffer_load_dwordx4 v3, s[32:35], s52 offen offset:1024 lds
buffer_load_dwordx4 v3, s[32:35], s52 offen offset:2048 lds
s_waitcnt lgkmcnt(4)
v_mfma_f32_16x16x32_bf16 v[64:67], a[48:51], v[16:19], v[64:67]
s_setprio 1
ds_read_b128 v[36:39], v1 offset:41984
v_mfma_f32_16x16x32_bf16 v[68:71], a[52:55], v[16:19], v[68:71]
s_setprio 0
s_waitcnt lgkmcnt(4)
v_mfma_f32_16x16x32_bf16 v[72:75], a[48:51], v[20:23], v[72:75]
s_setprio 1
ds_read_b128 v[40:43], v1 offset:44032
v_mfma_f32_16x16x32_bf16 v[76:79], a[52:55], v[20:23], v[76:79]
s_setprio 0
s_waitcnt lgkmcnt(4)
v_mfma_f32_16x16x32_bf16 v[80:83], a[48:51], v[24:27], v[80:83]
s_setprio 1
ds_read_b128 v[44:47], v1 offset:46080
v_mfma_f32_16x16x32_bf16 v[84:87], a[52:55], v[24:27], v[84:87]
s_setprio 0
s_waitcnt vmcnt(5)
s_barrier
s_waitcnt lgkmcnt(4)
v_mfma_f32_16x16x32_bf16 v[48:51], a[56:59], v[28:31], v[48:51]
s_setprio 1
v_add_u32 v1, 0xfffee000, v1
ds_read_b128 v[16:19], v1 offset:0
v_add_u32 v2, 0xfffee000, v2
ds_read_b128 a[64:67], v2 offset:0
ds_read_b128 a[68:71], v2 offset:1024
v_mfma_f32_16x16x32_bf16 v[52:55], a[60:63], v[28:31], v[52:55]
s_setprio 0
s_waitcnt lgkmcnt(6)
v_mfma_f32_16x16x32_bf16 v[56:59], a[56:59], v[32:35], v[56:59]
s_setprio 1
ds_read_b128 v[20:23], v1 offset:2048
ds_read_b128 a[72:75], v2 offset:2048
ds_read_b128 a[76:79], v2 offset:3072
v_mfma_f32_16x16x32_bf16 v[60:63], a[60:63], v[32:35], v[60:63]
s_setprio 0
s_add_u32 s49, s49, 4096
s_add_u32 m0, s48, 0x17000
s_nop 0
buffer_load_dwordx4 v3, s[28:31], s49 offen offset:0 lds
buffer_load_dwordx4 v3, s[28:31], s49 offen offset:1024 lds
s_waitcnt lgkmcnt(8)
v_mfma_f32_16x16x32_bf16 v[64:67], a[56:59], v[36:39], v[64:67]
s_setprio 1
ds_read_b128 v[24:27], v1 offset:4096
v_mfma_f32_16x16x32_bf16 v[68:71], a[60:63], v[36:39], v[68:71]
s_setprio 0
s_waitcnt lgkmcnt(8)
v_mfma_f32_16x16x32_bf16 v[72:75], a[56:59], v[40:43], v[72:75]
s_setprio 1
ds_read_b128 v[28:31], v1 offset:6144
v_mfma_f32_16x16x32_bf16 v[76:79], a[60:63], v[40:43], v[76:79]
s_setprio 0
s_waitcnt lgkmcnt(8)
v_mfma_f32_16x16x32_bf16 v[80:83], a[56:59], v[44:47], v[80:83]
s_setprio 1
ds_read_b128 v[32:35], v1 offset:8192
v_mfma_f32_16x16x32_bf16 v[84:87], a[60:63], v[44:47], v[84:87]
s_setprio 0
s_waitcnt lgkmcnt(8)
s_waitcnt lgkmcnt(7)
s_waitcnt lgkmcnt(6)
v_mfma_f32_16x16x32_bf16 v[48:51], a[64:67], v[16:19], v[48:51]
s_setprio 1
ds_read_b128 v[36:39], v1 offset:1024
v_mfma_f32_16x16x32_bf16 v[52:55], a[68:71], v[16:19], v[52:55]
s_setprio 0
s_waitcnt lgkmcnt(6)
v_mfma_f32_16x16x32_bf16 v[56:59], a[64:67], v[20:23], v[56:59]
s_setprio 1
ds_read_b128 v[40:43], v1 offset:3072
v_mfma_f32_16x16x32_bf16 v[60:63], a[68:71], v[20:23], v[60:63]
s_setprio 0
s_add_u32 s52, s52, 688128
s_add_u32 m0, s50, 0x12000
s_nop 0
buffer_load_dwordx4 v3, s[32:35], s52 offen offset:0 lds
buffer_load_dwordx4 v3, s[32:35], s52 offen offset:1024 lds
buffer_load_dwordx4 v3, s[32:35], s52 offen offset:2048 lds
s_waitcnt lgkmcnt(4)
v_mfma_f32_16x16x32_bf16 v[64:67], a[64:67], v[24:27], v[64:67]
s_setprio 1
ds_read_b128 v[44:47], v1 offset:5120
v_mfma_f32_16x16x32_bf16 v[68:71], a[68:71], v[24:27], v[68:71]
s_setprio 0
s_waitcnt lgkmcnt(4)
v_mfma_f32_16x16x32_bf16 v[72:75], a[64:67], v[28:31], v[72:75]
s_setprio 1
ds_read_b128 v[16:19], v1 offset:7168
v_mfma_f32_16x16x32_bf16 v[76:79], a[68:71], v[28:31], v[76:79]
s_setprio 0
s_waitcnt lgkmcnt(4)
v_mfma_f32_16x16x32_bf16 v[80:83], a[64:67], v[32:35], v[80:83]
s_setprio 1
ds_read_b128 v[20:23], v1 offset:9216
v_mfma_f32_16x16x32_bf16 v[84:87], a[68:71], v[32:35], v[84:87]
s_setprio 0
s_waitcnt vmcnt(5)
s_barrier
s_waitcnt lgkmcnt(4)
v_mfma_f32_16x16x32_bf16 v[48:51], a[72:75], v[36:39], v[48:51]
s_setprio 1
ds_read_b128 v[24:27], v1 offset:36864
ds_read_b128 a[80:83], v2 offset:36864
ds_read_b128 a[84:87], v2 offset:37888
v_mfma_f32_16x16x32_bf16 v[52:55], a[76:79], v[36:39], v[52:55]
s_setprio 0
s_waitcnt lgkmcnt(6)
v_mfma_f32_16x16x32_bf16 v[56:59], a[72:75], v[40:43], v[56:59]
s_setprio 1
ds_read_b128 v[28:31], v1 offset:38912
ds_read_b128 a[88:91], v2 offset:38912
ds_read_b128 a[92:95], v2 offset:39936
v_mfma_f32_16x16x32_bf16 v[60:63], a[76:79], v[40:43], v[60:63]
s_setprio 0
s_add_u32 s49, s49, 4096
s_add_u32 m0, s48, 0x20000
s_nop 0
buffer_load_dwordx4 v3, s[28:31], s49 offen offset:0 lds
buffer_load_dwordx4 v3, s[28:31], s49 offen offset:1024 lds
s_waitcnt lgkmcnt(8)
v_mfma_f32_16x16x32_bf16 v[64:67], a[72:75], v[44:47], v[64:67]
s_setprio 1
ds_read_b128 v[32:35], v1 offset:40960
v_mfma_f32_16x16x32_bf16 v[68:71], a[76:79], v[44:47], v[68:71]
s_setprio 0
s_waitcnt lgkmcnt(8)
v_mfma_f32_16x16x32_bf16 v[72:75], a[72:75], v[16:19], v[72:75]
s_setprio 1
ds_read_b128 v[36:39], v1 offset:43008
v_mfma_f32_16x16x32_bf16 v[76:79], a[76:79], v[16:19], v[76:79]
s_setprio 0
s_waitcnt lgkmcnt(8)
v_mfma_f32_16x16x32_bf16 v[80:83], a[72:75], v[20:23], v[80:83]
s_setprio 1
ds_read_b128 v[40:43], v1 offset:45056
v_mfma_f32_16x16x32_bf16 v[84:87], a[76:79], v[20:23], v[84:87]
s_setprio 0
s_waitcnt lgkmcnt(8)
s_waitcnt lgkmcnt(7)
s_waitcnt lgkmcnt(6)
v_mfma_f32_16x16x32_bf16 v[48:51], a[80:83], v[24:27], v[48:51]
s_setprio 1
ds_read_b128 v[44:47], v1 offset:37888
v_mfma_f32_16x16x32_bf16 v[52:55], a[84:87], v[24:27], v[52:55]
s_setprio 0
s_waitcnt lgkmcnt(6)
v_mfma_f32_16x16x32_bf16 v[56:59], a[80:83], v[28:31], v[56:59]
s_setprio 1
ds_read_b128 v[16:19], v1 offset:39936
v_mfma_f32_16x16x32_bf16 v[60:63], a[84:87], v[28:31], v[60:63]
s_setprio 0
s_add_u32 s52, s52, 688128
s_add_u32 m0, s50, 0x1b000
s_nop 0
buffer_load_dwordx4 v3, s[32:35], s52 offen offset:0 lds
buffer_load_dwordx4 v3, s[32:35], s52 offen offset:1024 lds
buffer_load_dwordx4 v3, s[32:35], s52 offen offset:2048 lds
s_waitcnt lgkmcnt(4)
v_mfma_f32_16x16x32_bf16 v[64:67], a[80:83], v[32:35], v[64:67]
s_setprio 1
ds_read_b128 v[20:23], v1 offset:41984
v_mfma_f32_16x16x32_bf16 v[68:71], a[84:87], v[32:35], v[68:71]
s_setprio 0
s_waitcnt lgkmcnt(4)
v_mfma_f32_16x16x32_bf16 v[72:75], a[80:83], v[36:39], v[72:75]
s_setprio 1
ds_read_b128 v[24:27], v1 offset:44032
v_mfma_f32_16x16x32_bf16 v[76:79], a[84:87], v[36:39], v[76:79]
s_setprio 0
s_waitcnt lgkmcnt(4)
v_mfma_f32_16x16x32_bf16 v[80:83], a[80:83], v[40:43], v[80:83]
s_setprio 1
ds_read_b128 v[28:31], v1 offset:46080
v_mfma_f32_16x16x32_bf16 v[84:87], a[84:87], v[40:43], v[84:87]
s_setprio 0
s_waitcnt vmcnt(5)
s_barrier
s_waitcnt lgkmcnt(4)
v_mfma_f32_16x16x32_bf16 v[48:51], a[88:91], v[44:47], v[48:51]
s_setprio 1
v_add_u32 v1, 0x12000, v1
ds_read_b128 v[32:35], v1 offset:0
v_add_u32 v2, 0x12000, v2
ds_read_b128 a[96:99], v2 offset:0
ds_read_b128 a[100:103], v2 offset:1024
v_mfma_f32_16x16x32_bf16 v[52:55], a[92:95], v[44:47], v[52:55]
s_setprio 0
s_waitcnt lgkmcnt(6)
v_mfma_f32_16x16x32_bf16 v[56:59], a[88:91], v[16:19], v[56:59]
s_setprio 1
ds_read_b128 v[36:39], v1 offset:2048
ds_read_b128 a[104:107], v2 offset:2048
ds_read_b128 a[108:111], v2 offset:3072
v_mfma_f32_16x16x32_bf16 v[60:63], a[92:95], v[16:19], v[60:63]
s_setprio 0
s_add_u32 s49, s49, 4096
s_add_u32 m0, s48, 0x5000
s_nop 0
buffer_load_dwordx4 v3, s[28:31], s49 offen offset:0 lds
buffer_load_dwordx4 v3, s[28:31], s49 offen offset:1024 lds
s_waitcnt lgkmcnt(8)
v_mfma_f32_16x16x32_bf16 v[64:67], a[88:91], v[20:23], v[64:67]
s_setprio 1
ds_read_b128 v[40:43], v1 offset:4096
v_mfma_f32_16x16x32_bf16 v[68:71], a[92:95], v[20:23], v[68:71]
s_setprio 0
s_waitcnt lgkmcnt(8)
v_mfma_f32_16x16x32_bf16 v[72:75], a[88:91], v[24:27], v[72:75]
s_setprio 1
ds_read_b128 v[44:47], v1 offset:6144
v_mfma_f32_16x16x32_bf16 v[76:79], a[92:95], v[24:27], v[76:79]
s_setprio 0
s_waitcnt lgkmcnt(8)
v_mfma_f32_16x16x32_bf16 v[80:83], a[88:91], v[28:31], v[80:83]
s_setprio 1
ds_read_b128 v[16:19], v1 offset:8192
v_mfma_f32_16x16x32_bf16 v[84:87], a[92:95], v[28:31], v[84:87]
s_setprio 0
s_waitcnt lgkmcnt(8)
s_waitcnt lgkmcnt(7)
s_waitcnt lgkmcnt(6)
v_mfma_f32_16x16x32_bf16 v[48:51], a[96:99], v[32:35], v[48:51]
s_setprio 1
ds_read_b128 v[20:23], v1 offset:1024
v_mfma_f32_16x16x32_bf16 v[52:55], a[100:103], v[32:35], v[52:55]
s_setprio 0
s_waitcnt lgkmcnt(6)
v_mfma_f32_16x16x32_bf16 v[56:59], a[96:99], v[36:39], v[56:59]
s_setprio 1
ds_read_b128 v[24:27], v1 offset:3072
v_mfma_f32_16x16x32_bf16 v[60:63], a[100:103], v[36:39], v[60:63]
s_setprio 0
s_add_u32 s52, s52, 688128
s_add_u32 m0, s50, 0x0
s_nop 0
buffer_load_dwordx4 v3, s[32:35], s52 offen offset:0 lds
buffer_load_dwordx4 v3, s[32:35], s52 offen offset:1024 lds
buffer_load_dwordx4 v3, s[32:35], s52 offen offset:2048 lds
s_waitcnt lgkmcnt(4)
v_mfma_f32_16x16x32_bf16 v[64:67], a[96:99], v[40:43], v[64:67]
s_setprio 1
ds_read_b128 v[28:31], v1 offset:5120
v_mfma_f32_16x16x32_bf16 v[68:71], a[100:103], v[40:43], v[68:71]
s_setprio 0
s_waitcnt lgkmcnt(4)
v_mfma_f32_16x16x32_bf16 v[72:75], a[96:99], v[44:47], v[72:75]
s_setprio 1
ds_read_b128 v[32:35], v1 offset:7168
v_mfma_f32_16x16x32_bf16 v[76:79], a[100:103], v[44:47], v[76:79]
s_setprio 0
s_waitcnt lgkmcnt(4)
v_mfma_f32_16x16x32_bf16 v[80:83], a[96:99], v[16:19], v[80:83]
s_setprio 1
ds_read_b128 v[36:39], v1 offset:9216
v_mfma_f32_16x16x32_bf16 v[84:87], a[100:103], v[16:19], v[84:87]
s_setprio 0
s_waitcnt vmcnt(5)
s_barrier
s_waitcnt lgkmcnt(4)
v_mfma_f32_16x16x32_bf16 v[48:51], a[104:107], v[20:23], v[48:51]
s_setprio 1
ds_read_b128 v[40:43], v1 offset:36864
ds_read_b128 a[112:115], v2 offset:36864
ds_read_b128 a[116:119], v2 offset:37888
v_mfma_f32_16x16x32_bf16 v[52:55], a[108:111], v[20:23], v[52:55]
s_setprio 0
s_waitcnt lgkmcnt(6)
v_mfma_f32_16x16x32_bf16 v[56:59], a[104:107], v[24:27], v[56:59]
s_setprio 1
ds_read_b128 v[44:47], v1 offset:38912
ds_read_b128 a[120:123], v2 offset:38912
ds_read_b128 a[124:127], v2 offset:39936
v_mfma_f32_16x16x32_bf16 v[60:63], a[108:111], v[24:27], v[60:63]
s_setprio 0
s_add_u32 s49, s49, 4096
s_add_u32 m0, s48, 0xe000
s_nop 0
buffer_load_dwordx4 v3, s[28:31], s49 offen offset:0 lds
buffer_load_dwordx4 v3, s[28:31], s49 offen offset:1024 lds
s_waitcnt lgkmcnt(8)
v_mfma_f32_16x16x32_bf16 v[64:67], a[104:107], v[28:31], v[64:67]
s_setprio 1
ds_read_b128 v[16:19], v1 offset:40960
v_mfma_f32_16x16x32_bf16 v[68:71], a[108:111], v[28:31], v[68:71]
s_setprio 0
s_waitcnt lgkmcnt(8)
v_mfma_f32_16x16x32_bf16 v[72:75], a[104:107], v[32:35], v[72:75]
s_setprio 1
ds_read_b128 v[20:23], v1 offset:43008
v_mfma_f32_16x16x32_bf16 v[76:79], a[108:111], v[32:35], v[76:79]
s_setprio 0
s_waitcnt lgkmcnt(8)
v_mfma_f32_16x16x32_bf16 v[80:83], a[104:107], v[36:39], v[80:83]
s_setprio 1
ds_read_b128 v[24:27], v1 offset:45056
v_mfma_f32_16x16x32_bf16 v[84:87], a[108:111], v[36:39], v[84:87]
s_setprio 0
s_waitcnt lgkmcnt(8)
s_waitcnt lgkmcnt(7)
s_waitcnt lgkmcnt(6)
v_mfma_f32_16x16x32_bf16 v[48:51], a[112:115], v[40:43], v[48:51]
s_setprio 1
ds_read_b128 v[28:31], v1 offset:37888
v_mfma_f32_16x16x32_bf16 v[52:55], a[116:119], v[40:43], v[52:55]
s_setprio 0
s_waitcnt lgkmcnt(6)
v_mfma_f32_16x16x32_bf16 v[56:59], a[112:115], v[44:47], v[56:59]
s_setprio 1
ds_read_b128 v[32:35], v1 offset:39936
v_mfma_f32_16x16x32_bf16 v[60:63], a[116:119], v[44:47], v[60:63]
s_setprio 0
s_add_u32 s52, s52, 688128
s_add_u32 m0, s50, 0x9000
s_nop 0
buffer_load_dwordx4 v3, s[32:35], s52 offen offset:0 lds
buffer_load_dwordx4 v3, s[32:35], s52 offen offset:1024 lds
buffer_load_dwordx4 v3, s[32:35], s52 offen offset:2048 lds
s_waitcnt lgkmcnt(4)
v_mfma_f32_16x16x32_bf16 v[64:67], a[112:115], v[16:19], v[64:67]
s_setprio 1
ds_read_b128 v[36:39], v1 offset:41984
v_mfma_f32_16x16x32_bf16 v[68:71], a[116:119], v[16:19], v[68:71]
s_setprio 0
s_waitcnt lgkmcnt(4)
v_mfma_f32_16x16x32_bf16 v[72:75], a[112:115], v[20:23], v[72:75]
s_setprio 1
ds_read_b128 v[40:43], v1 offset:44032
v_mfma_f32_16x16x32_bf16 v[76:79], a[116:119], v[20:23], v[76:79]
s_setprio 0
s_waitcnt lgkmcnt(4)
v_mfma_f32_16x16x32_bf16 v[80:83], a[112:115], v[24:27], v[80:83]
s_setprio 1
ds_read_b128 v[44:47], v1 offset:46080
v_mfma_f32_16x16x32_bf16 v[84:87], a[116:119], v[24:27], v[84:87]
s_setprio 0
s_waitcnt vmcnt(5)
s_barrier
s_waitcnt lgkmcnt(4)
v_mfma_f32_16x16x32_bf16 v[48:51], a[120:123], v[28:31], v[48:51]
s_setprio 1
v_add_u32 v1, 0xfffee000, v1
ds_read_b128 v[16:19], v1 offset:0
v_add_u32 v2, 0xfffee000, v2
ds_read_b128 a[128:131], v2 offset:0
ds_read_b128 a[132:135], v2 offset:1024
v_mfma_f32_16x16x32_bf16 v[52:55], a[124:127], v[28:31], v[52:55]
s_setprio 0
s_waitcnt lgkmcnt(6)
v_mfma_f32_16x16x32_bf16 v[56:59], a[120:123], v[32:35], v[56:59]
s_setprio 1
ds_read_b128 v[20:23], v1 offset:2048
ds_read_b128 a[136:139], v2 offset:2048
ds_read_b128 a[140:143], v2 offset:3072
v_mfma_f32_16x16x32_bf16 v[60:63], a[124:127], v[32:35], v[60:63]
s_setprio 0
s_add_u32 s53, s53, 688128
s_add_u32 m0, s51, 0x12000
s_nop 0
buffer_load_dwordx4 v3, s[32:35], s53 offen offset:0 lds
buffer_load_dwordx4 v3, s[32:35], s53 offen offset:1024 lds
buffer_load_dwordx4 v3, s[32:35], s53 offen offset:2048 lds
s_waitcnt lgkmcnt(8)
v_mfma_f32_16x16x32_bf16 v[64:67], a[120:123], v[36:39], v[64:67]
s_setprio 1
ds_read_b128 v[24:27], v1 offset:4096
v_mfma_f32_16x16x32_bf16 v[68:71], a[124:127], v[36:39], v[68:71]
s_setprio 0
s_waitcnt lgkmcnt(8)
v_mfma_f32_16x16x32_bf16 v[72:75], a[120:123], v[40:43], v[72:75]
s_setprio 1
ds_read_b128 v[28:31], v1 offset:6144
v_mfma_f32_16x16x32_bf16 v[76:79], a[124:127], v[40:43], v[76:79]
s_setprio 0
s_waitcnt lgkmcnt(8)
v_mfma_f32_16x16x32_bf16 v[80:83], a[120:123], v[44:47], v[80:83]
s_setprio 1
ds_read_b128 v[32:35], v1 offset:8192
v_mfma_f32_16x16x32_bf16 v[84:87], a[124:127], v[44:47], v[84:87]
s_setprio 0
s_waitcnt lgkmcnt(8)
s_waitcnt lgkmcnt(7)
s_waitcnt lgkmcnt(6)
v_mfma_f32_16x16x32_bf16 v[48:51], a[128:131], v[16:19], v[48:51]
s_setprio 1
ds_read_b128 v[36:39], v1 offset:1024
v_mfma_f32_16x16x32_bf16 v[52:55], a[132:135], v[16:19], v[52:55]
s_setprio 0
s_waitcnt lgkmcnt(6)
v_mfma_f32_16x16x32_bf16 v[56:59], a[128:131], v[20:23], v[56:59]
s_setprio 1
ds_read_b128 v[40:43], v1 offset:3072
v_mfma_f32_16x16x32_bf16 v[60:63], a[132:135], v[20:23], v[60:63]
s_setprio 0
s_waitcnt lgkmcnt(4)
v_mfma_f32_16x16x32_bf16 v[64:67], a[128:131], v[24:27], v[64:67]
s_setprio 1
ds_read_b128 v[44:47], v1 offset:5120
v_mfma_f32_16x16x32_bf16 v[68:71], a[132:135], v[24:27], v[68:71]
s_setprio 0
s_waitcnt lgkmcnt(4)
v_mfma_f32_16x16x32_bf16 v[72:75], a[128:131], v[28:31], v[72:75]
s_setprio 1
ds_read_b128 v[16:19], v1 offset:7168
v_mfma_f32_16x16x32_bf16 v[76:79], a[132:135], v[28:31], v[76:79]
s_setprio 0
s_waitcnt lgkmcnt(4)
v_mfma_f32_16x16x32_bf16 v[80:83], a[128:131], v[32:35], v[80:83]
s_setprio 1
ds_read_b128 v[20:23], v1 offset:9216
v_mfma_f32_16x16x32_bf16 v[84:87], a[132:135], v[32:35], v[84:87]
s_setprio 0
s_waitcnt vmcnt(3)
s_barrier
s_waitcnt lgkmcnt(4)
v_mfma_f32_16x16x32_bf16 v[48:51], a[136:139], v[36:39], v[48:51]
s_setprio 1
ds_read_b128 v[24:27], v1 offset:36864
ds_read_b128 a[144:147], v2 offset:36864
ds_read_b128 a[148:151], v2 offset:37888
v_mfma_f32_16x16x32_bf16 v[52:55], a[140:143], v[36:39], v[52:55]
s_setprio 0
s_waitcnt lgkmcnt(6)
v_mfma_f32_16x16x32_bf16 v[56:59], a[136:139], v[40:43], v[56:59]
s_setprio 1
ds_read_b128 v[28:31], v1 offset:38912
ds_read_b128 a[152:155], v2 offset:38912
ds_read_b128 a[156:159], v2 offset:39936
v_mfma_f32_16x16x32_bf16 v[60:63], a[140:143], v[40:43], v[60:63]
s_setprio 0
s_add_u32 s53, s53, 688128
s_add_u32 m0, s51, 0x1e000
s_nop 0
buffer_load_dwordx4 v3, s[32:35], s53 offen offset:0 lds
buffer_load_dwordx4 v3, s[32:35], s53 offen offset:1024 lds
buffer_load_dwordx4 v3, s[32:35], s53 offen offset:2048 lds
s_waitcnt lgkmcnt(8)
v_mfma_f32_16x16x32_bf16 v[64:67], a[136:139], v[44:47], v[64:67]
s_setprio 1
ds_read_b128 v[32:35], v1 offset:40960
v_mfma_f32_16x16x32_bf16 v[68:71], a[140:143], v[44:47], v[68:71]
s_setprio 0
s_waitcnt lgkmcnt(8)
v_mfma_f32_16x16x32_bf16 v[72:75], a[136:139], v[16:19], v[72:75]
s_setprio 1
ds_read_b128 v[36:39], v1 offset:43008
v_mfma_f32_16x16x32_bf16 v[76:79], a[140:143], v[16:19], v[76:79]
s_setprio 0
s_waitcnt lgkmcnt(8)
v_mfma_f32_16x16x32_bf16 v[80:83], a[136:139], v[20:23], v[80:83]
s_setprio 1
ds_read_b128 v[40:43], v1 offset:45056
v_mfma_f32_16x16x32_bf16 v[84:87], a[140:143], v[20:23], v[84:87]
s_setprio 0
s_waitcnt lgkmcnt(8)
s_waitcnt lgkmcnt(7)
s_waitcnt lgkmcnt(6)
v_mfma_f32_16x16x32_bf16 v[48:51], a[144:147], v[24:27], v[48:51]
s_setprio 1
ds_read_b128 v[44:47], v1 offset:37888
v_mfma_f32_16x16x32_bf16 v[52:55], a[148:151], v[24:27], v[52:55]
s_setprio 0
s_waitcnt lgkmcnt(6)
v_mfma_f32_16x16x32_bf16 v[56:59], a[144:147], v[28:31], v[56:59]
s_setprio 1
ds_read_b128 v[16:19], v1 offset:39936
v_mfma_f32_16x16x32_bf16 v[60:63], a[148:151], v[28:31], v[60:63]
s_setprio 0
s_waitcnt lgkmcnt(4)
v_mfma_f32_16x16x32_bf16 v[64:67], a[144:147], v[32:35], v[64:67]
s_setprio 1
ds_read_b128 v[20:23], v1 offset:41984
v_mfma_f32_16x16x32_bf16 v[68:71], a[148:151], v[32:35], v[68:71]
s_setprio 0
s_waitcnt lgkmcnt(4)
v_mfma_f32_16x16x32_bf16 v[72:75], a[144:147], v[36:39], v[72:75]
s_setprio 1
ds_read_b128 v[24:27], v1 offset:44032
v_mfma_f32_16x16x32_bf16 v[76:79], a[148:151], v[36:39], v[76:79]
s_setprio 0
s_waitcnt lgkmcnt(4)
v_mfma_f32_16x16x32_bf16 v[80:83], a[144:147], v[40:43], v[80:83]
s_setprio 1
ds_read_b128 v[28:31], v1 offset:46080
v_mfma_f32_16x16x32_bf16 v[84:87], a[148:151], v[40:43], v[84:87]
s_setprio 0
s_waitcnt vmcnt(3)
s_barrier
s_waitcnt lgkmcnt(4)
v_mfma_f32_16x16x32_bf16 v[48:51], a[152:155], v[44:47], v[48:51]
s_setprio 1
v_mfma_f32_16x16x32_bf16 v[52:55], a[156:159], v[44:47], v[52:55]
s_setprio 0
s_waitcnt lgkmcnt(3)
v_mfma_f32_16x16x32_bf16 v[56:59], a[152:155], v[16:19], v[56:59]
s_setprio 1
v_mfma_f32_16x16x32_bf16 v[60:63], a[156:159], v[16:19], v[60:63]
s_setprio 0
s_add_u32 s53, s53, 688128
s_add_u32 m0, s51, 0x0
s_nop 0
buffer_load_dwordx4 v3, s[32:35], s53 offen offset:0 lds
buffer_load_dwordx4 v3, s[32:35], s53 offen offset:1024 lds
buffer_load_dwordx4 v3, s[32:35], s53 offen offset:2048 lds
s_waitcnt lgkmcnt(2)
v_mfma_f32_16x16x32_bf16 v[64:67], a[152:155], v[20:23], v[64:67]
s_setprio 1
v_mfma_f32_16x16x32_bf16 v[68:71], a[156:159], v[20:23], v[68:71]
s_setprio 0
s_waitcnt lgkmcnt(1)
v_mfma_f32_16x16x32_bf16 v[72:75], a[152:155], v[24:27], v[72:75]
s_setprio 1
v_mfma_f32_16x16x32_bf16 v[76:79], a[156:159], v[24:27], v[76:79]
s_setprio 0
s_waitcnt lgkmcnt(0)
v_mfma_f32_16x16x32_bf16 v[80:83], a[152:155], v[28:31], v[80:83]
s_setprio 1
v_mfma_f32_16x16x32_bf16 v[84:87], a[156:159], v[28:31], v[84:87]
s_setprio 0
s_nop 5
s_barrier
v_bfe_u32 v5, v3, 4, 4
s_movk_i32 s60, 272
v_mul_lo_u32 v5, v5, s60
v_lshrrev_b32 v6, 8, v3
v_lshl_add_u32 v5, v6, 3, v5
s_lshl_b32 s60, s4, 6
s_add_u32 s60, s60, 24576
v_add_u32 v5, s60, v5
v_pk_mul_f32 v[16:17], v[48:49], s[80:81]
v_pk_mul_f32 v[18:19], v[50:51], s[80:81]
v_exp_f32_e64 v16, v16 clamp
v_exp_f32_e64 v17, v17 clamp
v_exp_f32_e64 v18, v18 clamp
v_exp_f32_e64 v19, v19 clamp
v_pk_add_f32 v[48:49], v[48:49], s[86:87]
v_pk_add_f32 v[50:51], v[50:51], s[86:87]
v_max_f32 v48, s86, v48
v_max_f32 v49, s86, v49
v_max_f32 v50, s86, v50
v_max_f32 v51, s86, v51
v_pk_add_f32 v[48:49], v[48:49], v[16:17]
v_pk_add_f32 v[50:51], v[50:51], v[18:19]
v_cvt_pk_bf16_f32 v20, v48, v49
v_cvt_pk_bf16_f32 v21, v50, v51
ds_write_b64 v5, v[20:21] offset:0
v_pk_mul_f32 v[16:17], v[52:53], s[80:81]
v_pk_mul_f32 v[18:19], v[54:55], s[80:81]
v_exp_f32_e64 v16, v16 clamp
v_exp_f32_e64 v17, v17 clamp
v_exp_f32_e64 v18, v18 clamp
v_exp_f32_e64 v19, v19 clamp
v_pk_add_f32 v[52:53], v[52:53], s[86:87]
v_pk_add_f32 v[54:55], v[54:55], s[86:87]
v_max_f32 v52, s86, v52
v_max_f32 v53, s86, v53
v_max_f32 v54, s86, v54
v_max_f32 v55, s86, v55
v_pk_add_f32 v[52:53], v[52:53], v[16:17]
v_pk_add_f32 v[54:55], v[54:55], v[18:19]
v_cvt_pk_bf16_f32 v22, v52, v53
v_cvt_pk_bf16_f32 v23, v54, v55
ds_write_b64 v5, v[22:23] offset:32
v_pk_mul_f32 v[16:17], v[56:57], s[80:81]
v_pk_mul_f32 v[18:19], v[58:59], s[80:81]
v_exp_f32_e64 v16, v16 clamp
v_exp_f32_e64 v17, v17 clamp
v_exp_f32_e64 v18, v18 clamp
v_exp_f32_e64 v19, v19 clamp
v_pk_add_f32 v[56:57], v[56:57], s[86:87]
v_pk_add_f32 v[58:59], v[58:59], s[86:87]
v_max_f32 v56, s86, v56
v_max_f32 v57, s86, v57
v_max_f32 v58, s86, v58
v_max_f32 v59, s86, v59
v_pk_add_f32 v[56:57], v[56:57], v[16:17]
v_pk_add_f32 v[58:59], v[58:59], v[18:19]
v_cvt_pk_bf16_f32 v24, v56, v57
v_cvt_pk_bf16_f32 v25, v58, v59
ds_write_b64 v5, v[24:25] offset:4352
v_pk_mul_f32 v[16:17], v[60:61], s[80:81]
v_pk_mul_f32 v[18:19], v[62:63], s[80:81]
v_exp_f32_e64 v16, v16 clamp
v_exp_f32_e64 v17, v17 clamp
v_exp_f32_e64 v18, v18 clamp
v_exp_f32_e64 v19, v19 clamp
v_pk_add_f32 v[60:61], v[60:61], s[86:87]
v_pk_add_f32 v[62:63], v[62:63], s[86:87]
v_max_f32 v60, s86, v60
v_max_f32 v61, s86, v61
v_max_f32 v62, s86, v62
v_max_f32 v63, s86, v63
v_pk_add_f32 v[60:61], v[60:61], v[16:17]
v_pk_add_f32 v[62:63], v[62:63], v[18:19]
v_cvt_pk_bf16_f32 v26, v60, v61
v_cvt_pk_bf16_f32 v27, v62, v63
ds_write_b64 v5, v[26:27] offset:4384
v_pk_mul_f32 v[16:17], v[64:65], s[80:81]
v_pk_mul_f32 v[18:19], v[66:67], s[80:81]
v_exp_f32_e64 v16, v16 clamp
v_exp_f32_e64 v17, v17 clamp
v_exp_f32_e64 v18, v18 clamp
v_exp_f32_e64 v19, v19 clamp
v_pk_add_f32 v[64:65], v[64:65], s[86:87]
v_pk_add_f32 v[66:67], v[66:67], s[86:87]
v_max_f32 v64, s86, v64
v_max_f32 v65, s86, v65
v_max_f32 v66, s86, v66
v_max_f32 v67, s86, v67
v_pk_add_f32 v[64:65], v[64:65], v[16:17]
v_pk_add_f32 v[66:67], v[66:67], v[18:19]
v_cvt_pk_bf16_f32 v20, v64, v65
v_cvt_pk_bf16_f32 v21, v66, v67
ds_write_b64 v5, v[20:21] offset:8704
v_pk_mul_f32 v[16:17], v[68:69], s[80:81]
v_pk_mul_f32 v[18:19], v[70:71], s[80:81]
v_exp_f32_e64 v16, v16 clamp
v_exp_f32_e64 v17, v17 clamp
v_exp_f32_e64 v18, v18 clamp
v_exp_f32_e64 v19, v19 clamp
v_pk_add_f32 v[68:69], v[68:69], s[86:87]
v_pk_add_f32 v[70:71], v[70:71], s[86:87]
v_max_f32 v68, s86, v68
v_max_f32 v69, s86, v69
v_max_f32 v70, s86, v70
v_max_f32 v71, s86, v71
v_pk_add_f32 v[68:69], v[68:69], v[16:17]
v_pk_add_f32 v[70:71], v[70:71], v[18:19]
v_cvt_pk_bf16_f32 v22, v68, v69
v_cvt_pk_bf16_f32 v23, v70, v71
ds_write_b64 v5, v[22:23] offset:8736
v_cvt_pk_bf16_f32 v24, v72, v73
v_cvt_pk_bf16_f32 v25, v74, v75
ds_write_b64 v5, v[24:25] offset:21760
v_cvt_pk_bf16_f32 v26, v76, v77
v_cvt_pk_bf16_f32 v27, v78, v79
ds_write_b64 v5, v[26:27] offset:21792
v_cvt_pk_bf16_f32 v20, v80, v81
v_cvt_pk_bf16_f32 v21, v82, v83
ds_write_b64 v5, v[20:21] offset:26112
v_cvt_pk_bf16_f32 v22, v84, v85
v_cvt_pk_bf16_f32 v23, v86, v87
ds_write_b64 v5, v[22:23] offset:26144
s_waitcnt lgkmcnt(0)
s_barrier
v_bfe_u32 v6, v3, 4, 4
v_lshrrev_b32 v7, 8, v3
v_lshlrev_b32 v7, 4, v7
s_mul_i32 s60, s4, 5440
s_movk_i32 s61, 272
v_mul_lo_u32 v5, v6, s61
v_add_u32 v5, s60, v5
v_add_u32 v5, v5, v7
v_add_u32 v8, 24576, v5
v_add_u32 v5, 46336, v5
ds_read_b128 v[16:19], v5 offset:0
ds_read_b128 v[20:23], v5 offset:64
ds_read_b128 v[24:27], v5 offset:128
ds_read_b128 v[28:31], v5 offset:192
ds_read_b128 v[32:35], v8 offset:0
ds_read_b128 v[36:39], v8 offset:64
ds_read_b128 v[40:43], v8 offset:128
ds_read_b128 v[44:47], v8 offset:192
ds_read_b128 v[64:67], v8 offset:4352
ds_read_b128 v[68:71], v8 offset:4416
ds_read_b128 v[72:75], v8 offset:4480
ds_read_b128 v[76:79], v8 offset:4544
s_waitcnt lgkmcnt(7)
v_mfma_f32_16x16x32_bf16 v[80:83], v[16:19], v[32:35], 0
s_waitcnt lgkmcnt(6)
v_mfma_f32_16x16x32_bf16 v[80:83], v[20:23], v[36:39], v[80:83]
s_waitcnt lgkmcnt(5)
v_mfma_f32_16x16x32_bf16 v[80:83], v[24:27], v[40:43], v[80:83]
s_waitcnt lgkmcnt(4)
v_mfma_f32_16x16x32_bf16 v[80:83], v[28:31], v[44:47], v[80:83]
s_waitcnt lgkmcnt(3)
v_mfma_f32_16x16x32_bf16 v[84:87], v[16:19], v[64:67], 0
s_waitcnt lgkmcnt(2)
v_mfma_f32_16x16x32_bf16 v[84:87], v[20:23], v[68:71], v[84:87]
s_waitcnt lgkmcnt(1)
v_mfma_f32_16x16x32_bf16 v[84:87], v[24:27], v[72:75], v[84:87]
s_waitcnt lgkmcnt(0)
v_mfma_f32_16x16x32_bf16 v[84:87], v[28:31], v[76:79], v[84:87]
s_lshl_b32 s60, s3, 11
s_add_u32 s60, s60, 148480
s_cmp_eq_u32 s3, 7
s_cselect_b32 s60, 68096, s60
v_add_u32 v5, s60, v3
s_nop 5
ds_write_b128 v5, v[80:83] offset:0
ds_write_b128 v5, v[84:87] offset:1024
s_waitcnt lgkmcnt(0)
v_add_u32 v1, 0x12000, v1
ds_read_b128 v[16:19], v1 offset:0
ds_read_b128 v[20:23], v1 offset:2048
ds_read_b128 v[24:27], v1 offset:4096
ds_read_b128 v[28:31], v1 offset:6144
ds_read_b128 v[32:35], v1 offset:8192
s_waitcnt lgkmcnt(4)
v_mfma_f32_16x16x32_bf16 v[48:51], v[16:19], a[0:3], 0
s_setprio 1
ds_read_b128 v[36:39], v1 offset:1024
v_mfma_f32_16x16x32_bf16 v[52:55], v[16:19], a[4:7], 0
s_setprio 0
s_waitcnt lgkmcnt(4)
v_mfma_f32_16x16x32_bf16 v[56:59], v[20:23], a[0:3], 0
s_setprio 1
ds_read_b128 v[40:43], v1 offset:3072
v_mfma_f32_16x16x32_bf16 v[60:63], v[20:23], a[4:7], 0
s_setprio 0
s_waitcnt lgkmcnt(4)
v_mfma_f32_16x16x32_bf16 v[64:67], v[24:27], a[0:3], 0
s_setprio 1
ds_read_b128 v[44:47], v1 offset:5120
v_mfma_f32_16x16x32_bf16 v[68:71], v[24:27], a[4:7], 0
s_setprio 0
s_waitcnt lgkmcnt(4)
v_mfma_f32_16x16x32_bf16 v[72:75], v[28:31], a[0:3], 0
s_setprio 1
ds_read_b128 v[16:19], v1 offset:7168
v_mfma_f32_16x16x32_bf16 v[76:79], v[28:31], a[4:7], 0
s_setprio 0
s_waitcnt lgkmcnt(4)
v_mfma_f32_16x16x32_bf16 v[80:83], v[32:35], a[0:3], 0
s_setprio 1
ds_read_b128 v[20:23], v1 offset:9216
v_mfma_f32_16x16x32_bf16 v[84:87], v[32:35], a[4:7], 0
s_setprio 0
s_waitcnt vmcnt(3)
s_barrier
s_waitcnt lgkmcnt(4)
v_mfma_f32_16x16x32_bf16 v[48:51], v[36:39], a[8:11], v[48:51]
s_setprio 1
ds_read_b128 v[24:27], v1 offset:49152
v_mfma_f32_16x16x32_bf16 v[52:55], v[36:39], a[12:15], v[52:55]
s_setprio 0
s_waitcnt lgkmcnt(4)
v_mfma_f32_16x16x32_bf16 v[56:59], v[40:43], a[8:11], v[56:59]
s_setprio 1
ds_read_b128 v[28:31], v1 offset:51200
v_mfma_f32_16x16x32_bf16 v[60:63], v[40:43], a[12:15], v[60:63]
s_setprio 0
s_add_u32 s53, s53, 688128
s_add_u32 m0, s51, 0x18000
s_nop 0
buffer_load_dwordx4 v3, s[32:35], s53 offen offset:0 lds
buffer_load_dwordx4 v3, s[32:35], s53 offen offset:1024 lds
buffer_load_dwordx4 v3, s[32:35], s53 offen offset:2048 lds
s_waitcnt lgkmcnt(4)
v_mfma_f32_16x16x32_bf16 v[64:67], v[44:47], a[8:11], v[64:67]
s_setprio 1
ds_read_b128 v[32:35], v1 offset:53248
v_mfma_f32_16x16x32_bf16 v[68:71], v[44:47], a[12:15], v[68:71]
s_setprio 0
s_waitcnt lgkmcnt(4)
v_mfma_f32_16x16x32_bf16 v[72:75], v[16:19], a[8:11], v[72:75]
s_setprio 1
ds_read_b128 v[36:39], v1 offset:55296
v_mfma_f32_16x16x32_bf16 v[76:79], v[16:19], a[12:15], v[76:79]
s_setprio 0
s_waitcnt lgkmcnt(4)
v_mfma_f32_16x16x32_bf16 v[80:83], v[20:23], a[8:11], v[80:83]
s_setprio 1
ds_read_b128 v[40:43], v1 offset:57344
v_mfma_f32_16x16x32_bf16 v[84:87], v[20:23], a[12:15], v[84:87]
s_setprio 0
s_waitcnt lgkmcnt(4)
v_mfma_f32_16x16x32_bf16 v[48:51], v[24:27], a[16:19], v[48:51]
s_setprio 1
ds_read_b128 v[44:47], v1 offset:50176
v_mfma_f32_16x16x32_bf16 v[52:55], v[24:27], a[20:23], v[52:55]
s_setprio 0
s_waitcnt lgkmcnt(4)
v_mfma_f32_16x16x32_bf16 v[56:59], v[28:31], a[16:19], v[56:59]
s_setprio 1
ds_read_b128 v[16:19], v1 offset:52224
v_mfma_f32_16x16x32_bf16 v[60:63], v[28:31], a[20:23], v[60:63]
s_setprio 0
s_waitcnt lgkmcnt(4)
v_mfma_f32_16x16x32_bf16 v[64:67], v[32:35], a[16:19], v[64:67]
s_setprio 1
ds_read_b128 v[20:23], v1 offset:54272
v_mfma_f32_16x16x32_bf16 v[68:71], v[32:35], a[20:23], v[68:71]
s_setprio 0
s_waitcnt lgkmcnt(4)
v_mfma_f32_16x16x32_bf16 v[72:75], v[36:39], a[16:19], v[72:75]
s_setprio 1
ds_read_b128 v[24:27], v1 offset:56320
v_mfma_f32_16x16x32_bf16 v[76:79], v[36:39], a[20:23], v[76:79]
s_setprio 0
s_waitcnt lgkmcnt(4)
v_mfma_f32_16x16x32_bf16 v[80:83], v[40:43], a[16:19], v[80:83]
s_setprio 1
ds_read_b128 v[28:31], v1 offset:58368
v_mfma_f32_16x16x32_bf16 v[84:87], v[40:43], a[20:23], v[84:87]
s_setprio 0
s_waitcnt vmcnt(3)
s_barrier
s_waitcnt lgkmcnt(4)
v_mfma_f32_16x16x32_bf16 v[48:51], v[44:47], a[24:27], v[48:51]
s_setprio 1
v_add_u32 v1, 0xfffee000, v1
ds_read_b128 v[32:35], v1 offset:0
v_mfma_f32_16x16x32_bf16 v[52:55], v[44:47], a[28:31], v[52:55]
s_setprio 0
s_waitcnt lgkmcnt(4)
v_mfma_f32_16x16x32_bf16 v[56:59], v[16:19], a[24:27], v[56:59]
s_setprio 1
ds_read_b128 v[36:39], v1 offset:2048
v_mfma_f32_16x16x32_bf16 v[60:63], v[16:19], a[28:31], v[60:63]
s_setprio 0
s_add_u32 s53, s53, 688128
s_add_u32 m0, s51, 0x12000
s_nop 0
buffer_load_dwordx4 v3, s[32:35], s53 offen offset:0 lds
buffer_load_dwordx4 v3, s[32:35], s53 offen offset:1024 lds
buffer_load_dwordx4 v3, s[32:35], s53 offen offset:2048 lds
s_waitcnt lgkmcnt(4)
v_mfma_f32_16x16x32_bf16 v[64:67], v[20:23], a[24:27], v[64:67]
s_setprio 1
ds_read_b128 v[40:43], v1 offset:4096
v_mfma_f32_16x16x32_bf16 v[68:71], v[20:23], a[28:31], v[68:71]
s_setprio 0
s_waitcnt lgkmcnt(4)
v_mfma_f32_16x16x32_bf16 v[72:75], v[24:27], a[24:27], v[72:75]
s_setprio 1
ds_read_b128 v[44:47], v1 offset:6144
v_mfma_f32_16x16x32_bf16 v[76:79], v[24:27], a[28:31], v[76:79]
s_setprio 0
s_waitcnt lgkmcnt(4)
v_mfma_f32_16x16x32_bf16 v[80:83], v[28:31], a[24:27], v[80:83]
s_setprio 1
ds_read_b128 v[16:19], v1 offset:8192
v_mfma_f32_16x16x32_bf16 v[84:87], v[28:31], a[28:31], v[84:87]
s_setprio 0
s_waitcnt lgkmcnt(4)
v_mfma_f32_16x16x32_bf16 v[48:51], v[32:35], a[32:35], v[48:51]
s_setprio 1
ds_read_b128 v[20:23], v1 offset:1024
v_mfma_f32_16x16x32_bf16 v[52:55], v[32:35], a[36:39], v[52:55]
s_setprio 0
s_waitcnt lgkmcnt(4)
v_mfma_f32_16x16x32_bf16 v[56:59], v[36:39], a[32:35], v[56:59]
s_setprio 1
ds_read_b128 v[24:27], v1 offset:3072
v_mfma_f32_16x16x32_bf16 v[60:63], v[36:39], a[36:39], v[60:63]
s_setprio 0
s_waitcnt lgkmcnt(4)
v_mfma_f32_16x16x32_bf16 v[64:67], v[40:43], a[32:35], v[64:67]
s_setprio 1
ds_read_b128 v[28:31], v1 offset:5120
v_mfma_f32_16x16x32_bf16 v[68:71], v[40:43], a[36:39], v[68:71]
s_setprio 0
s_waitcnt lgkmcnt(4)
v_mfma_f32_16x16x32_bf16 v[72:75], v[44:47], a[32:35], v[72:75]
s_setprio 1
ds_read_b128 v[32:35], v1 offset:7168
v_mfma_f32_16x16x32_bf16 v[76:79], v[44:47], a[36:39], v[76:79]
s_setprio 0
s_waitcnt lgkmcnt(4)
v_mfma_f32_16x16x32_bf16 v[80:83], v[16:19], a[32:35], v[80:83]
s_setprio 1
ds_read_b128 v[36:39], v1 offset:9216
v_mfma_f32_16x16x32_bf16 v[84:87], v[16:19], a[36:39], v[84:87]
s_setprio 0
s_waitcnt vmcnt(3)
s_barrier
s_waitcnt lgkmcnt(4)
v_mfma_f32_16x16x32_bf16 v[48:51], v[20:23], a[40:43], v[48:51]
s_setprio 1
v_add_u32 v1, 0x18000, v1
ds_read_b128 v[40:43], v1 offset:0
v_mfma_f32_16x16x32_bf16 v[52:55], v[20:23], a[44:47], v[52:55]
s_setprio 0
s_waitcnt lgkmcnt(4)
v_mfma_f32_16x16x32_bf16 v[56:59], v[24:27], a[40:43], v[56:59]
s_setprio 1
ds_read_b128 v[44:47], v1 offset:2048
v_mfma_f32_16x16x32_bf16 v[60:63], v[24:27], a[44:47], v[60:63]
s_setprio 0
s_add_u32 s53, s53, 688128
s_add_u32 m0, s51, 0x1e000
s_nop 0
buffer_load_dwordx4 v3, s[32:35], s53 offen offset:0 lds
buffer_load_dwordx4 v3, s[32:35], s53 offen offset:1024 lds
buffer_load_dwordx4 v3, s[32:35], s53 offen offset:2048 lds
s_waitcnt lgkmcnt(4)
v_mfma_f32_16x16x32_bf16 v[64:67], v[28:31], a[40:43], v[64:67]
s_setprio 1
ds_read_b128 v[16:19], v1 offset:4096
v_mfma_f32_16x16x32_bf16 v[68:71], v[28:31], a[44:47], v[68:71]
s_setprio 0
s_waitcnt lgkmcnt(4)
v_mfma_f32_16x16x32_bf16 v[72:75], v[32:35], a[40:43], v[72:75]
s_setprio 1
ds_read_b128 v[20:23], v1 offset:6144
v_mfma_f32_16x16x32_bf16 v[76:79], v[32:35], a[44:47], v[76:79]
s_setprio 0
s_waitcnt lgkmcnt(4)
v_mfma_f32_16x16x32_bf16 v[80:83], v[36:39], a[40:43], v[80:83]
s_setprio 1
ds_read_b128 v[24:27], v1 offset:8192
v_mfma_f32_16x16x32_bf16 v[84:87], v[36:39], a[44:47], v[84:87]
s_setprio 0
s_waitcnt lgkmcnt(4)
v_mfma_f32_16x16x32_bf16 v[48:51], v[40:43], a[48:51], v[48:51]
s_setprio 1
ds_read_b128 v[28:31], v1 offset:1024
v_mfma_f32_16x16x32_bf16 v[52:55], v[40:43], a[52:55], v[52:55]
s_setprio 0
s_waitcnt lgkmcnt(4)
v_mfma_f32_16x16x32_bf16 v[56:59], v[44:47], a[48:51], v[56:59]
s_setprio 1
ds_read_b128 v[32:35], v1 offset:3072
v_mfma_f32_16x16x32_bf16 v[60:63], v[44:47], a[52:55], v[60:63]
s_setprio 0
s_waitcnt lgkmcnt(4)
v_mfma_f32_16x16x32_bf16 v[64:67], v[16:19], a[48:51], v[64:67]
s_setprio 1
ds_read_b128 v[36:39], v1 offset:5120
v_mfma_f32_16x16x32_bf16 v[68:71], v[16:19], a[52:55], v[68:71]
s_setprio 0
s_waitcnt lgkmcnt(4)
v_mfma_f32_16x16x32_bf16 v[72:75], v[20:23], a[48:51], v[72:75]
s_setprio 1
ds_read_b128 v[40:43], v1 offset:7168
v_mfma_f32_16x16x32_bf16 v[76:79], v[20:23], a[52:55], v[76:79]
s_setprio 0
s_waitcnt lgkmcnt(4)
v_mfma_f32_16x16x32_bf16 v[80:83], v[24:27], a[48:51], v[80:83]
s_setprio 1
ds_read_b128 v[44:47], v1 offset:9216
v_mfma_f32_16x16x32_bf16 v[84:87], v[24:27], a[52:55], v[84:87]
s_setprio 0
s_waitcnt vmcnt(3)
s_barrier
s_waitcnt lgkmcnt(4)
v_mfma_f32_16x16x32_bf16 v[48:51], v[28:31], a[56:59], v[48:51]
s_setprio 1
v_add_u32 v1, 0xffffa000, v1
ds_read_b128 v[16:19], v1 offset:0
v_mfma_f32_16x16x32_bf16 v[52:55], v[28:31], a[60:63], v[52:55]
s_setprio 0
s_waitcnt lgkmcnt(4)
v_mfma_f32_16x16x32_bf16 v[56:59], v[32:35], a[56:59], v[56:59]
s_setprio 1
ds_read_b128 v[20:23], v1 offset:2048
v_mfma_f32_16x16x32_bf16 v[60:63], v[32:35], a[60:63], v[60:63]
s_setprio 0
s_add_u32 s53, s53, 688128
s_add_u32 m0, s51, 0x0
s_nop 0
buffer_load_dwordx4 v3, s[32:35], s53 offen offset:0 lds
buffer_load_dwordx4 v3, s[32:35], s53 offen offset:1024 lds
buffer_load_dwordx4 v3, s[32:35], s53 offen offset:2048 lds
s_waitcnt lgkmcnt(4)
v_mfma_f32_16x16x32_bf16 v[64:67], v[36:39], a[56:59], v[64:67]
s_setprio 1
ds_read_b128 v[24:27], v1 offset:4096
v_mfma_f32_16x16x32_bf16 v[68:71], v[36:39], a[60:63], v[68:71]
s_setprio 0
s_waitcnt lgkmcnt(4)
v_mfma_f32_16x16x32_bf16 v[72:75], v[40:43], a[56:59], v[72:75]
s_setprio 1
ds_read_b128 v[28:31], v1 offset:6144
v_mfma_f32_16x16x32_bf16 v[76:79], v[40:43], a[60:63], v[76:79]
s_setprio 0
s_waitcnt lgkmcnt(4)
v_mfma_f32_16x16x32_bf16 v[80:83], v[44:47], a[56:59], v[80:83]
s_setprio 1
ds_read_b128 v[32:35], v1 offset:8192
v_mfma_f32_16x16x32_bf16 v[84:87], v[44:47], a[60:63], v[84:87]
s_setprio 0
s_waitcnt lgkmcnt(4)
v_mfma_f32_16x16x32_bf16 v[48:51], v[16:19], a[64:67], v[48:51]
s_setprio 1
ds_read_b128 v[36:39], v1 offset:1024
v_mfma_f32_16x16x32_bf16 v[52:55], v[16:19], a[68:71], v[52:55]
s_setprio 0
s_waitcnt lgkmcnt(4)
v_mfma_f32_16x16x32_bf16 v[56:59], v[20:23], a[64:67], v[56:59]
s_setprio 1
ds_read_b128 v[40:43], v1 offset:3072
v_mfma_f32_16x16x32_bf16 v[60:63], v[20:23], a[68:71], v[60:63]
s_setprio 0
s_waitcnt lgkmcnt(4)
v_mfma_f32_16x16x32_bf16 v[64:67], v[24:27], a[64:67], v[64:67]
s_setprio 1
ds_read_b128 v[44:47], v1 offset:5120
v_mfma_f32_16x16x32_bf16 v[68:71], v[24:27], a[68:71], v[68:71]
s_setprio 0
s_waitcnt lgkmcnt(4)
v_mfma_f32_16x16x32_bf16 v[72:75], v[28:31], a[64:67], v[72:75]
s_setprio 1
ds_read_b128 v[16:19], v1 offset:7168
v_mfma_f32_16x16x32_bf16 v[76:79], v[28:31], a[68:71], v[76:79]
s_setprio 0
s_waitcnt lgkmcnt(4)
v_mfma_f32_16x16x32_bf16 v[80:83], v[32:35], a[64:67], v[80:83]
s_setprio 1
ds_read_b128 v[20:23], v1 offset:9216
v_mfma_f32_16x16x32_bf16 v[84:87], v[32:35], a[68:71], v[84:87]
s_setprio 0
s_waitcnt vmcnt(3)
s_barrier
s_waitcnt lgkmcnt(4)
v_mfma_f32_16x16x32_bf16 v[48:51], v[36:39], a[72:75], v[48:51]
s_setprio 1
ds_read_b128 v[24:27], v1 offset:49152
v_mfma_f32_16x16x32_bf16 v[52:55], v[36:39], a[76:79], v[52:55]
s_setprio 0
s_waitcnt lgkmcnt(4)
v_mfma_f32_16x16x32_bf16 v[56:59], v[40:43], a[72:75], v[56:59]
s_setprio 1
ds_read_b128 v[28:31], v1 offset:51200
v_mfma_f32_16x16x32_bf16 v[60:63], v[40:43], a[76:79], v[60:63]
s_setprio 0
s_add_u32 s53, s53, 688128
s_add_u32 m0, s51, 0x18000
s_nop 0
buffer_load_dwordx4 v3, s[32:35], s53 offen offset:0 lds
buffer_load_dwordx4 v3, s[32:35], s53 offen offset:1024 lds
buffer_load_dwordx4 v3, s[32:35], s53 offen offset:2048 lds
s_waitcnt lgkmcnt(4)
v_mfma_f32_16x16x32_bf16 v[64:67], v[44:47], a[72:75], v[64:67]
s_setprio 1
ds_read_b128 v[32:35], v1 offset:53248
v_mfma_f32_16x16x32_bf16 v[68:71], v[44:47], a[76:79], v[68:71]
s_setprio 0
s_waitcnt lgkmcnt(4)
v_mfma_f32_16x16x32_bf16 v[72:75], v[16:19], a[72:75], v[72:75]
s_setprio 1
ds_read_b128 v[36:39], v1 offset:55296
v_mfma_f32_16x16x32_bf16 v[76:79], v[16:19], a[76:79], v[76:79]
s_setprio 0
s_waitcnt lgkmcnt(4)
v_mfma_f32_16x16x32_bf16 v[80:83], v[20:23], a[72:75], v[80:83]
s_setprio 1
ds_read_b128 v[40:43], v1 offset:57344
v_mfma_f32_16x16x32_bf16 v[84:87], v[20:23], a[76:79], v[84:87]
s_setprio 0
s_waitcnt lgkmcnt(4)
v_mfma_f32_16x16x32_bf16 v[48:51], v[24:27], a[80:83], v[48:51]
s_setprio 1
ds_read_b128 v[44:47], v1 offset:50176
v_mfma_f32_16x16x32_bf16 v[52:55], v[24:27], a[84:87], v[52:55]
s_setprio 0
s_waitcnt lgkmcnt(4)
v_mfma_f32_16x16x32_bf16 v[56:59], v[28:31], a[80:83], v[56:59]
s_setprio 1
ds_read_b128 v[16:19], v1 offset:52224
v_mfma_f32_16x16x32_bf16 v[60:63], v[28:31], a[84:87], v[60:63]
s_setprio 0
s_waitcnt lgkmcnt(4)
v_mfma_f32_16x16x32_bf16 v[64:67], v[32:35], a[80:83], v[64:67]
s_setprio 1
ds_read_b128 v[20:23], v1 offset:54272
v_mfma_f32_16x16x32_bf16 v[68:71], v[32:35], a[84:87], v[68:71]
s_setprio 0
s_waitcnt lgkmcnt(4)
v_mfma_f32_16x16x32_bf16 v[72:75], v[36:39], a[80:83], v[72:75]
s_setprio 1
ds_read_b128 v[24:27], v1 offset:56320
v_mfma_f32_16x16x32_bf16 v[76:79], v[36:39], a[84:87], v[76:79]
s_setprio 0
s_waitcnt lgkmcnt(4)
v_mfma_f32_16x16x32_bf16 v[80:83], v[40:43], a[80:83], v[80:83]
s_setprio 1
ds_read_b128 v[28:31], v1 offset:58368
v_mfma_f32_16x16x32_bf16 v[84:87], v[40:43], a[84:87], v[84:87]
s_setprio 0
s_waitcnt vmcnt(3)
s_barrier
s_waitcnt lgkmcnt(4)
v_mfma_f32_16x16x32_bf16 v[48:51], v[44:47], a[88:91], v[48:51]
s_setprio 1
v_add_u32 v1, 0xfffee000, v1
ds_read_b128 v[32:35], v1 offset:0
v_mfma_f32_16x16x32_bf16 v[52:55], v[44:47], a[92:95], v[52:55]
s_setprio 0
s_waitcnt lgkmcnt(4)
v_mfma_f32_16x16x32_bf16 v[56:59], v[16:19], a[88:91], v[56:59]
s_setprio 1
ds_read_b128 v[36:39], v1 offset:2048
v_mfma_f32_16x16x32_bf16 v[60:63], v[16:19], a[92:95], v[60:63]
s_setprio 0
s_add_u32 s53, s53, 688128
s_add_u32 m0, s51, 0x12000
s_nop 0
buffer_load_dwordx4 v3, s[32:35], s53 offen offset:0 lds
buffer_load_dwordx4 v3, s[32:35], s53 offen offset:1024 lds
buffer_load_dwordx4 v3, s[32:35], s53 offen offset:2048 lds
s_waitcnt lgkmcnt(4)
v_mfma_f32_16x16x32_bf16 v[64:67], v[20:23], a[88:91], v[64:67]
s_setprio 1
ds_read_b128 v[40:43], v1 offset:4096
v_mfma_f32_16x16x32_bf16 v[68:71], v[20:23], a[92:95], v[68:71]
s_setprio 0
s_waitcnt lgkmcnt(4)
v_mfma_f32_16x16x32_bf16 v[72:75], v[24:27], a[88:91], v[72:75]
s_setprio 1
ds_read_b128 v[44:47], v1 offset:6144
v_mfma_f32_16x16x32_bf16 v[76:79], v[24:27], a[92:95], v[76:79]
s_setprio 0
s_waitcnt lgkmcnt(4)
v_mfma_f32_16x16x32_bf16 v[80:83], v[28:31], a[88:91], v[80:83]
s_setprio 1
ds_read_b128 v[16:19], v1 offset:8192
v_mfma_f32_16x16x32_bf16 v[84:87], v[28:31], a[92:95], v[84:87]
s_setprio 0
s_waitcnt lgkmcnt(4)
v_mfma_f32_16x16x32_bf16 v[48:51], v[32:35], a[96:99], v[48:51]
s_setprio 1
ds_read_b128 v[20:23], v1 offset:1024
v_mfma_f32_16x16x32_bf16 v[52:55], v[32:35], a[100:103], v[52:55]
s_setprio 0
s_waitcnt lgkmcnt(4)
v_mfma_f32_16x16x32_bf16 v[56:59], v[36:39], a[96:99], v[56:59]
s_setprio 1
ds_read_b128 v[24:27], v1 offset:3072
v_mfma_f32_16x16x32_bf16 v[60:63], v[36:39], a[100:103], v[60:63]
s_setprio 0
s_waitcnt lgkmcnt(4)
v_mfma_f32_16x16x32_bf16 v[64:67], v[40:43], a[96:99], v[64:67]
s_setprio 1
ds_read_b128 v[28:31], v1 offset:5120
v_mfma_f32_16x16x32_bf16 v[68:71], v[40:43], a[100:103], v[68:71]
s_setprio 0
s_waitcnt lgkmcnt(4)
v_mfma_f32_16x16x32_bf16 v[72:75], v[44:47], a[96:99], v[72:75]
s_setprio 1
ds_read_b128 v[32:35], v1 offset:7168
v_mfma_f32_16x16x32_bf16 v[76:79], v[44:47], a[100:103], v[76:79]
s_setprio 0
s_waitcnt lgkmcnt(4)
v_mfma_f32_16x16x32_bf16 v[80:83], v[16:19], a[96:99], v[80:83]
s_setprio 1
ds_read_b128 v[36:39], v1 offset:9216
v_mfma_f32_16x16x32_bf16 v[84:87], v[16:19], a[100:103], v[84:87]
s_setprio 0
s_waitcnt vmcnt(3)
s_barrier
s_waitcnt lgkmcnt(4)
v_mfma_f32_16x16x32_bf16 v[48:51], v[20:23], a[104:107], v[48:51]
s_setprio 1
v_add_u32 v1, 0x18000, v1
ds_read_b128 v[40:43], v1 offset:0
v_mfma_f32_16x16x32_bf16 v[52:55], v[20:23], a[108:111], v[52:55]
s_setprio 0
s_waitcnt lgkmcnt(4)
v_mfma_f32_16x16x32_bf16 v[56:59], v[24:27], a[104:107], v[56:59]
s_setprio 1
ds_read_b128 v[44:47], v1 offset:2048
v_mfma_f32_16x16x32_bf16 v[60:63], v[24:27], a[108:111], v[60:63]
s_setprio 0
s_add_u32 s53, s53, 688128
s_add_u32 m0, s51, 0x1e000
s_nop 0
buffer_load_dwordx4 v3, s[32:35], s53 offen offset:0 lds
buffer_load_dwordx4 v3, s[32:35], s53 offen offset:1024 lds
buffer_load_dwordx4 v3, s[32:35], s53 offen offset:2048 lds
s_waitcnt lgkmcnt(4)
v_mfma_f32_16x16x32_bf16 v[64:67], v[28:31], a[104:107], v[64:67]
s_setprio 1
ds_read_b128 v[16:19], v1 offset:4096
v_mfma_f32_16x16x32_bf16 v[68:71], v[28:31], a[108:111], v[68:71]
s_setprio 0
s_waitcnt lgkmcnt(4)
v_mfma_f32_16x16x32_bf16 v[72:75], v[32:35], a[104:107], v[72:75]
s_setprio 1
ds_read_b128 v[20:23], v1 offset:6144
v_mfma_f32_16x16x32_bf16 v[76:79], v[32:35], a[108:111], v[76:79]
s_setprio 0
s_waitcnt lgkmcnt(4)
v_mfma_f32_16x16x32_bf16 v[80:83], v[36:39], a[104:107], v[80:83]
s_setprio 1
ds_read_b128 v[24:27], v1 offset:8192
v_mfma_f32_16x16x32_bf16 v[84:87], v[36:39], a[108:111], v[84:87]
s_setprio 0
s_waitcnt lgkmcnt(4)
v_mfma_f32_16x16x32_bf16 v[48:51], v[40:43], a[112:115], v[48:51]
s_setprio 1
ds_read_b128 v[28:31], v1 offset:1024
v_mfma_f32_16x16x32_bf16 v[52:55], v[40:43], a[116:119], v[52:55]
s_setprio 0
s_waitcnt lgkmcnt(4)
v_mfma_f32_16x16x32_bf16 v[56:59], v[44:47], a[112:115], v[56:59]
s_setprio 1
ds_read_b128 v[32:35], v1 offset:3072
v_mfma_f32_16x16x32_bf16 v[60:63], v[44:47], a[116:119], v[60:63]
s_setprio 0
s_waitcnt lgkmcnt(4)
v_mfma_f32_16x16x32_bf16 v[64:67], v[16:19], a[112:115], v[64:67]
s_setprio 1
ds_read_b128 v[36:39], v1 offset:5120
v_mfma_f32_16x16x32_bf16 v[68:71], v[16:19], a[116:119], v[68:71]
s_setprio 0
s_waitcnt lgkmcnt(4)
v_mfma_f32_16x16x32_bf16 v[72:75], v[20:23], a[112:115], v[72:75]
s_setprio 1
ds_read_b128 v[40:43], v1 offset:7168
v_mfma_f32_16x16x32_bf16 v[76:79], v[20:23], a[116:119], v[76:79]
s_setprio 0
s_waitcnt lgkmcnt(4)
v_mfma_f32_16x16x32_bf16 v[80:83], v[24:27], a[112:115], v[80:83]
s_setprio 1
ds_read_b128 v[44:47], v1 offset:9216
v_mfma_f32_16x16x32_bf16 v[84:87], v[24:27], a[116:119], v[84:87]
s_setprio 0
s_waitcnt vmcnt(3)
s_barrier
s_waitcnt lgkmcnt(4)
v_mfma_f32_16x16x32_bf16 v[48:51], v[28:31], a[120:123], v[48:51]
s_setprio 1
v_add_u32 v1, 0xffffa000, v1
ds_read_b128 v[16:19], v1 offset:0
v_mfma_f32_16x16x32_bf16 v[52:55], v[28:31], a[124:127], v[52:55]
s_setprio 0
s_waitcnt lgkmcnt(4)
v_mfma_f32_16x16x32_bf16 v[56:59], v[32:35], a[120:123], v[56:59]
s_setprio 1
ds_read_b128 v[20:23], v1 offset:2048
v_mfma_f32_16x16x32_bf16 v[60:63], v[32:35], a[124:127], v[60:63]
s_setprio 0
s_waitcnt lgkmcnt(4)
v_mfma_f32_16x16x32_bf16 v[64:67], v[36:39], a[120:123], v[64:67]
s_setprio 1
ds_read_b128 v[24:27], v1 offset:4096
v_mfma_f32_16x16x32_bf16 v[68:71], v[36:39], a[124:127], v[68:71]
s_setprio 0
s_waitcnt lgkmcnt(4)
v_mfma_f32_16x16x32_bf16 v[72:75], v[40:43], a[120:123], v[72:75]
s_setprio 1
ds_read_b128 v[28:31], v1 offset:6144
v_mfma_f32_16x16x32_bf16 v[76:79], v[40:43], a[124:127], v[76:79]
s_setprio 0
s_waitcnt lgkmcnt(4)
v_mfma_f32_16x16x32_bf16 v[80:83], v[44:47], a[120:123], v[80:83]
s_setprio 1
ds_read_b128 v[32:35], v1 offset:8192
v_mfma_f32_16x16x32_bf16 v[84:87], v[44:47], a[124:127], v[84:87]
s_setprio 0
s_waitcnt lgkmcnt(4)
v_mfma_f32_16x16x32_bf16 v[48:51], v[16:19], a[128:131], v[48:51]
s_setprio 1
ds_read_b128 v[36:39], v1 offset:1024
v_mfma_f32_16x16x32_bf16 v[52:55], v[16:19], a[132:135], v[52:55]
s_setprio 0
s_waitcnt lgkmcnt(4)
v_mfma_f32_16x16x32_bf16 v[56:59], v[20:23], a[128:131], v[56:59]
s_setprio 1
ds_read_b128 v[40:43], v1 offset:3072
v_mfma_f32_16x16x32_bf16 v[60:63], v[20:23], a[132:135], v[60:63]
s_setprio 0
s_waitcnt lgkmcnt(4)
v_mfma_f32_16x16x32_bf16 v[64:67], v[24:27], a[128:131], v[64:67]
s_setprio 1
ds_read_b128 v[44:47], v1 offset:5120
v_mfma_f32_16x16x32_bf16 v[68:71], v[24:27], a[132:135], v[68:71]
s_setprio 0
s_waitcnt lgkmcnt(4)
v_mfma_f32_16x16x32_bf16 v[72:75], v[28:31], a[128:131], v[72:75]
s_setprio 1
ds_read_b128 v[16:19], v1 offset:7168
v_mfma_f32_16x16x32_bf16 v[76:79], v[28:31], a[132:135], v[76:79]
s_setprio 0
s_waitcnt lgkmcnt(4)
v_mfma_f32_16x16x32_bf16 v[80:83], v[32:35], a[128:131], v[80:83]
s_setprio 1
ds_read_b128 v[20:23], v1 offset:9216
v_mfma_f32_16x16x32_bf16 v[84:87], v[32:35], a[132:135], v[84:87]
s_setprio 0
s_waitcnt vmcnt(0)
s_barrier
s_waitcnt lgkmcnt(4)
v_mfma_f32_16x16x32_bf16 v[48:51], v[36:39], a[136:139], v[48:51]
s_setprio 1
ds_read_b128 v[24:27], v1 offset:49152
v_mfma_f32_16x16x32_bf16 v[52:55], v[36:39], a[140:143], v[52:55]
s_setprio 0
s_waitcnt lgkmcnt(4)
v_mfma_f32_16x16x32_bf16 v[56:59], v[40:43], a[136:139], v[56:59]
s_setprio 1
ds_read_b128 v[28:31], v1 offset:51200
v_mfma_f32_16x16x32_bf16 v[60:63], v[40:43], a[140:143], v[60:63]
s_setprio 0
s_waitcnt lgkmcnt(4)
v_mfma_f32_16x16x32_bf16 v[64:67], v[44:47], a[136:139], v[64:67]
s_setprio 1
ds_read_b128 v[32:35], v1 offset:53248
v_mfma_f32_16x16x32_bf16 v[68:71], v[44:47], a[140:143], v[68:71]
s_setprio 0
s_lshl_b32 s60, s3, 11
s_add_u32 s60, s60, 148480
s_cmp_eq_u32 s3, 7
s_cselect_b32 s60, 68096, s60
v_add_u32 v5, s60, v3
v_bfe_u32 v6, v3, 4, 4
v_lshrrev_b32 v7, 8, v3
v_mul_u32_u24 v8, 320, v7
v_lshl_add_u32 v8, v6, 2, v8
s_lshl_b32 s60, s7, 2
s_add_u32 s60, s60, s4
s_mul_i32 s60, s60, 1792
s_add_u32 s60, s60, 0
v_mov_b32 v4, 0x7f000000
ds_read_b128 v[10:13], v5 offset:0
v_mov_b32 v9, v8
s_waitcnt lgkmcnt(0)
buffer_atomic_add_f32 v10, v9, s[40:43], s60 offen offset:0
buffer_atomic_add_f32 v11, v9, s[40:43], s60 offen offset:80
buffer_atomic_add_f32 v12, v9, s[40:43], s60 offen offset:160
buffer_atomic_add_f32 v13, v9, s[40:43], s60 offen offset:240
s_nop 1
ds_read_b128 v[10:13], v5 offset:1024
v_mov_b32 v9, v8
v_cmp_gt_u32 vcc, 4, v6
s_nop 1
v_cndmask_b32 v9, v4, v9, vcc
s_waitcnt lgkmcnt(0)
buffer_atomic_add_f32 v10, v9, s[40:43], s60 offen offset:64
buffer_atomic_add_f32 v11, v9, s[40:43], s60 offen offset:144
buffer_atomic_add_f32 v12, v9, s[40:43], s60 offen offset:224
buffer_atomic_add_f32 v13, v9, s[40:43], s60 offen offset:304
s_nop 1
v_mfma_f32_16x16x32_bf16 v[72:75], v[16:19], a[136:139], v[72:75]
s_setprio 1
ds_read_b128 v[36:39], v1 offset:55296
v_mfma_f32_16x16x32_bf16 v[76:79], v[16:19], a[140:143], v[76:79]
s_setprio 0
v_mfma_f32_16x16x32_bf16 v[80:83], v[20:23], a[136:139], v[80:83]
s_setprio 1
ds_read_b128 v[40:43], v1 offset:57344
v_mfma_f32_16x16x32_bf16 v[84:87], v[20:23], a[140:143], v[84:87]
s_setprio 0
v_mfma_f32_16x16x32_bf16 v[48:51], v[24:27], a[144:147], v[48:51]
s_setprio 1
ds_read_b128 v[44:47], v1 offset:50176
v_mfma_f32_16x16x32_bf16 v[52:55], v[24:27], a[148:151], v[52:55]
s_setprio 0
v_mfma_f32_16x16x32_bf16 v[56:59], v[28:31], a[144:147], v[56:59]
s_setprio 1
ds_read_b128 v[16:19], v1 offset:52224
v_mfma_f32_16x16x32_bf16 v[60:63], v[28:31], a[148:151], v[60:63]
s_setprio 0
v_mfma_f32_16x16x32_bf16 v[64:67], v[32:35], a[144:147], v[64:67]
s_setprio 1
ds_read_b128 v[20:23], v1 offset:54272
v_mfma_f32_16x16x32_bf16 v[68:71], v[32:35], a[148:151], v[68:71]
s_setprio 0
s_waitcnt lgkmcnt(4)
v_mfma_f32_16x16x32_bf16 v[72:75], v[36:39], a[144:147], v[72:75]
s_setprio 1
ds_read_b128 v[24:27], v1 offset:56320
v_mfma_f32_16x16x32_bf16 v[76:79], v[36:39], a[148:151], v[76:79]
s_setprio 0
s_waitcnt lgkmcnt(4)
v_mfma_f32_16x16x32_bf16 v[80:83], v[40:43], a[144:147], v[80:83]
s_setprio 1
ds_read_b128 v[28:31], v1 offset:58368
v_mfma_f32_16x16x32_bf16 v[84:87], v[40:43], a[148:151], v[84:87]
s_setprio 0
s_waitcnt lgkmcnt(4)
v_mfma_f32_16x16x32_bf16 v[48:51], v[44:47], a[152:155], v[48:51]
s_setprio 1
v_mfma_f32_16x16x32_bf16 v[52:55], v[44:47], a[156:159], v[52:55]
s_setprio 0
s_waitcnt lgkmcnt(3)
v_mfma_f32_16x16x32_bf16 v[56:59], v[16:19], a[152:155], v[56:59]
s_setprio 1
v_mfma_f32_16x16x32_bf16 v[60:63], v[16:19], a[156:159], v[60:63]
s_setprio 0
s_waitcnt lgkmcnt(2)
v_mfma_f32_16x16x32_bf16 v[64:67], v[20:23], a[152:155], v[64:67]
s_setprio 1
v_mfma_f32_16x16x32_bf16 v[68:71], v[20:23], a[156:159], v[68:71]
s_setprio 0
s_waitcnt lgkmcnt(1)
v_mfma_f32_16x16x32_bf16 v[72:75], v[24:27], a[152:155], v[72:75]
s_setprio 1
v_mfma_f32_16x16x32_bf16 v[76:79], v[24:27], a[156:159], v[76:79]
s_setprio 0
s_waitcnt lgkmcnt(0)
v_mfma_f32_16x16x32_bf16 v[80:83], v[28:31], a[152:155], v[80:83]
s_setprio 1
v_mfma_f32_16x16x32_bf16 v[84:87], v[28:31], a[156:159], v[84:87]
s_setprio 0
s_nop 5
s_mul_i32 s60, s7, 5120
s_add_u32 s60, s60, s54
s_add_u32 s61, s60, 4096
v_pk_mul_f32 v[16:17], v[48:49], s[80:81]
v_pk_mul_f32 v[18:19], v[50:51], s[80:81]
v_exp_f32_e64 v16, v16 clamp
v_exp_f32_e64 v17, v17 clamp
v_exp_f32_e64 v18, v18 clamp
v_exp_f32_e64 v19, v19 clamp
v_pk_add_f32 v[48:49], v[48:49], s[86:87]
v_pk_add_f32 v[50:51], v[50:51], s[86:87]
v_max_f32 v48, s86, v48
v_max_f32 v49, s86, v49
v_max_f32 v50, s86, v50
v_max_f32 v51, s86, v51
v_pk_add_f32 v[48:49], v[48:49], v[16:17]
v_pk_add_f32 v[50:51], v[50:51], v[18:19]
v_pk_mul_f32 v[16:17], v[52:53], s[80:81]
v_pk_mul_f32 v[18:19], v[54:55], s[80:81]
v_exp_f32_e64 v16, v16 clamp
v_exp_f32_e64 v17, v17 clamp
v_exp_f32_e64 v18, v18 clamp
v_exp_f32_e64 v19, v19 clamp
v_pk_add_f32 v[52:53], v[52:53], s[86:87]
v_pk_add_f32 v[54:55], v[54:55], s[86:87]
v_max_f32 v52, s86, v52
v_max_f32 v53, s86, v53
v_max_f32 v54, s86, v54
v_max_f32 v55, s86, v55
v_pk_add_f32 v[52:53], v[52:53], v[16:17]
v_pk_add_f32 v[54:55], v[54:55], v[18:19]
v_cvt_pk_bf16_f32 v20, v48, v49
v_cvt_pk_bf16_f32 v21, v50, v51
v_cvt_pk_bf16_f32 v22, v52, v53
v_cvt_pk_bf16_f32 v23, v54, v55
s_nop 1
v_permlane16_swap_b32 v20, v22
v_permlane16_swap_b32 v21, v23
s_nop 0
buffer_store_dwordx4 v[20:23], v3, s[36:39], s60 offen offset:0 sc1
v_pk_mul_f32 v[16:17], v[56:57], s[80:81]
v_pk_mul_f32 v[18:19], v[58:59], s[80:81]
v_exp_f32_e64 v16, v16 clamp
v_exp_f32_e64 v17, v17 clamp
v_exp_f32_e64 v18, v18 clamp
v_exp_f32_e64 v19, v19 clamp
v_pk_add_f32 v[56:57], v[56:57], s[86:87]
v_pk_add_f32 v[58:59], v[58:59], s[86:87]
v_max_f32 v56, s86, v56
v_max_f32 v57, s86, v57
v_max_f32 v58, s86, v58
v_max_f32 v59, s86, v59
v_pk_add_f32 v[56:57], v[56:57], v[16:17]
v_pk_add_f32 v[58:59], v[58:59], v[18:19]
v_pk_mul_f32 v[16:17], v[60:61], s[80:81]
v_pk_mul_f32 v[18:19], v[62:63], s[80:81]
v_exp_f32_e64 v16, v16 clamp
v_exp_f32_e64 v17, v17 clamp
v_exp_f32_e64 v18, v18 clamp
v_exp_f32_e64 v19, v19 clamp
v_pk_add_f32 v[60:61], v[60:61], s[86:87]
v_pk_add_f32 v[62:63], v[62:63], s[86:87]
v_max_f32 v60, s86, v60
v_max_f32 v61, s86, v61
v_max_f32 v62, s86, v62
v_max_f32 v63, s86, v63
v_pk_add_f32 v[60:61], v[60:61], v[16:17]
v_pk_add_f32 v[62:63], v[62:63], v[18:19]
v_cvt_pk_bf16_f32 v24, v56, v57
v_cvt_pk_bf16_f32 v25, v58, v59
v_cvt_pk_bf16_f32 v26, v60, v61
v_cvt_pk_bf16_f32 v27, v62, v63
s_nop 1
v_permlane16_swap_b32 v24, v26
v_permlane16_swap_b32 v25, v27
s_nop 0
buffer_store_dwordx4 v[24:27], v3, s[36:39], s60 offen offset:1024 sc1
v_pk_mul_f32 v[16:17], v[64:65], s[80:81]
v_pk_mul_f32 v[18:19], v[66:67], s[80:81]
v_exp_f32_e64 v16, v16 clamp
v_exp_f32_e64 v17, v17 clamp
v_exp_f32_e64 v18, v18 clamp
v_exp_f32_e64 v19, v19 clamp
v_pk_add_f32 v[64:65], v[64:65], s[86:87]
v_pk_add_f32 v[66:67], v[66:67], s[86:87]
v_max_f32 v64, s86, v64
v_max_f32 v65, s86, v65
v_max_f32 v66, s86, v66
v_max_f32 v67, s86, v67
v_pk_add_f32 v[64:65], v[64:65], v[16:17]
v_pk_add_f32 v[66:67], v[66:67], v[18:19]
v_pk_mul_f32 v[16:17], v[68:69], s[80:81]
v_pk_mul_f32 v[18:19], v[70:71], s[80:81]
v_exp_f32_e64 v16, v16 clamp
v_exp_f32_e64 v17, v17 clamp
v_exp_f32_e64 v18, v18 clamp
v_exp_f32_e64 v19, v19 clamp
v_pk_add_f32 v[68:69], v[68:69], s[86:87]
v_pk_add_f32 v[70:71], v[70:71], s[86:87]
v_max_f32 v68, s86, v68
v_max_f32 v69, s86, v69
v_max_f32 v70, s86, v70
v_max_f32 v71, s86, v71
v_pk_add_f32 v[68:69], v[68:69], v[16:17]
v_pk_add_f32 v[70:71], v[70:71], v[18:19]
v_cvt_pk_bf16_f32 v20, v64, v65
v_cvt_pk_bf16_f32 v21, v66, v67
v_cvt_pk_bf16_f32 v22, v68, v69
v_cvt_pk_bf16_f32 v23, v70, v71
s_nop 1
v_permlane16_swap_b32 v20, v22
v_permlane16_swap_b32 v21, v23
s_nop 0
buffer_store_dwordx4 v[20:23], v3, s[36:39], s60 offen offset:2048 sc1
v_pk_mul_f32 v[16:17], v[72:73], s[80:81]
v_pk_mul_f32 v[18:19], v[74:75], s[80:81]
v_exp_f32_e64 v16, v16 clamp
v_exp_f32_e64 v17, v17 clamp
v_exp_f32_e64 v18, v18 clamp
v_exp_f32_e64 v19, v19 clamp
v_pk_add_f32 v[72:73], v[72:73], s[86:87]
v_pk_add_f32 v[74:75], v[74:75], s[86:87]
v_max_f32 v72, s86, v72
v_max_f32 v73, s86, v73
v_max_f32 v74, s86, v74
v_max_f32 v75, s86, v75
v_pk_add_f32 v[72:73], v[72:73], v[16:17]
v_pk_add_f32 v[74:75], v[74:75], v[18:19]
v_pk_mul_f32 v[16:17], v[76:77], s[80:81]
v_pk_mul_f32 v[18:19], v[78:79], s[80:81]
v_exp_f32_e64 v16, v16 clamp
v_exp_f32_e64 v17, v17 clamp
v_exp_f32_e64 v18, v18 clamp
v_exp_f32_e64 v19, v19 clamp
v_pk_add_f32 v[76:77], v[76:77], s[86:87]
v_pk_add_f32 v[78:79], v[78:79], s[86:87]
v_max_f32 v76, s86, v76
v_max_f32 v77, s86, v77
v_max_f32 v78, s86, v78
v_max_f32 v79, s86, v79
v_pk_add_f32 v[76:77], v[76:77], v[16:17]
v_pk_add_f32 v[78:79], v[78:79], v[18:19]
v_cvt_pk_bf16_f32 v24, v72, v73
v_cvt_pk_bf16_f32 v25, v74, v75
v_cvt_pk_bf16_f32 v26, v76, v77
v_cvt_pk_bf16_f32 v27, v78, v79
s_nop 1
v_permlane16_swap_b32 v24, v26
v_permlane16_swap_b32 v25, v27
s_nop 0
buffer_store_dwordx4 v[24:27], v3, s[36:39], s60 offen offset:3072 sc1
v_pk_mul_f32 v[16:17], v[80:81], s[80:81]
v_pk_mul_f32 v[18:19], v[82:83], s[80:81]
v_exp_f32_e64 v16, v16 clamp
v_exp_f32_e64 v17, v17 clamp
v_exp_f32_e64 v18, v18 clamp
v_exp_f32_e64 v19, v19 clamp
v_pk_add_f32 v[80:81], v[80:81], s[86:87]
v_pk_add_f32 v[82:83], v[82:83], s[86:87]
v_max_f32 v80, s86, v80
v_max_f32 v81, s86, v81
v_max_f32 v82, s86, v82
v_max_f32 v83, s86, v83
v_pk_add_f32 v[80:81], v[80:81], v[16:17]
v_pk_add_f32 v[82:83], v[82:83], v[18:19]
v_pk_mul_f32 v[16:17], v[84:85], s[80:81]
v_pk_mul_f32 v[18:19], v[86:87], s[80:81]
v_exp_f32_e64 v16, v16 clamp
v_exp_f32_e64 v17, v17 clamp
v_exp_f32_e64 v18, v18 clamp
v_exp_f32_e64 v19, v19 clamp
v_pk_add_f32 v[84:85], v[84:85], s[86:87]
v_pk_add_f32 v[86:87], v[86:87], s[86:87]
v_max_f32 v84, s86, v84
v_max_f32 v85, s86, v85
v_max_f32 v86, s86, v86
v_max_f32 v87, s86, v87
v_pk_add_f32 v[84:85], v[84:85], v[16:17]
v_pk_add_f32 v[86:87], v[86:87], v[18:19]
v_cvt_pk_bf16_f32 v20, v80, v81
v_cvt_pk_bf16_f32 v21, v82, v83
v_cvt_pk_bf16_f32 v22, v84, v85
v_cvt_pk_bf16_f32 v23, v86, v87
s_nop 1
v_permlane16_swap_b32 v20, v22
v_permlane16_swap_b32 v21, v23
s_nop 0
buffer_store_dwordx4 v[20:23], v3, s[36:39], s61 offen offset:0 sc1
s_branch k1_kernel_end
k1_kernel_A1:
s_mul_i32 s60, s7, 5
s_mul_i32 s56, s7, 3
s_lshl_b32 s62, s60, 1
s_add_u32 s62, s62, 45
s_lshl_b32 s63, s56, 1
s_add_u32 s63, s63, 120
s_mul_i32 s64, s4, 3
s_min_u32 s64, s64, 7
s_lshl_b32 s50, s64, 10
s_lshl_b32 s52, s62, 11
s_add_u32 s52, s52, s50
s_sub_u32 s52, s52, 688128
s_mul_i32 s64, s4, 3
s_min_u32 s64, s64, 9
s_lshl_b32 s51, s64, 10
s_lshl_b32 s53, s63, 11
s_add_u32 s53, s53, s51
s_sub_u32 s53, s53, 688128
s_waitcnt lgkmcnt(0)
s_add_u32 s28, s26, 0x1000000
s_addc_u32 s29, s27, 0
s_mov_b32 s30, 0x280000
s_mov_b32 s31, 0x20000
s_add_u32 s32, s26, 0x2000000
s_addc_u32 s33, s27, 0
s_mov_b32 s34, 0x690000
s_mov_b32 s35, 0x20000
s_add_u32 s49, s49, 4096
s_add_u32 m0, s48, 0x5000
s_nop 0
buffer_load_dwordx4 v3, s[28:31], s49 offen offset:2048 lds
buffer_load_dwordx4 v3, s[28:31], s49 offen offset:3072 lds
s_add_u32 s52, s52, 688128
s_add_u32 m0, s50, 0x2800
s_nop 0
buffer_load_dwordx4 v3, s[32:35], s52 offen offset:0 lds
buffer_load_dwordx4 v3, s[32:35], s52 offen offset:1024 lds
buffer_load_dwordx4 v3, s[32:35], s52 offen offset:2048 lds
s_add_u32 s49, s49, 4096
s_add_u32 m0, s48, 0xe000
s_nop 0
buffer_load_dwordx4 v3, s[28:31], s49 offen offset:2048 lds
buffer_load_dwordx4 v3, s[28:31], s49 offen offset:3072 lds
s_add_u32 s52, s52, 688128
s_add_u32 m0, s50, 0xb800
s_nop 0
buffer_load_dwordx4 v3, s[32:35], s52 offen offset:0 lds
buffer_load_dwordx4 v3, s[32:35], s52 offen offset:1024 lds
buffer_load_dwordx4 v3, s[32:35], s52 offen offset:2048 lds
s_add_u32 s49, s49, 4096
s_add_u32 m0, s48, 0x17000
s_nop 0
buffer_load_dwordx4 v3, s[28:31], s49 offen offset:2048 lds
buffer_load_dwordx4 v3, s[28:31], s49 offen offset:3072 lds
s_add_u32 s52, s52, 688128
s_add_u32 m0, s50, 0x14800
s_nop 0
buffer_load_dwordx4 v3, s[32:35], s52 offen offset:0 lds
buffer_load_dwordx4 v3, s[32:35], s52 offen offset:1024 lds
buffer_load_dwordx4 v3, s[32:35], s52 offen offset:2048 lds
s_mov_b32 s36, s26
s_mov_b32 s37, s27
s_mov_b32 s38, 0x940000
s_mov_b32 s39, 0x20000
s_add_u32 s40, s26, 0xe00000
s_addc_u32 s41, s27, 0
s_mov_b32 s42, 0xe000
s_mov_b32 s43, 0x20000
s_add_u32 s44, s26, 0x1400000
s_addc_u32 s45, s27, 0
s_mov_b32 s46, 0x100000
s_mov_b32 s47, 0x20000
v_add_u32 v1, 10240, v3
s_mov_b32 s80, 0x3fb8aa3b
s_mov_b32 s81, 0x3fb8aa3b
s_mov_b32 s82, 0xbfb8aa3b
s_mov_b32 s83, 0xbfb8aa3b
s_mov_b32 s84, 0x3f800000
s_mov_b32 s85, 0x3f800000
s_mov_b32 s86, 0x358637bd
s_mov_b32 s87, 0x358637bd
s_waitcnt vmcnt(10)
s_barrier
ds_read_b128 a[0:3], v2 offset:0
ds_read_b128 a[4:7], v2 offset:1024
ds_read_b128 a[8:11], v2 offset:2048
ds_read_b128 a[12:15], v2 offset:3072
ds_read_b128 v[16:19], v1 offset:0
ds_read_b128 v[20:23], v1 offset:2048
ds_read_b128 v[24:27], v1 offset:4096
ds_read_b128 v[28:31], v1 offset:6144
ds_read_b128 v[32:35], v1 offset:8192
s_waitcnt lgkmcnt(4)
v_mfma_f32_16x16x32_bf16 v[48:51], a[0:3], v[16:19], 0
s_setprio 1
ds_read_b128 v[36:39], v1 offset:1024
v_mfma_f32_16x16x32_bf16 v[52:55], a[4:7], v[16:19], 0
s_setprio 0
s_waitcnt lgkmcnt(4)
v_mfma_f32_16x16x32_bf16 v[56:59], a[0:3], v[20:23], 0
s_setprio 1
ds_read_b128 v[40:43], v1 offset:3072
v_mfma_f32_16x16x32_bf16 v[60:63], a[4:7], v[20:23], 0
s_setprio 0
s_waitcnt lgkmcnt(4)
v_mfma_f32_16x16x32_bf16 v[64:67], a[0:3], v[24:27], 0
s_setprio 1
ds_read_b128 v[44:47], v1 offset:5120
v_mfma_f32_16x16x32_bf16 v[68:71], a[4:7], v[24:27], 0
s_setprio 0
s_waitcnt lgkmcnt(4)
v_mfma_f32_16x16x32_bf16 v[72:75], a[0:3], v[28:31], 0
s_setprio 1
ds_read_b128 v[16:19], v1 offset:7168
v_mfma_f32_16x16x32_bf16 v[76:79], a[4:7], v[28:31], 0
s_setprio 0
s_waitcnt lgkmcnt(4)
v_mfma_f32_16x16x32_bf16 v[80:83], a[0:3], v[32:35], 0
s_setprio 1
ds_read_b128 v[20:23], v1 offset:9216
v_mfma_f32_16x16x32_bf16 v[84:87], a[4:7], v[32:35], 0
s_setprio 0
s_waitcnt vmcnt(5)
s_barrier
s_waitcnt lgkmcnt(4)
v_mfma_f32_16x16x32_bf16 v[48:51], a[8:11], v[36:39], v[48:51]
s_setprio 1
ds_read_b128 v[24:27], v1 offset:36864
ds_read_b128 a[16:19], v2 offset:36864
ds_read_b128 a[20:23], v2 offset:37888
v_mfma_f32_16x16x32_bf16 v[52:55], a[12:15], v[36:39], v[52:55]
s_setprio 0
s_waitcnt lgkmcnt(6)
v_mfma_f32_16x16x32_bf16 v[56:59], a[8:11], v[40:43], v[56:59]
s_setprio 1
ds_read_b128 v[28:31], v1 offset:38912
ds_read_b128 a[24:27], v2 offset:38912
ds_read_b128 a[28:31], v2 offset:39936
v_mfma_f32_16x16x32_bf16 v[60:63], a[12:15], v[40:43], v[60:63]
s_setprio 0
s_add_u32 s49, s49, 4096
s_add_u32 m0, s48, 0x20000
s_nop 0
buffer_load_dwordx4 v3, s[28:31], s49 offen offset:2048 lds
buffer_load_dwordx4 v3, s[28:31], s49 offen offset:3072 lds
s_waitcnt lgkmcnt(8)
v_mfma_f32_16x16x32_bf16 v[64:67], a[8:11], v[44:47], v[64:67]
s_setprio 1
ds_read_b128 v[32:35], v1 offset:40960
v_mfma_f32_16x16x32_bf16 v[68:71], a[12:15], v[44:47], v[68:71]
s_setprio 0
s_waitcnt lgkmcnt(8)
v_mfma_f32_16x16x32_bf16 v[72:75], a[8:11], v[16:19], v[72:75]
s_setprio 1
ds_read_b128 v[36:39], v1 offset:43008
v_mfma_f32_16x16x32_bf16 v[76:79], a[12:15], v[16:19], v[76:79]
s_setprio 0
s_waitcnt lgkmcnt(8)
v_mfma_f32_16x16x32_bf16 v[80:83], a[8:11], v[20:23], v[80:83]
s_setprio 1
ds_read_b128 v[40:43], v1 offset:45056
v_mfma_f32_16x16x32_bf16 v[84:87], a[12:15], v[20:23], v[84:87]
s_setprio 0
s_waitcnt lgkmcnt(8)
s_waitcnt lgkmcnt(7)
s_waitcnt lgkmcnt(6)
v_mfma_f32_16x16x32_bf16 v[48:51], a[16:19], v[24:27], v[48:51]
s_setprio 1
ds_read_b128 v[44:47], v1 offset:37888
v_mfma_f32_16x16x32_bf16 v[52:55], a[20:23], v[24:27], v[52:55]
s_setprio 0
s_waitcnt lgkmcnt(6)
v_mfma_f32_16x16x32_bf16 v[56:59], a[16:19], v[28:31], v[56:59]
s_setprio 1
ds_read_b128 v[16:19], v1 offset:39936
v_mfma_f32_16x16x32_bf16 v[60:63], a[20:23], v[28:31], v[60:63]
s_setprio 0
s_add_u32 s52, s52, 688128
s_add_u32 m0, s50, 0x1d800
s_nop 0
buffer_load_dwordx4 v3, s[32:35], s52 offen offset:0 lds
buffer_load_dwordx4 v3, s[32:35], s52 offen offset:1024 lds
buffer_load_dwordx4 v3, s[32:35], s52 offen offset:2048 lds
s_waitcnt lgkmcnt(4)
v_mfma_f32_16x16x32_bf16 v[64:67], a[16:19], v[32:35], v[64:67]
s_setprio 1
ds_read_b128 v[20:23], v1 offset:41984
v_mfma_f32_16x16x32_bf16 v[68:71], a[20:23], v[32:35], v[68:71]
s_setprio 0
s_waitcnt lgkmcnt(4)
v_mfma_f32_16x16x32_bf16 v[72:75], a[16:19], v[36:39], v[72:75]
s_setprio 1
ds_read_b128 v[24:27], v1 offset:44032
v_mfma_f32_16x16x32_bf16 v[76:79], a[20:23], v[36:39], v[76:79]
s_setprio 0
s_waitcnt lgkmcnt(4)
v_mfma_f32_16x16x32_bf16 v[80:83], a[16:19], v[40:43], v[80:83]
s_setprio 1
ds_read_b128 v[28:31], v1 offset:46080
v_mfma_f32_16x16x32_bf16 v[84:87], a[20:23], v[40:43], v[84:87]
s_setprio 0
s_waitcnt vmcnt(5)
s_barrier
s_waitcnt lgkmcnt(4)
v_mfma_f32_16x16x32_bf16 v[48:51], a[24:27], v[44:47], v[48:51]
s_setprio 1
v_add_u32 v1, 0x12000, v1
ds_read_b128 v[32:35], v1 offset:0
v_add_u32 v2, 0x12000, v2
ds_read_b128 a[32:35], v2 offset:0
ds_read_b128 a[36:39], v2 offset:1024
v_mfma_f32_16x16x32_bf16 v[52:55], a[28:31], v[44:47], v[52:55]
s_setprio 0
s_waitcnt lgkmcnt(6)
v_mfma_f32_16x16x32_bf16 v[56:59], a[24:27], v[16:19], v[56:59]
s_setprio 1
ds_read_b128 v[36:39], v1 offset:2048
ds_read_b128 a[40:43], v2 offset:2048
ds_read_b128 a[44:47], v2 offset:3072
v_mfma_f32_16x16x32_bf16 v[60:63], a[28:31], v[16:19], v[60:63]
s_setprio 0
s_add_u32 s49, s49, 4096
s_add_u32 m0, s48, 0x5000
s_nop 0
buffer_load_dwordx4 v3, s[28:31], s49 offen offset:2048 lds
buffer_load_dwordx4 v3, s[28:31], s49 offen offset:3072 lds
s_waitcnt lgkmcnt(8)
v_mfma_f32_16x16x32_bf16 v[64:67], a[24:27], v[20:23], v[64:67]
s_setprio 1
ds_read_b128 v[40:43], v1 offset:4096
v_mfma_f32_16x16x32_bf16 v[68:71], a[28:31], v[20:23], v[68:71]
s_setprio 0
s_waitcnt lgkmcnt(8)
v_mfma_f32_16x16x32_bf16 v[72:75], a[24:27], v[24:27], v[72:75]
s_setprio 1
ds_read_b128 v[44:47], v1 offset:6144
v_mfma_f32_16x16x32_bf16 v[76:79], a[28:31], v[24:27], v[76:79]
s_setprio 0
s_waitcnt lgkmcnt(8)
v_mfma_f32_16x16x32_bf16 v[80:83], a[24:27], v[28:31], v[80:83]
s_setprio 1
ds_read_b128 v[16:19], v1 offset:8192
v_mfma_f32_16x16x32_bf16 v[84:87], a[28:31], v[28:31], v[84:87]
s_setprio 0
s_waitcnt lgkmcnt(8)
s_waitcnt lgkmcnt(7)
s_waitcnt lgkmcnt(6)
v_mfma_f32_16x16x32_bf16 v[48:51], a[32:35], v[32:35], v[48:51]
s_setprio 1
ds_read_b128 v[20:23], v1 offset:1024
v_mfma_f32_16x16x32_bf16 v[52:55], a[36:39], v[32:35], v[52:55]
s_setprio 0
s_waitcnt lgkmcnt(6)
v_mfma_f32_16x16x32_bf16 v[56:59], a[32:35], v[36:39], v[56:59]
s_setprio 1
ds_read_b128 v[24:27], v1 offset:3072
v_mfma_f32_16x16x32_bf16 v[60:63], a[36:39], v[36:39], v[60:63]
s_setprio 0
s_add_u32 s52, s52, 688128
s_add_u32 m0, s50, 0x2800
s_nop 0
buffer_load_dwordx4 v3, s[32:35], s52 offen offset:0 lds
buffer_load_dwordx4 v3, s[32:35], s52 offen offset:1024 lds
buffer_load_dwordx4 v3, s[32:35], s52 offen offset:2048 lds
s_waitcnt lgkmcnt(4)
v_mfma_f32_16x16x32_bf16 v[64:67], a[32:35], v[40:43], v[64:67]
s_setprio 1
ds_read_b128 v[28:31], v1 offset:5120
v_mfma_f32_16x16x32_bf16 v[68:71], a[36:39], v[40:43], v[68:71]
s_setprio 0
s_waitcnt lgkmcnt(4)
v_mfma_f32_16x16x32_bf16 v[72:75], a[32:35], v[44:47], v[72:75]
s_setprio 1
ds_read_b128 v[32:35], v1 offset:7168
v_mfma_f32_16x16x32_bf16 v[76:79], a[36:39], v[44:47], v[76:79]
s_setprio 0
s_waitcnt lgkmcnt(4)
v_mfma_f32_16x16x32_bf16 v[80:83], a[32:35], v[16:19], v[80:83]
s_setprio 1
ds_read_b128 v[36:39], v1 offset:9216
v_mfma_f32_16x16x32_bf16 v[84:87], a[36:39], v[16:19], v[84:87]
s_setprio 0
s_waitcnt vmcnt(5)
s_barrier
s_waitcnt lgkmcnt(4)
v_mfma_f32_16x16x32_bf16 v[48:51], a[40:43], v[20:23], v[48:51]
s_setprio 1
ds_read_b128 v[40:43], v1 offset:36864
ds_read_b128 a[48:51], v2 offset:36864
ds_read_b128 a[52:55], v2 offset:37888
v_mfma_f32_16x16x32_bf16 v[52:55], a[44:47], v[20:23], v[52:55]
s_setprio 0
s_waitcnt lgkmcnt(6)
v_mfma_f32_16x16x32_bf16 v[56:59], a[40:43], v[24:27], v[56:59]
s_setprio 1
ds_read_b128 v[44:47], v1 offset:38912
ds_read_b128 a[56:59], v2 offset:38912
ds_read_b128 a[60:63], v2 offset:39936
v_mfma_f32_16x16x32_bf16 v[60:63], a[44:47], v[24:27], v[60:63]
s_setprio 0
s_add_u32 s49, s49, 4096
s_add_u32 m0, s48, 0xe000
s_nop 0
buffer_load_dwordx4 v3, s[28:31], s49 offen offset:2048 lds
buffer_load_dwordx4 v3, s[28:31], s49 offen offset:3072 lds
s_waitcnt lgkmcnt(8)
v_mfma_f32_16x16x32_bf16 v[64:67], a[40:43], v[28:31], v[64:67]
s_setprio 1
ds_read_b128 v[16:19], v1 offset:40960
v_mfma_f32_16x16x32_bf16 v[68:71], a[44:47], v[28:31], v[68:71]
s_setprio 0
s_waitcnt lgkmcnt(8)
v_mfma_f32_16x16x32_bf16 v[72:75], a[40:43], v[32:35], v[72:75]
s_setprio 1
ds_read_b128 v[20:23], v1 offset:43008
v_mfma_f32_16x16x32_bf16 v[76:79], a[44:47], v[32:35], v[76:79]
s_setprio 0
s_waitcnt lgkmcnt(8)
v_mfma_f32_16x16x32_bf16 v[80:83], a[40:43], v[36:39], v[80:83]
s_setprio 1
ds_read_b128 v[24:27], v1 offset:45056
v_mfma_f32_16x16x32_bf16 v[84:87], a[44:47], v[36:39], v[84:87]
s_setprio 0
s_waitcnt lgkmcnt(8)
s_waitcnt lgkmcnt(7)
s_waitcnt lgkmcnt(6)
v_mfma_f32_16x16x32_bf16 v[48:51], a[48:51], v[40:43], v[48:51]
s_setprio 1
ds_read_b128 v[28:31], v1 offset:37888
v_mfma_f32_16x16x32_bf16 v[52:55], a[52:55], v[40:43], v[52:55]
s_setprio 0
s_waitcnt lgkmcnt(6)
v_mfma_f32_16x16x32_bf16 v[56:59], a[48:51], v[44:47], v[56:59]
s_setprio 1
ds_read_b128 v[32:35], v1 offset:39936
v_mfma_f32_16x16x32_bf16 v[60:63], a[52:55], v[44:47], v[60:63]
s_setprio 0
s_add_u32 s52, s52, 688128
s_add_u32 m0, s50, 0xb800
s_nop 0
buffer_load_dwordx4 v3, s[32:35], s52 offen offset:0 lds
buffer_load_dwordx4 v3, s[32:35], s52 offen offset:1024 lds
buffer_load_dwordx4 v3, s[32:35], s52 offen offset:2048 lds
s_waitcnt lgkmcnt(4)
v_mfma_f32_16x16x32_bf16 v[64:67], a[48:51], v[16:19], v[64:67]
s_setprio 1
ds_read_b128 v[36:39], v1 offset:41984
v_mfma_f32_16x16x32_bf16 v[68:71], a[52:55], v[16:19], v[68:71]
s_setprio 0
s_waitcnt lgkmcnt(4)
v_mfma_f32_16x16x32_bf16 v[72:75], a[48:51], v[20:23], v[72:75]
s_setprio 1
ds_read_b128 v[40:43], v1 offset:44032
v_mfma_f32_16x16x32_bf16 v[76:79], a[52:55], v[20:23], v[76:79]
s_setprio 0
s_waitcnt lgkmcnt(4)
v_mfma_f32_16x16x32_bf16 v[80:83], a[48:51], v[24:27], v[80:83]
s_setprio 1
ds_read_b128 v[44:47], v1 offset:46080
v_mfma_f32_16x16x32_bf16 v[84:87], a[52:55], v[24:27], v[84:87]
s_setprio 0
s_waitcnt vmcnt(5)
s_barrier
s_waitcnt lgkmcnt(4)
v_mfma_f32_16x16x32_bf16 v[48:51], a[56:59], v[28:31], v[48:51]
s_setprio 1
v_add_u32 v1, 0xfffee000, v1
ds_read_b128 v[16:19], v1 offset:0
v_add_u32 v2, 0xfffee000, v2
ds_read_b128 a[64:67], v2 offset:0
ds_read_b128 a[68:71], v2 offset:1024
v_mfma_f32_16x16x32_bf16 v[52:55], a[60:63], v[28:31], v[52:55]
s_setprio 0
s_waitcnt lgkmcnt(6)
v_mfma_f32_16x16x32_bf16 v[56:59], a[56:59], v[32:35], v[56:59]
s_setprio 1
ds_read_b128 v[20:23], v1 offset:2048
ds_read_b128 a[72:75], v2 offset:2048
ds_read_b128 a[76:79], v2 offset:3072
v_mfma_f32_16x16x32_bf16 v[60:63], a[60:63], v[32:35], v[60:63]
s_setprio 0
s_add_u32 s49, s49, 4096
s_add_u32 m0, s48, 0x17000
s_nop 0
buffer_load_dwordx4 v3, s[28:31], s49 offen offset:2048 lds
buffer_load_dwordx4 v3, s[28:31], s49 offen offset:3072 lds
s_waitcnt lgkmcnt(8)
v_mfma_f32_16x16x32_bf16 v[64:67], a[56:59], v[36:39], v[64:67]
s_setprio 1
ds_read_b128 v[24:27], v1 offset:4096
v_mfma_f32_16x16x32_bf16 v[68:71], a[60:63], v[36:39], v[68:71]
s_setprio 0
s_waitcnt lgkmcnt(8)
v_mfma_f32_16x16x32_bf16 v[72:75], a[56:59], v[40:43], v[72:75]
s_setprio 1
ds_read_b128 v[28:31], v1 offset:6144
v_mfma_f32_16x16x32_bf16 v[76:79], a[60:63], v[40:43], v[76:79]
s_setprio 0
s_waitcnt lgkmcnt(8)
v_mfma_f32_16x16x32_bf16 v[80:83], a[56:59], v[44:47], v[80:83]
s_setprio 1
ds_read_b128 v[32:35], v1 offset:8192
v_mfma_f32_16x16x32_bf16 v[84:87], a[60:63], v[44:47], v[84:87]
s_setprio 0
s_waitcnt lgkmcnt(8)
s_waitcnt lgkmcnt(7)
s_waitcnt lgkmcnt(6)
v_mfma_f32_16x16x32_bf16 v[48:51], a[64:67], v[16:19], v[48:51]
s_setprio 1
ds_read_b128 v[36:39], v1 offset:1024
v_mfma_f32_16x16x32_bf16 v[52:55], a[68:71], v[16:19], v[52:55]
s_setprio 0
s_waitcnt lgkmcnt(6)
v_mfma_f32_16x16x32_bf16 v[56:59], a[64:67], v[20:23], v[56:59]
s_setprio 1
ds_read_b128 v[40:43], v1 offset:3072
v_mfma_f32_16x16x32_bf16 v[60:63], a[68:71], v[20:23], v[60:63]
s_setprio 0
s_add_u32 s52, s52, 688128
s_add_u32 m0, s50, 0x14800
s_nop 0
buffer_load_dwordx4 v3, s[32:35], s52 offen offset:0 lds
buffer_load_dwordx4 v3, s[32:35], s52 offen offset:1024 lds
buffer_load_dwordx4 v3, s[32:35], s52 offen offset:2048 lds
s_waitcnt lgkmcnt(4)
v_mfma_f32_16x16x32_bf16 v[64:67], a[64:67], v[24:27], v[64:67]
s_setprio 1
ds_read_b128 v[44:47], v1 offset:5120
v_mfma_f32_16x16x32_bf16 v[68:71], a[68:71], v[24:27], v[68:71]
s_setprio 0
s_waitcnt lgkmcnt(4)
v_mfma_f32_16x16x32_bf16 v[72:75], a[64:67], v[28:31], v[72:75]
s_setprio 1
ds_read_b128 v[16:19], v1 offset:7168
v_mfma_f32_16x16x32_bf16 v[76:79], a[68:71], v[28:31], v[76:79]
s_setprio 0
s_waitcnt lgkmcnt(4)
v_mfma_f32_16x16x32_bf16 v[80:83], a[64:67], v[32:35], v[80:83]
s_setprio 1
ds_read_b128 v[20:23], v1 offset:9216
v_mfma_f32_16x16x32_bf16 v[84:87], a[68:71], v[32:35], v[84:87]
s_setprio 0
s_waitcnt vmcnt(5)
s_barrier
s_waitcnt lgkmcnt(4)
v_mfma_f32_16x16x32_bf16 v[48:51], a[72:75], v[36:39], v[48:51]
s_setprio 1
ds_read_b128 v[24:27], v1 offset:36864
ds_read_b128 a[80:83], v2 offset:36864
ds_read_b128 a[84:87], v2 offset:37888
v_mfma_f32_16x16x32_bf16 v[52:55], a[76:79], v[36:39], v[52:55]
s_setprio 0
s_waitcnt lgkmcnt(6)
v_mfma_f32_16x16x32_bf16 v[56:59], a[72:75], v[40:43], v[56:59]
s_setprio 1
ds_read_b128 v[28:31], v1 offset:38912
ds_read_b128 a[88:91], v2 offset:38912
ds_read_b128 a[92:95], v2 offset:39936
v_mfma_f32_16x16x32_bf16 v[60:63], a[76:79], v[40:43], v[60:63]
s_setprio 0
s_add_u32 s49, s49, 4096
s_add_u32 m0, s48, 0x20000
s_nop 0
buffer_load_dwordx4 v3, s[28:31], s49 offen offset:2048 lds
buffer_load_dwordx4 v3, s[28:31], s49 offen offset:3072 lds
s_waitcnt lgkmcnt(8)
v_mfma_f32_16x16x32_bf16 v[64:67], a[72:75], v[44:47], v[64:67]
s_setprio 1
ds_read_b128 v[32:35], v1 offset:40960
v_mfma_f32_16x16x32_bf16 v[68:71], a[76:79], v[44:47], v[68:71]
s_setprio 0
s_waitcnt lgkmcnt(8)
v_mfma_f32_16x16x32_bf16 v[72:75], a[72:75], v[16:19], v[72:75]
s_setprio 1
ds_read_b128 v[36:39], v1 offset:43008
v_mfma_f32_16x16x32_bf16 v[76:79], a[76:79], v[16:19], v[76:79]
s_setprio 0
s_waitcnt lgkmcnt(8)
v_mfma_f32_16x16x32_bf16 v[80:83], a[72:75], v[20:23], v[80:83]
s_setprio 1
ds_read_b128 v[40:43], v1 offset:45056
v_mfma_f32_16x16x32_bf16 v[84:87], a[76:79], v[20:23], v[84:87]
s_setprio 0
s_waitcnt lgkmcnt(8)
s_waitcnt lgkmcnt(7)
s_waitcnt lgkmcnt(6)
v_mfma_f32_16x16x32_bf16 v[48:51], a[80:83], v[24:27], v[48:51]
s_setprio 1
ds_read_b128 v[44:47], v1 offset:37888
v_mfma_f32_16x16x32_bf16 v[52:55], a[84:87], v[24:27], v[52:55]
s_setprio 0
s_waitcnt lgkmcnt(6)
v_mfma_f32_16x16x32_bf16 v[56:59], a[80:83], v[28:31], v[56:59]
s_setprio 1
ds_read_b128 v[16:19], v1 offset:39936
v_mfma_f32_16x16x32_bf16 v[60:63], a[84:87], v[28:31], v[60:63]
s_setprio 0
s_add_u32 s52, s52, 688128
s_add_u32 m0, s50, 0x1d800
s_nop 0
buffer_load_dwordx4 v3, s[32:35], s52 offen offset:0 lds
buffer_load_dwordx4 v3, s[32:35], s52 offen offset:1024 lds
buffer_load_dwordx4 v3, s[32:35], s52 offen offset:2048 lds
s_waitcnt lgkmcnt(4)
v_mfma_f32_16x16x32_bf16 v[64:67], a[80:83], v[32:35], v[64:67]
s_setprio 1
ds_read_b128 v[20:23], v1 offset:41984
v_mfma_f32_16x16x32_bf16 v[68:71], a[84:87], v[32:35], v[68:71]
s_setprio 0
s_waitcnt lgkmcnt(4)
v_mfma_f32_16x16x32_bf16 v[72:75], a[80:83], v[36:39], v[72:75]
s_setprio 1
ds_read_b128 v[24:27], v1 offset:44032
v_mfma_f32_16x16x32_bf16 v[76:79], a[84:87], v[36:39], v[76:79]
s_setprio 0
s_waitcnt lgkmcnt(4)
v_mfma_f32_16x16x32_bf16 v[80:83], a[80:83], v[40:43], v[80:83]
s_setprio 1
ds_read_b128 v[28:31], v1 offset:46080
v_mfma_f32_16x16x32_bf16 v[84:87], a[84:87], v[40:43], v[84:87]
s_setprio 0
s_waitcnt vmcnt(5)
s_barrier
s_waitcnt lgkmcnt(4)
v_mfma_f32_16x16x32_bf16 v[48:51], a[88:91], v[44:47], v[48:51]
s_setprio 1
v_add_u32 v1, 0x12000, v1
ds_read_b128 v[32:35], v1 offset:0
v_add_u32 v2, 0x12000, v2
ds_read_b128 a[96:99], v2 offset:0
ds_read_b128 a[100:103], v2 offset:1024
v_mfma_f32_16x16x32_bf16 v[52:55], a[92:95], v[44:47], v[52:55]
s_setprio 0
s_waitcnt lgkmcnt(6)
v_mfma_f32_16x16x32_bf16 v[56:59], a[88:91], v[16:19], v[56:59]
s_setprio 1
ds_read_b128 v[36:39], v1 offset:2048
ds_read_b128 a[104:107], v2 offset:2048
ds_read_b128 a[108:111], v2 offset:3072
v_mfma_f32_16x16x32_bf16 v[60:63], a[92:95], v[16:19], v[60:63]
s_setprio 0
s_add_u32 s49, s49, 4096
s_add_u32 m0, s48, 0x5000
s_nop 0
buffer_load_dwordx4 v3, s[28:31], s49 offen offset:2048 lds
buffer_load_dwordx4 v3, s[28:31], s49 offen offset:3072 lds
s_waitcnt lgkmcnt(8)
v_mfma_f32_16x16x32_bf16 v[64:67], a[88:91], v[20:23], v[64:67]
s_setprio 1
ds_read_b128 v[40:43], v1 offset:4096
v_mfma_f32_16x16x32_bf16 v[68:71], a[92:95], v[20:23], v[68:71]
s_setprio 0
s_waitcnt lgkmcnt(8)
v_mfma_f32_16x16x32_bf16 v[72:75], a[88:91], v[24:27], v[72:75]
s_setprio 1
ds_read_b128 v[44:47], v1 offset:6144
v_mfma_f32_16x16x32_bf16 v[76:79], a[92:95], v[24:27], v[76:79]
s_setprio 0
s_waitcnt lgkmcnt(8)
v_mfma_f32_16x16x32_bf16 v[80:83], a[88:91], v[28:31], v[80:83]
s_setprio 1
ds_read_b128 v[16:19], v1 offset:8192
v_mfma_f32_16x16x32_bf16 v[84:87], a[92:95], v[28:31], v[84:87]
s_setprio 0
s_waitcnt lgkmcnt(8)
s_waitcnt lgkmcnt(7)
s_waitcnt lgkmcnt(6)
v_mfma_f32_16x16x32_bf16 v[48:51], a[96:99], v[32:35], v[48:51]
s_setprio 1
ds_read_b128 v[20:23], v1 offset:1024
v_mfma_f32_16x16x32_bf16 v[52:55], a[100:103], v[32:35], v[52:55]
s_setprio 0
s_waitcnt lgkmcnt(6)
v_mfma_f32_16x16x32_bf16 v[56:59], a[96:99], v[36:39], v[56:59]
s_setprio 1
ds_read_b128 v[24:27], v1 offset:3072
v_mfma_f32_16x16x32_bf16 v[60:63], a[100:103], v[36:39], v[60:63]
s_setprio 0
s_add_u32 s52, s52, 688128
s_add_u32 m0, s50, 0x2800
s_nop 0
buffer_load_dwordx4 v3, s[32:35], s52 offen offset:0 lds
buffer_load_dwordx4 v3, s[32:35], s52 offen offset:1024 lds
buffer_load_dwordx4 v3, s[32:35], s52 offen offset:2048 lds
s_waitcnt lgkmcnt(4)
v_mfma_f32_16x16x32_bf16 v[64:67], a[96:99], v[40:43], v[64:67]
s_setprio 1
ds_read_b128 v[28:31], v1 offset:5120
v_mfma_f32_16x16x32_bf16 v[68:71], a[100:103], v[40:43], v[68:71]
s_setprio 0
s_waitcnt lgkmcnt(4)
v_mfma_f32_16x16x32_bf16 v[72:75], a[96:99], v[44:47], v[72:75]
s_setprio 1
ds_read_b128 v[32:35], v1 offset:7168
v_mfma_f32_16x16x32_bf16 v[76:79], a[100:103], v[44:47], v[76:79]
s_setprio 0
s_waitcnt lgkmcnt(4)
v_mfma_f32_16x16x32_bf16 v[80:83], a[96:99], v[16:19], v[80:83]
s_setprio 1
ds_read_b128 v[36:39], v1 offset:9216
v_mfma_f32_16x16x32_bf16 v[84:87], a[100:103], v[16:19], v[84:87]
s_setprio 0
s_waitcnt vmcnt(5)
s_barrier
s_waitcnt lgkmcnt(4)
v_mfma_f32_16x16x32_bf16 v[48:51], a[104:107], v[20:23], v[48:51]
s_setprio 1
ds_read_b128 v[40:43], v1 offset:36864
ds_read_b128 a[112:115], v2 offset:36864
ds_read_b128 a[116:119], v2 offset:37888
v_mfma_f32_16x16x32_bf16 v[52:55], a[108:111], v[20:23], v[52:55]
s_setprio 0
s_waitcnt lgkmcnt(6)
v_mfma_f32_16x16x32_bf16 v[56:59], a[104:107], v[24:27], v[56:59]
s_setprio 1
ds_read_b128 v[44:47], v1 offset:38912
ds_read_b128 a[120:123], v2 offset:38912
ds_read_b128 a[124:127], v2 offset:39936
v_mfma_f32_16x16x32_bf16 v[60:63], a[108:111], v[24:27], v[60:63]
s_setprio 0
s_add_u32 s49, s49, 4096
s_add_u32 m0, s48, 0xe000
s_nop 0
buffer_load_dwordx4 v3, s[28:31], s49 offen offset:2048 lds
buffer_load_dwordx4 v3, s[28:31], s49 offen offset:3072 lds
s_waitcnt lgkmcnt(8)
v_mfma_f32_16x16x32_bf16 v[64:67], a[104:107], v[28:31], v[64:67]
s_setprio 1
ds_read_b128 v[16:19], v1 offset:40960
v_mfma_f32_16x16x32_bf16 v[68:71], a[108:111], v[28:31], v[68:71]
s_setprio 0
s_waitcnt lgkmcnt(8)
v_mfma_f32_16x16x32_bf16 v[72:75], a[104:107], v[32:35], v[72:75]
s_setprio 1
ds_read_b128 v[20:23], v1 offset:43008
v_mfma_f32_16x16x32_bf16 v[76:79], a[108:111], v[32:35], v[76:79]
s_setprio 0
s_waitcnt lgkmcnt(8)
v_mfma_f32_16x16x32_bf16 v[80:83], a[104:107], v[36:39], v[80:83]
s_setprio 1
ds_read_b128 v[24:27], v1 offset:45056
v_mfma_f32_16x16x32_bf16 v[84:87], a[108:111], v[36:39], v[84:87]
s_setprio 0
s_waitcnt lgkmcnt(8)
s_waitcnt lgkmcnt(7)
s_waitcnt lgkmcnt(6)
v_mfma_f32_16x16x32_bf16 v[48:51], a[112:115], v[40:43], v[48:51]
s_setprio 1
ds_read_b128 v[28:31], v1 offset:37888
v_mfma_f32_16x16x32_bf16 v[52:55], a[116:119], v[40:43], v[52:55]
s_setprio 0
s_waitcnt lgkmcnt(6)
v_mfma_f32_16x16x32_bf16 v[56:59], a[112:115], v[44:47], v[56:59]
s_setprio 1
ds_read_b128 v[32:35], v1 offset:39936
v_mfma_f32_16x16x32_bf16 v[60:63], a[116:119], v[44:47], v[60:63]
s_setprio 0
s_add_u32 s52, s52, 688128
s_add_u32 m0, s50, 0xb800
s_nop 0
buffer_load_dwordx4 v3, s[32:35], s52 offen offset:0 lds
buffer_load_dwordx4 v3, s[32:35], s52 offen offset:1024 lds
buffer_load_dwordx4 v3, s[32:35], s52 offen offset:2048 lds
s_waitcnt lgkmcnt(4)
v_mfma_f32_16x16x32_bf16 v[64:67], a[112:115], v[16:19], v[64:67]
s_setprio 1
ds_read_b128 v[36:39], v1 offset:41984
v_mfma_f32_16x16x32_bf16 v[68:71], a[116:119], v[16:19], v[68:71]
s_setprio 0
s_waitcnt lgkmcnt(4)
v_mfma_f32_16x16x32_bf16 v[72:75], a[112:115], v[20:23], v[72:75]
s_setprio 1
ds_read_b128 v[40:43], v1 offset:44032
v_mfma_f32_16x16x32_bf16 v[76:79], a[116:119], v[20:23], v[76:79]
s_setprio 0
s_waitcnt lgkmcnt(4)
v_mfma_f32_16x16x32_bf16 v[80:83], a[112:115], v[24:27], v[80:83]
s_setprio 1
ds_read_b128 v[44:47], v1 offset:46080
v_mfma_f32_16x16x32_bf16 v[84:87], a[116:119], v[24:27], v[84:87]
s_setprio 0
s_waitcnt vmcnt(5)
s_barrier
s_waitcnt lgkmcnt(4)
v_mfma_f32_16x16x32_bf16 v[48:51], a[120:123], v[28:31], v[48:51]
s_setprio 1
v_add_u32 v1, 0xfffee000, v1
ds_read_b128 v[16:19], v1 offset:0
v_add_u32 v2, 0xfffee000, v2
ds_read_b128 a[128:131], v2 offset:0
ds_read_b128 a[132:135], v2 offset:1024
v_mfma_f32_16x16x32_bf16 v[52:55], a[124:127], v[28:31], v[52:55]
s_setprio 0
s_waitcnt lgkmcnt(6)
v_mfma_f32_16x16x32_bf16 v[56:59], a[120:123], v[32:35], v[56:59]
s_setprio 1
ds_read_b128 v[20:23], v1 offset:2048
ds_read_b128 a[136:139], v2 offset:2048
ds_read_b128 a[140:143], v2 offset:3072
v_mfma_f32_16x16x32_bf16 v[60:63], a[124:127], v[32:35], v[60:63]
s_setprio 0
s_add_u32 s53, s53, 688128
s_add_u32 m0, s51, 0x14800
s_nop 0
buffer_load_dwordx4 v3, s[32:35], s53 offen offset:0 lds
buffer_load_dwordx4 v3, s[32:35], s53 offen offset:1024 lds
buffer_load_dwordx4 v3, s[32:35], s53 offen offset:2048 lds
s_waitcnt lgkmcnt(8)
v_mfma_f32_16x16x32_bf16 v[64:67], a[120:123], v[36:39], v[64:67]
s_setprio 1
ds_read_b128 v[24:27], v1 offset:4096
v_mfma_f32_16x16x32_bf16 v[68:71], a[124:127], v[36:39], v[68:71]
s_setprio 0
s_waitcnt lgkmcnt(8)
v_mfma_f32_16x16x32_bf16 v[72:75], a[120:123], v[40:43], v[72:75]
s_setprio 1
ds_read_b128 v[28:31], v1 offset:6144
v_mfma_f32_16x16x32_bf16 v[76:79], a[124:127], v[40:43], v[76:79]
s_setprio 0
s_waitcnt lgkmcnt(8)
v_mfma_f32_16x16x32_bf16 v[80:83], a[120:123], v[44:47], v[80:83]
s_setprio 1
ds_read_b128 v[32:35], v1 offset:8192
v_mfma_f32_16x16x32_bf16 v[84:87], a[124:127], v[44:47], v[84:87]
s_setprio 0
s_waitcnt lgkmcnt(8)
s_waitcnt lgkmcnt(7)
s_waitcnt lgkmcnt(6)
v_mfma_f32_16x16x32_bf16 v[48:51], a[128:131], v[16:19], v[48:51]
s_setprio 1
ds_read_b128 v[36:39], v1 offset:1024
v_mfma_f32_16x16x32_bf16 v[52:55], a[132:135], v[16:19], v[52:55]
s_setprio 0
s_waitcnt lgkmcnt(6)
v_mfma_f32_16x16x32_bf16 v[56:59], a[128:131], v[20:23], v[56:59]
s_setprio 1
ds_read_b128 v[40:43], v1 offset:3072
v_mfma_f32_16x16x32_bf16 v[60:63], a[132:135], v[20:23], v[60:63]
s_setprio 0
s_waitcnt lgkmcnt(4)
v_mfma_f32_16x16x32_bf16 v[64:67], a[128:131], v[24:27], v[64:67]
s_setprio 1
ds_read_b128 v[44:47], v1 offset:5120
v_mfma_f32_16x16x32_bf16 v[68:71], a[132:135], v[24:27], v[68:71]
s_setprio 0
s_waitcnt lgkmcnt(4)
v_mfma_f32_16x16x32_bf16 v[72:75], a[128:131], v[28:31], v[72:75]
s_setprio 1
ds_read_b128 v[16:19], v1 offset:7168
v_mfma_f32_16x16x32_bf16 v[76:79], a[132:135], v[28:31], v[76:79]
s_setprio 0
s_waitcnt lgkmcnt(4)
v_mfma_f32_16x16x32_bf16 v[80:83], a[128:131], v[32:35], v[80:83]
s_setprio 1
ds_read_b128 v[20:23], v1 offset:9216
v_mfma_f32_16x16x32_bf16 v[84:87], a[132:135], v[32:35], v[84:87]
s_setprio 0
s_waitcnt vmcnt(3)
s_barrier
s_waitcnt lgkmcnt(4)
v_mfma_f32_16x16x32_bf16 v[48:51], a[136:139], v[36:39], v[48:51]
s_setprio 1
ds_read_b128 v[24:27], v1 offset:36864
ds_read_b128 a[144:147], v2 offset:36864
ds_read_b128 a[148:151], v2 offset:37888
v_mfma_f32_16x16x32_bf16 v[52:55], a[140:143], v[36:39], v[52:55]
s_setprio 0
s_waitcnt lgkmcnt(6)
v_mfma_f32_16x16x32_bf16 v[56:59], a[136:139], v[40:43], v[56:59]
s_setprio 1
ds_read_b128 v[28:31], v1 offset:38912
ds_read_b128 a[152:155], v2 offset:38912
ds_read_b128 a[156:159], v2 offset:39936
v_mfma_f32_16x16x32_bf16 v[60:63], a[140:143], v[40:43], v[60:63]
s_setprio 0
s_add_u32 s53, s53, 688128
s_add_u32 m0, s51, 0x20800
s_nop 0
buffer_load_dwordx4 v3, s[32:35], s53 offen offset:0 lds
buffer_load_dwordx4 v3, s[32:35], s53 offen offset:1024 lds
buffer_load_dwordx4 v3, s[32:35], s53 offen offset:2048 lds
s_waitcnt lgkmcnt(8)
v_mfma_f32_16x16x32_bf16 v[64:67], a[136:139], v[44:47], v[64:67]
s_setprio 1
ds_read_b128 v[32:35], v1 offset:40960
v_mfma_f32_16x16x32_bf16 v[68:71], a[140:143], v[44:47], v[68:71]
s_setprio 0
s_waitcnt lgkmcnt(8)
v_mfma_f32_16x16x32_bf16 v[72:75], a[136:139], v[16:19], v[72:75]
s_setprio 1
ds_read_b128 v[36:39], v1 offset:43008
v_mfma_f32_16x16x32_bf16 v[76:79], a[140:143], v[16:19], v[76:79]
s_setprio 0
s_waitcnt lgkmcnt(8)
v_mfma_f32_16x16x32_bf16 v[80:83], a[136:139], v[20:23], v[80:83]
s_setprio 1
ds_read_b128 v[40:43], v1 offset:45056
v_mfma_f32_16x16x32_bf16 v[84:87], a[140:143], v[20:23], v[84:87]
s_setprio 0
s_waitcnt lgkmcnt(8)
s_waitcnt lgkmcnt(7)
s_waitcnt lgkmcnt(6)
v_mfma_f32_16x16x32_bf16 v[48:51], a[144:147], v[24:27], v[48:51]
s_setprio 1
ds_read_b128 v[44:47], v1 offset:37888
v_mfma_f32_16x16x32_bf16 v[52:55], a[148:151], v[24:27], v[52:55]
s_setprio 0
s_waitcnt lgkmcnt(6)
v_mfma_f32_16x16x32_bf16 v[56:59], a[144:147], v[28:31], v[56:59]
s_setprio 1
ds_read_b128 v[16:19], v1 offset:39936
v_mfma_f32_16x16x32_bf16 v[60:63], a[148:151], v[28:31], v[60:63]
s_setprio 0
s_waitcnt lgkmcnt(4)
v_mfma_f32_16x16x32_bf16 v[64:67], a[144:147], v[32:35], v[64:67]
s_setprio 1
ds_read_b128 v[20:23], v1 offset:41984
v_mfma_f32_16x16x32_bf16 v[68:71], a[148:151], v[32:35], v[68:71]
s_setprio 0
s_waitcnt lgkmcnt(4)
v_mfma_f32_16x16x32_bf16 v[72:75], a[144:147], v[36:39], v[72:75]
s_setprio 1
ds_read_b128 v[24:27], v1 offset:44032
v_mfma_f32_16x16x32_bf16 v[76:79], a[148:151], v[36:39], v[76:79]
s_setprio 0
s_waitcnt lgkmcnt(4)
v_mfma_f32_16x16x32_bf16 v[80:83], a[144:147], v[40:43], v[80:83]
s_setprio 1
ds_read_b128 v[28:31], v1 offset:46080
v_mfma_f32_16x16x32_bf16 v[84:87], a[148:151], v[40:43], v[84:87]
s_setprio 0
s_waitcnt vmcnt(3)
s_barrier
s_waitcnt lgkmcnt(4)
v_mfma_f32_16x16x32_bf16 v[48:51], a[152:155], v[44:47], v[48:51]
s_setprio 1
v_mfma_f32_16x16x32_bf16 v[52:55], a[156:159], v[44:47], v[52:55]
s_setprio 0
s_waitcnt lgkmcnt(3)
v_mfma_f32_16x16x32_bf16 v[56:59], a[152:155], v[16:19], v[56:59]
s_setprio 1
v_mfma_f32_16x16x32_bf16 v[60:63], a[156:159], v[16:19], v[60:63]
s_setprio 0
s_add_u32 s53, s53, 688128
s_add_u32 m0, s51, 0x2800
s_nop 0
buffer_load_dwordx4 v3, s[32:35], s53 offen offset:0 lds
buffer_load_dwordx4 v3, s[32:35], s53 offen offset:1024 lds
buffer_load_dwordx4 v3, s[32:35], s53 offen offset:2048 lds
s_waitcnt lgkmcnt(2)
v_mfma_f32_16x16x32_bf16 v[64:67], a[152:155], v[20:23], v[64:67]
s_setprio 1
v_mfma_f32_16x16x32_bf16 v[68:71], a[156:159], v[20:23], v[68:71]
s_setprio 0
s_waitcnt lgkmcnt(1)
v_mfma_f32_16x16x32_bf16 v[72:75], a[152:155], v[24:27], v[72:75]
s_setprio 1
v_mfma_f32_16x16x32_bf16 v[76:79], a[156:159], v[24:27], v[76:79]
s_setprio 0
s_waitcnt lgkmcnt(0)
v_mfma_f32_16x16x32_bf16 v[80:83], a[152:155], v[28:31], v[80:83]
s_setprio 1
v_mfma_f32_16x16x32_bf16 v[84:87], a[156:159], v[28:31], v[84:87]
s_setprio 0
s_nop 5
s_barrier
v_bfe_u32 v5, v3, 4, 4
s_movk_i32 s60, 272
v_mul_lo_u32 v5, v5, s60
v_lshrrev_b32 v6, 8, v3
v_lshl_add_u32 v5, v6, 3, v5
s_lshl_b32 s60, s4, 6
s_add_u32 s60, s60, 24576
v_add_u32 v5, s60, v5
v_pk_mul_f32 v[16:17], v[48:49], s[80:81]
v_pk_mul_f32 v[18:19], v[50:51], s[80:81]
v_exp_f32_e64 v16, v16 clamp
v_exp_f32_e64 v17, v17 clamp
v_exp_f32_e64 v18, v18 clamp
v_exp_f32_e64 v19, v19 clamp
v_pk_add_f32 v[48:49], v[48:49], s[86:87]
v_pk_add_f32 v[50:51], v[50:51], s[86:87]
v_max_f32 v48, s86, v48
v_max_f32 v49, s86, v49
v_max_f32 v50, s86, v50
v_max_f32 v51, s86, v51
v_pk_add_f32 v[48:49], v[48:49], v[16:17]
v_pk_add_f32 v[50:51], v[50:51], v[18:19]
v_cvt_pk_bf16_f32 v20, v48, v49
v_cvt_pk_bf16_f32 v21, v50, v51
ds_write_b64 v5, v[20:21] offset:13056
v_pk_mul_f32 v[16:17], v[52:53], s[80:81]
v_pk_mul_f32 v[18:19], v[54:55], s[80:81]
v_exp_f32_e64 v16, v16 clamp
v_exp_f32_e64 v17, v17 clamp
v_exp_f32_e64 v18, v18 clamp
v_exp_f32_e64 v19, v19 clamp
v_pk_add_f32 v[52:53], v[52:53], s[86:87]
v_pk_add_f32 v[54:55], v[54:55], s[86:87]
v_max_f32 v52, s86, v52
v_max_f32 v53, s86, v53
v_max_f32 v54, s86, v54
v_max_f32 v55, s86, v55
v_pk_add_f32 v[52:53], v[52:53], v[16:17]
v_pk_add_f32 v[54:55], v[54:55], v[18:19]
v_cvt_pk_bf16_f32 v22, v52, v53
v_cvt_pk_bf16_f32 v23, v54, v55
ds_write_b64 v5, v[22:23] offset:13088
v_pk_mul_f32 v[16:17], v[56:57], s[80:81]
v_pk_mul_f32 v[18:19], v[58:59], s[80:81]
v_exp_f32_e64 v16, v16 clamp
v_exp_f32_e64 v17, v17 clamp
v_exp_f32_e64 v18, v18 clamp
v_exp_f32_e64 v19, v19 clamp
v_pk_add_f32 v[56:57], v[56:57], s[86:87]
v_pk_add_f32 v[58:59], v[58:59], s[86:87]
v_max_f32 v56, s86, v56
v_max_f32 v57, s86, v57
v_max_f32 v58, s86, v58
v_max_f32 v59, s86, v59
v_pk_add_f32 v[56:57], v[56:57], v[16:17]
v_pk_add_f32 v[58:59], v[58:59], v[18:19]
v_cvt_pk_bf16_f32 v24, v56, v57
v_cvt_pk_bf16_f32 v25, v58, v59
ds_write_b64 v5, v[24:25] offset:17408
v_pk_mul_f32 v[16:17], v[60:61], s[80:81]
v_pk_mul_f32 v[18:19], v[62:63], s[80:81]
v_exp_f32_e64 v16, v16 clamp
v_exp_f32_e64 v17, v17 clamp
v_exp_f32_e64 v18, v18 clamp
v_exp_f32_e64 v19, v19 clamp
v_pk_add_f32 v[60:61], v[60:61], s[86:87]
v_pk_add_f32 v[62:63], v[62:63], s[86:87]
v_max_f32 v60, s86, v60
v_max_f32 v61, s86, v61
v_max_f32 v62, s86, v62
v_max_f32 v63, s86, v63
v_pk_add_f32 v[60:61], v[60:61], v[16:17]
v_pk_add_f32 v[62:63], v[62:63], v[18:19]
v_cvt_pk_bf16_f32 v26, v60, v61
v_cvt_pk_bf16_f32 v27, v62, v63
ds_write_b64 v5, v[26:27] offset:17440
v_cvt_pk_bf16_f32 v20, v64, v65
v_cvt_pk_bf16_f32 v21, v66, v67
ds_write_b64 v5, v[20:21] offset:30464
v_cvt_pk_bf16_f32 v22, v68, v69
v_cvt_pk_bf16_f32 v23, v70, v71
ds_write_b64 v5, v[22:23] offset:30496
v_cvt_pk_bf16_f32 v24, v72, v73
v_cvt_pk_bf16_f32 v25, v74, v75
ds_write_b64 v5, v[24:25] offset:34816
v_cvt_pk_bf16_f32 v26, v76, v77
v_cvt_pk_bf16_f32 v27, v78, v79
ds_write_b64 v5, v[26:27] offset:34848
v_cvt_pk_bf16_f32 v20, v80, v81
v_cvt_pk_bf16_f32 v21, v82, v83
ds_write_b64 v5, v[20:21] offset:39168
v_cvt_pk_bf16_f32 v22, v84, v85
v_cvt_pk_bf16_f32 v23, v86, v87
ds_write_b64 v5, v[22:23] offset:39200
s_waitcnt lgkmcnt(0)
s_barrier
v_bfe_u32 v6, v3, 4, 4
v_lshrrev_b32 v7, 8, v3
v_lshlrev_b32 v7, 4, v7
s_mul_i32 s60, s4, 5440
s_movk_i32 s61, 272
v_mul_lo_u32 v5, v6, s61
v_add_u32 v5, s60, v5
v_add_u32 v5, v5, v7
v_add_u32 v8, 24576, v5
v_add_u32 v5, 50688, v5
v_add_u32 v7, 147456, v7
v_cmp_lt_u32 vcc, 3, v6
s_nop 1
v_cndmask_b32 v5, v5, v7, vcc
ds_read_b128 v[16:19], v5 offset:0
ds_read_b128 v[20:23], v5 offset:64
ds_read_b128 v[24:27], v5 offset:128
ds_read_b128 v[28:31], v5 offset:192
ds_read_b128 v[32:35], v8 offset:0
ds_read_b128 v[36:39], v8 offset:64
ds_read_b128 v[40:43], v8 offset:128
ds_read_b128 v[44:47], v8 offset:192
ds_read_b128 v[64:67], v8 offset:4352
ds_read_b128 v[68:71], v8 offset:4416
ds_read_b128 v[72:75], v8 offset:4480
ds_read_b128 v[76:79], v8 offset:4544
s_waitcnt lgkmcnt(7)
v_mfma_f32_16x16x32_bf16 v[80:83], v[16:19], v[32:35], 0
s_waitcnt lgkmcnt(6)
v_mfma_f32_16x16x32_bf16 v[80:83], v[20:23], v[36:39], v[80:83]
s_waitcnt lgkmcnt(5)
v_mfma_f32_16x16x32_bf16 v[80:83], v[24:27], v[40:43], v[80:83]
s_waitcnt lgkmcnt(4)
v_mfma_f32_16x16x32_bf16 v[80:83], v[28:31], v[44:47], v[80:83]
s_waitcnt lgkmcnt(3)
v_mfma_f32_16x16x32_bf16 v[84:87], v[16:19], v[64:67], 0
s_waitcnt lgkmcnt(2)
v_mfma_f32_16x16x32_bf16 v[84:87], v[20:23], v[68:71], v[84:87]
s_waitcnt lgkmcnt(1)
v_mfma_f32_16x16x32_bf16 v[84:87], v[24:27], v[72:75], v[84:87]
s_waitcnt lgkmcnt(0)
v_mfma_f32_16x16x32_bf16 v[84:87], v[28:31], v[76:79], v[84:87]
s_lshl_b32 s60, s3, 11
s_add_u32 s60, s60, 148480
s_cmp_eq_u32 s3, 7
s_cselect_b32 s60, 68096, s60
v_add_u32 v5, s60, v3
s_nop 5
ds_write_b128 v5, v[80:83] offset:0
ds_write_b128 v5, v[84:87] offset:1024
s_waitcnt lgkmcnt(0)
v_add_u32 v1, 0x12000, v1
ds_read_b128 v[16:19], v1 offset:0
ds_read_b128 v[20:23], v1 offset:2048
ds_read_b128 v[24:27], v1 offset:4096
ds_read_b128 v[28:31], v1 offset:6144
ds_read_b128 v[32:35], v1 offset:8192
s_waitcnt lgkmcnt(4)
v_mfma_f32_16x16x32_bf16 v[48:51], v[16:19], a[0:3], 0
s_setprio 1
ds_read_b128 v[36:39], v1 offset:10240
v_mfma_f32_16x16x32_bf16 v[52:55], v[16:19], a[4:7], 0
s_setprio 0
s_waitcnt lgkmcnt(4)
v_mfma_f32_16x16x32_bf16 v[56:59], v[20:23], a[0:3], 0
s_setprio 1
ds_read_b128 v[40:43], v1 offset:1024
v_mfma_f32_16x16x32_bf16 v[60:63], v[20:23], a[4:7], 0
s_setprio 0
s_waitcnt lgkmcnt(4)
v_mfma_f32_16x16x32_bf16 v[64:67], v[24:27], a[0:3], 0
s_setprio 1
ds_read_b128 v[44:47], v1 offset:3072
v_mfma_f32_16x16x32_bf16 v[68:71], v[24:27], a[4:7], 0
s_setprio 0
s_waitcnt lgkmcnt(4)
v_mfma_f32_16x16x32_bf16 v[72:75], v[28:31], a[0:3], 0
s_setprio 1
ds_read_b128 v[16:19], v1 offset:5120
v_mfma_f32_16x16x32_bf16 v[76:79], v[28:31], a[4:7], 0
s_setprio 0
s_waitcnt lgkmcnt(4)
v_mfma_f32_16x16x32_bf16 v[80:83], v[32:35], a[0:3], 0
s_setprio 1
ds_read_b128 v[20:23], v1 offset:7168
v_mfma_f32_16x16x32_bf16 v[84:87], v[32:35], a[4:7], 0
s_setprio 0
s_waitcnt lgkmcnt(4)
v_mfma_f32_16x16x32_bf16 v[88:91], v[36:39], a[0:3], 0
s_setprio 1
ds_read_b128 v[24:27], v1 offset:9216
v_mfma_f32_16x16x32_bf16 v[92:95], v[36:39], a[4:7], 0
s_setprio 0
s_waitcnt vmcnt(3)
s_barrier
s_waitcnt lgkmcnt(4)
v_mfma_f32_16x16x32_bf16 v[48:51], v[40:43], a[8:11], v[48:51]
s_setprio 1
ds_read_b128 v[28:31], v1 offset:11264
v_mfma_f32_16x16x32_bf16 v[52:55], v[40:43], a[12:15], v[52:55]
s_setprio 0
s_waitcnt lgkmcnt(4)
v_mfma_f32_16x16x32_bf16 v[56:59], v[44:47], a[8:11], v[56:59]
s_setprio 1
ds_read_b128 v[32:35], v1 offset:49152
v_mfma_f32_16x16x32_bf16 v[60:63], v[44:47], a[12:15], v[60:63]
s_setprio 0
s_add_u32 s53, s53, 688128
s_add_u32 m0, s51, 0x1a800
s_nop 0
buffer_load_dwordx4 v3, s[32:35], s53 offen offset:0 lds
buffer_load_dwordx4 v3, s[32:35], s53 offen offset:1024 lds
buffer_load_dwordx4 v3, s[32:35], s53 offen offset:2048 lds
s_waitcnt lgkmcnt(4)
v_mfma_f32_16x16x32_bf16 v[64:67], v[16:19], a[8:11], v[64:67]
s_setprio 1
ds_read_b128 v[36:39], v1 offset:51200
v_mfma_f32_16x16x32_bf16 v[68:71], v[16:19], a[12:15], v[68:71]
s_setprio 0
s_waitcnt lgkmcnt(4)
v_mfma_f32_16x16x32_bf16 v[72:75], v[20:23], a[8:11], v[72:75]
s_setprio 1
ds_read_b128 v[40:43], v1 offset:53248
v_mfma_f32_16x16x32_bf16 v[76:79], v[20:23], a[12:15], v[76:79]
s_setprio 0
s_waitcnt lgkmcnt(4)
v_mfma_f32_16x16x32_bf16 v[80:83], v[24:27], a[8:11], v[80:83]
s_setprio 1
ds_read_b128 v[44:47], v1 offset:55296
v_mfma_f32_16x16x32_bf16 v[84:87], v[24:27], a[12:15], v[84:87]
s_setprio 0
s_waitcnt lgkmcnt(4)
v_mfma_f32_16x16x32_bf16 v[88:91], v[28:31], a[8:11], v[88:91]
s_setprio 1
ds_read_b128 v[16:19], v1 offset:57344
v_mfma_f32_16x16x32_bf16 v[92:95], v[28:31], a[12:15], v[92:95]
s_setprio 0
s_waitcnt lgkmcnt(4)
v_mfma_f32_16x16x32_bf16 v[48:51], v[32:35], a[16:19], v[48:51]
s_setprio 1
ds_read_b128 v[20:23], v1 offset:59392
v_mfma_f32_16x16x32_bf16 v[52:55], v[32:35], a[20:23], v[52:55]
s_setprio 0
s_waitcnt lgkmcnt(4)
v_mfma_f32_16x16x32_bf16 v[56:59], v[36:39], a[16:19], v[56:59]
s_setprio 1
ds_read_b128 v[24:27], v1 offset:50176
v_mfma_f32_16x16x32_bf16 v[60:63], v[36:39], a[20:23], v[60:63]
s_setprio 0
s_waitcnt lgkmcnt(4)
v_mfma_f32_16x16x32_bf16 v[64:67], v[40:43], a[16:19], v[64:67]
s_setprio 1
ds_read_b128 v[28:31], v1 offset:52224
v_mfma_f32_16x16x32_bf16 v[68:71], v[40:43], a[20:23], v[68:71]
s_setprio 0
s_waitcnt lgkmcnt(4)
v_mfma_f32_16x16x32_bf16 v[72:75], v[44:47], a[16:19], v[72:75]
s_setprio 1
ds_read_b128 v[32:35], v1 offset:54272
v_mfma_f32_16x16x32_bf16 v[76:79], v[44:47], a[20:23], v[76:79]
s_setprio 0
s_waitcnt lgkmcnt(4)
v_mfma_f32_16x16x32_bf16 v[80:83], v[16:19], a[16:19], v[80:83]
s_setprio 1
ds_read_b128 v[36:39], v1 offset:56320
v_mfma_f32_16x16x32_bf16 v[84:87], v[16:19], a[20:23], v[84:87]
s_setprio 0
s_waitcnt lgkmcnt(4)
v_mfma_f32_16x16x32_bf16 v[88:91], v[20:23], a[16:19], v[88:91]
s_setprio 1
ds_read_b128 v[40:43], v1 offset:58368
v_mfma_f32_16x16x32_bf16 v[92:95], v[20:23], a[20:23], v[92:95]
s_setprio 0
s_waitcnt vmcnt(3)
s_barrier
s_waitcnt lgkmcnt(4)
v_mfma_f32_16x16x32_bf16 v[48:51], v[24:27], a[24:27], v[48:51]
s_setprio 1
ds_read_b128 v[44:47], v1 offset:60416
v_mfma_f32_16x16x32_bf16 v[52:55], v[24:27], a[28:31], v[52:55]
s_setprio 0
s_waitcnt lgkmcnt(4)
v_mfma_f32_16x16x32_bf16 v[56:59], v[28:31], a[24:27], v[56:59]
s_setprio 1
v_add_u32 v1, 0xfffee000, v1
ds_read_b128 v[16:19], v1 offset:0
v_mfma_f32_16x16x32_bf16 v[60:63], v[28:31], a[28:31], v[60:63]
s_setprio 0
s_add_u32 s53, s53, 688128
s_add_u32 m0, s51, 0x14800
s_nop 0
buffer_load_dwordx4 v3, s[32:35], s53 offen offset:0 lds
buffer_load_dwordx4 v3, s[32:35], s53 offen offset:1024 lds
buffer_load_dwordx4 v3, s[32:35], s53 offen offset:2048 lds
s_waitcnt lgkmcnt(4)
v_mfma_f32_16x16x32_bf16 v[64:67], v[32:35], a[24:27], v[64:67]
s_setprio 1
ds_read_b128 v[20:23], v1 offset:2048
v_mfma_f32_16x16x32_bf16 v[68:71], v[32:35], a[28:31], v[68:71]
s_setprio 0
s_waitcnt lgkmcnt(4)
v_mfma_f32_16x16x32_bf16 v[72:75], v[36:39], a[24:27], v[72:75]
s_setprio 1
ds_read_b128 v[24:27], v1 offset:4096
v_mfma_f32_16x16x32_bf16 v[76:79], v[36:39], a[28:31], v[76:79]
s_setprio 0
s_waitcnt lgkmcnt(4)
v_mfma_f32_16x16x32_bf16 v[80:83], v[40:43], a[24:27], v[80:83]
s_setprio 1
ds_read_b128 v[28:31], v1 offset:6144
v_mfma_f32_16x16x32_bf16 v[84:87], v[40:43], a[28:31], v[84:87]
s_setprio 0
s_waitcnt lgkmcnt(4)
v_mfma_f32_16x16x32_bf16 v[88:91], v[44:47], a[24:27], v[88:91]
s_setprio 1
ds_read_b128 v[32:35], v1 offset:8192
v_mfma_f32_16x16x32_bf16 v[92:95], v[44:47], a[28:31], v[92:95]
s_setprio 0
s_waitcnt lgkmcnt(4)
v_mfma_f32_16x16x32_bf16 v[48:51], v[16:19], a[32:35], v[48:51]
s_setprio 1
ds_read_b128 v[36:39], v1 offset:10240
v_mfma_f32_16x16x32_bf16 v[52:55], v[16:19], a[36:39], v[52:55]
s_setprio 0
s_waitcnt lgkmcnt(4)
v_mfma_f32_16x16x32_bf16 v[56:59], v[20:23], a[32:35], v[56:59]
s_setprio 1
ds_read_b128 v[40:43], v1 offset:1024
v_mfma_f32_16x16x32_bf16 v[60:63], v[20:23], a[36:39], v[60:63]
s_setprio 0
s_waitcnt lgkmcnt(4)
v_mfma_f32_16x16x32_bf16 v[64:67], v[24:27], a[32:35], v[64:67]
s_setprio 1
ds_read_b128 v[44:47], v1 offset:3072
v_mfma_f32_16x16x32_bf16 v[68:71], v[24:27], a[36:39], v[68:71]
s_setprio 0
s_waitcnt lgkmcnt(4)
v_mfma_f32_16x16x32_bf16 v[72:75], v[28:31], a[32:35], v[72:75]
s_setprio 1
ds_read_b128 v[16:19], v1 offset:5120
v_mfma_f32_16x16x32_bf16 v[76:79], v[28:31], a[36:39], v[76:79]
s_setprio 0
s_waitcnt lgkmcnt(4)
v_mfma_f32_16x16x32_bf16 v[80:83], v[32:35], a[32:35], v[80:83]
s_setprio 1
ds_read_b128 v[20:23], v1 offset:7168
v_mfma_f32_16x16x32_bf16 v[84:87], v[32:35], a[36:39], v[84:87]
s_setprio 0
s_waitcnt lgkmcnt(4)
v_mfma_f32_16x16x32_bf16 v[88:91], v[36:39], a[32:35], v[88:91]
s_setprio 1
ds_read_b128 v[24:27], v1 offset:9216
v_mfma_f32_16x16x32_bf16 v[92:95], v[36:39], a[36:39], v[92:95]
s_setprio 0
s_waitcnt vmcnt(3)
s_barrier
s_waitcnt lgkmcnt(4)
v_mfma_f32_16x16x32_bf16 v[48:51], v[40:43], a[40:43], v[48:51]
s_setprio 1
ds_read_b128 v[28:31], v1 offset:11264
v_mfma_f32_16x16x32_bf16 v[52:55], v[40:43], a[44:47], v[52:55]
s_setprio 0
s_waitcnt lgkmcnt(4)
v_mfma_f32_16x16x32_bf16 v[56:59], v[44:47], a[40:43], v[56:59]
s_setprio 1
v_add_u32 v1, 0x18000, v1
ds_read_b128 v[32:35], v1 offset:0
v_mfma_f32_16x16x32_bf16 v[60:63], v[44:47], a[44:47], v[60:63]
s_setprio 0
s_add_u32 s53, s53, 688128
s_add_u32 m0, s51, 0x20800
s_nop 0
buffer_load_dwordx4 v3, s[32:35], s53 offen offset:0 lds
buffer_load_dwordx4 v3, s[32:35], s53 offen offset:1024 lds
buffer_load_dwordx4 v3, s[32:35], s53 offen offset:2048 lds
s_waitcnt lgkmcnt(4)
v_mfma_f32_16x16x32_bf16 v[64:67], v[16:19], a[40:43], v[64:67]
s_setprio 1
ds_read_b128 v[36:39], v1 offset:2048
v_mfma_f32_16x16x32_bf16 v[68:71], v[16:19], a[44:47], v[68:71]
s_setprio 0
s_waitcnt lgkmcnt(4)
v_mfma_f32_16x16x32_bf16 v[72:75], v[20:23], a[40:43], v[72:75]
s_setprio 1
ds_read_b128 v[40:43], v1 offset:4096
v_mfma_f32_16x16x32_bf16 v[76:79], v[20:23], a[44:47], v[76:79]
s_setprio 0
s_waitcnt lgkmcnt(4)
v_mfma_f32_16x16x32_bf16 v[80:83], v[24:27], a[40:43], v[80:83]
s_setprio 1
ds_read_b128 v[44:47], v1 offset:6144
v_mfma_f32_16x16x32_bf16 v[84:87], v[24:27], a[44:47], v[84:87]
s_setprio 0
s_waitcnt lgkmcnt(4)
v_mfma_f32_16x16x32_bf16 v[88:91], v[28:31], a[40:43], v[88:91]
s_setprio 1
ds_read_b128 v[16:19], v1 offset:8192
v_mfma_f32_16x16x32_bf16 v[92:95], v[28:31], a[44:47], v[92:95]
s_setprio 0
s_waitcnt lgkmcnt(4)
v_mfma_f32_16x16x32_bf16 v[48:51], v[32:35], a[48:51], v[48:51]
s_setprio 1
ds_read_b128 v[20:23], v1 offset:10240
v_mfma_f32_16x16x32_bf16 v[52:55], v[32:35], a[52:55], v[52:55]
s_setprio 0
s_waitcnt lgkmcnt(4)
v_mfma_f32_16x16x32_bf16 v[56:59], v[36:39], a[48:51], v[56:59]
s_setprio 1
ds_read_b128 v[24:27], v1 offset:1024
v_mfma_f32_16x16x32_bf16 v[60:63], v[36:39], a[52:55], v[60:63]
s_setprio 0
s_waitcnt lgkmcnt(4)
v_mfma_f32_16x16x32_bf16 v[64:67], v[40:43], a[48:51], v[64:67]
s_setprio 1
ds_read_b128 v[28:31], v1 offset:3072
v_mfma_f32_16x16x32_bf16 v[68:71], v[40:43], a[52:55], v[68:71]
s_setprio 0
s_waitcnt lgkmcnt(4)
v_mfma_f32_16x16x32_bf16 v[72:75], v[44:47], a[48:51], v[72:75]
s_setprio 1
ds_read_b128 v[32:35], v1 offset:5120
v_mfma_f32_16x16x32_bf16 v[76:79], v[44:47], a[52:55], v[76:79]
s_setprio 0
s_waitcnt lgkmcnt(4)
v_mfma_f32_16x16x32_bf16 v[80:83], v[16:19], a[48:51], v[80:83]
s_setprio 1
ds_read_b128 v[36:39], v1 offset:7168
v_mfma_f32_16x16x32_bf16 v[84:87], v[16:19], a[52:55], v[84:87]
s_setprio 0
s_waitcnt lgkmcnt(4)
v_mfma_f32_16x16x32_bf16 v[88:91], v[20:23], a[48:51], v[88:91]
s_setprio 1
ds_read_b128 v[40:43], v1 offset:9216
v_mfma_f32_16x16x32_bf16 v[92:95], v[20:23], a[52:55], v[92:95]
s_setprio 0
s_waitcnt vmcnt(3)
s_barrier
s_waitcnt lgkmcnt(4)
v_mfma_f32_16x16x32_bf16 v[48:51], v[24:27], a[56:59], v[48:51]
s_setprio 1
ds_read_b128 v[44:47], v1 offset:11264
v_mfma_f32_16x16x32_bf16 v[52:55], v[24:27], a[60:63], v[52:55]
s_setprio 0
s_waitcnt lgkmcnt(4)
v_mfma_f32_16x16x32_bf16 v[56:59], v[28:31], a[56:59], v[56:59]
s_setprio 1
v_add_u32 v1, 0xffffa000, v1
ds_read_b128 v[16:19], v1 offset:0
v_mfma_f32_16x16x32_bf16 v[60:63], v[28:31], a[60:63], v[60:63]
s_setprio 0
s_add_u32 s53, s53, 688128
s_add_u32 m0, s51, 0x2800
s_nop 0
buffer_load_dwordx4 v3, s[32:35], s53 offen offset:0 lds
buffer_load_dwordx4 v3, s[32:35], s53 offen offset:1024 lds
buffer_load_dwordx4 v3, s[32:35], s53 offen offset:2048 lds
s_waitcnt lgkmcnt(4)
v_mfma_f32_16x16x32_bf16 v[64:67], v[32:35], a[56:59], v[64:67]
s_setprio 1
ds_read_b128 v[20:23], v1 offset:2048
v_mfma_f32_16x16x32_bf16 v[68:71], v[32:35], a[60:63], v[68:71]
s_setprio 0
s_waitcnt lgkmcnt(4)
v_mfma_f32_16x16x32_bf16 v[72:75], v[36:39], a[56:59], v[72:75]
s_setprio 1
ds_read_b128 v[24:27], v1 offset:4096
v_mfma_f32_16x16x32_bf16 v[76:79], v[36:39], a[60:63], v[76:79]
s_setprio 0
s_waitcnt lgkmcnt(4)
v_mfma_f32_16x16x32_bf16 v[80:83], v[40:43], a[56:59], v[80:83]
s_setprio 1
ds_read_b128 v[28:31], v1 offset:6144
v_mfma_f32_16x16x32_bf16 v[84:87], v[40:43], a[60:63], v[84:87]
s_setprio 0
s_waitcnt lgkmcnt(4)
v_mfma_f32_16x16x32_bf16 v[88:91], v[44:47], a[56:59], v[88:91]
s_setprio 1
ds_read_b128 v[32:35], v1 offset:8192
v_mfma_f32_16x16x32_bf16 v[92:95], v[44:47], a[60:63], v[92:95]
s_setprio 0
s_waitcnt lgkmcnt(4)
v_mfma_f32_16x16x32_bf16 v[48:51], v[16:19], a[64:67], v[48:51]
s_setprio 1
ds_read_b128 v[36:39], v1 offset:10240
v_mfma_f32_16x16x32_bf16 v[52:55], v[16:19], a[68:71], v[52:55]
s_setprio 0
s_waitcnt lgkmcnt(4)
v_mfma_f32_16x16x32_bf16 v[56:59], v[20:23], a[64:67], v[56:59]
s_setprio 1
ds_read_b128 v[40:43], v1 offset:1024
v_mfma_f32_16x16x32_bf16 v[60:63], v[20:23], a[68:71], v[60:63]
s_setprio 0
s_waitcnt lgkmcnt(4)
v_mfma_f32_16x16x32_bf16 v[64:67], v[24:27], a[64:67], v[64:67]
s_setprio 1
ds_read_b128 v[44:47], v1 offset:3072
v_mfma_f32_16x16x32_bf16 v[68:71], v[24:27], a[68:71], v[68:71]
s_setprio 0
s_waitcnt lgkmcnt(4)
v_mfma_f32_16x16x32_bf16 v[72:75], v[28:31], a[64:67], v[72:75]
s_setprio 1
ds_read_b128 v[16:19], v1 offset:5120
v_mfma_f32_16x16x32_bf16 v[76:79], v[28:31], a[68:71], v[76:79]
s_setprio 0
s_waitcnt lgkmcnt(4)
v_mfma_f32_16x16x32_bf16 v[80:83], v[32:35], a[64:67], v[80:83]
s_setprio 1
ds_read_b128 v[20:23], v1 offset:7168
v_mfma_f32_16x16x32_bf16 v[84:87], v[32:35], a[68:71], v[84:87]
s_setprio 0
s_waitcnt lgkmcnt(4)
v_mfma_f32_16x16x32_bf16 v[88:91], v[36:39], a[64:67], v[88:91]
s_setprio 1
ds_read_b128 v[24:27], v1 offset:9216
v_mfma_f32_16x16x32_bf16 v[92:95], v[36:39], a[68:71], v[92:95]
s_setprio 0
s_waitcnt vmcnt(3)
s_barrier
s_waitcnt lgkmcnt(4)
v_mfma_f32_16x16x32_bf16 v[48:51], v[40:43], a[72:75], v[48:51]
s_setprio 1
ds_read_b128 v[28:31], v1 offset:11264
v_mfma_f32_16x16x32_bf16 v[52:55], v[40:43], a[76:79], v[52:55]
s_setprio 0
s_waitcnt lgkmcnt(4)
v_mfma_f32_16x16x32_bf16 v[56:59], v[44:47], a[72:75], v[56:59]
s_setprio 1
ds_read_b128 v[32:35], v1 offset:49152
v_mfma_f32_16x16x32_bf16 v[60:63], v[44:47], a[76:79], v[60:63]
s_setprio 0
s_add_u32 s53, s53, 688128
s_add_u32 m0, s51, 0x1a800
s_nop 0
buffer_load_dwordx4 v3, s[32:35], s53 offen offset:0 lds
buffer_load_dwordx4 v3, s[32:35], s53 offen offset:1024 lds
buffer_load_dwordx4 v3, s[32:35], s53 offen offset:2048 lds
s_waitcnt lgkmcnt(4)
v_mfma_f32_16x16x32_bf16 v[64:67], v[16:19], a[72:75], v[64:67]
s_setprio 1
ds_read_b128 v[36:39], v1 offset:51200
v_mfma_f32_16x16x32_bf16 v[68:71], v[16:19], a[76:79], v[68:71]
s_setprio 0
s_waitcnt lgkmcnt(4)
v_mfma_f32_16x16x32_bf16 v[72:75], v[20:23], a[72:75], v[72:75]
s_setprio 1
ds_read_b128 v[40:43], v1 offset:53248
v_mfma_f32_16x16x32_bf16 v[76:79], v[20:23], a[76:79], v[76:79]
s_setprio 0
s_waitcnt lgkmcnt(4)
v_mfma_f32_16x16x32_bf16 v[80:83], v[24:27], a[72:75], v[80:83]
s_setprio 1
ds_read_b128 v[44:47], v1 offset:55296
v_mfma_f32_16x16x32_bf16 v[84:87], v[24:27], a[76:79], v[84:87]
s_setprio 0
s_waitcnt lgkmcnt(4)
v_mfma_f32_16x16x32_bf16 v[88:91], v[28:31], a[72:75], v[88:91]
s_setprio 1
ds_read_b128 v[16:19], v1 offset:57344
v_mfma_f32_16x16x32_bf16 v[92:95], v[28:31], a[76:79], v[92:95]
s_setprio 0
s_waitcnt lgkmcnt(4)
v_mfma_f32_16x16x32_bf16 v[48:51], v[32:35], a[80:83], v[48:51]
s_setprio 1
ds_read_b128 v[20:23], v1 offset:59392
v_mfma_f32_16x16x32_bf16 v[52:55], v[32:35], a[84:87], v[52:55]
s_setprio 0
s_waitcnt lgkmcnt(4)
v_mfma_f32_16x16x32_bf16 v[56:59], v[36:39], a[80:83], v[56:59]
s_setprio 1
ds_read_b128 v[24:27], v1 offset:50176
v_mfma_f32_16x16x32_bf16 v[60:63], v[36:39], a[84:87], v[60:63]
s_setprio 0
s_waitcnt lgkmcnt(4)
v_mfma_f32_16x16x32_bf16 v[64:67], v[40:43], a[80:83], v[64:67]
s_setprio 1
ds_read_b128 v[28:31], v1 offset:52224
v_mfma_f32_16x16x32_bf16 v[68:71], v[40:43], a[84:87], v[68:71]
s_setprio 0
s_waitcnt lgkmcnt(4)
v_mfma_f32_16x16x32_bf16 v[72:75], v[44:47], a[80:83], v[72:75]
s_setprio 1
ds_read_b128 v[32:35], v1 offset:54272
v_mfma_f32_16x16x32_bf16 v[76:79], v[44:47], a[84:87], v[76:79]
s_setprio 0
s_waitcnt lgkmcnt(4)
v_mfma_f32_16x16x32_bf16 v[80:83], v[16:19], a[80:83], v[80:83]
s_setprio 1
ds_read_b128 v[36:39], v1 offset:56320
v_mfma_f32_16x16x32_bf16 v[84:87], v[16:19], a[84:87], v[84:87]
s_setprio 0
s_waitcnt lgkmcnt(4)
v_mfma_f32_16x16x32_bf16 v[88:91], v[20:23], a[80:83], v[88:91]
s_setprio 1
ds_read_b128 v[40:43], v1 offset:58368
v_mfma_f32_16x16x32_bf16 v[92:95], v[20:23], a[84:87], v[92:95]
s_setprio 0
s_waitcnt vmcnt(3)
s_barrier
s_waitcnt lgkmcnt(4)
v_mfma_f32_16x16x32_bf16 v[48:51], v[24:27], a[88:91], v[48:51]
s_setprio 1
ds_read_b128 v[44:47], v1 offset:60416
v_mfma_f32_16x16x32_bf16 v[52:55], v[24:27], a[92:95], v[52:55]
s_setprio 0
s_waitcnt lgkmcnt(4)
v_mfma_f32_16x16x32_bf16 v[56:59], v[28:31], a[88:91], v[56:59]
s_setprio 1
v_add_u32 v1, 0xfffee000, v1
ds_read_b128 v[16:19], v1 offset:0
v_mfma_f32_16x16x32_bf16 v[60:63], v[28:31], a[92:95], v[60:63]
s_setprio 0
s_add_u32 s53, s53, 688128
s_add_u32 m0, s51, 0x14800
s_nop 0
buffer_load_dwordx4 v3, s[32:35], s53 offen offset:0 lds
buffer_load_dwordx4 v3, s[32:35], s53 offen offset:1024 lds
buffer_load_dwordx4 v3, s[32:35], s53 offen offset:2048 lds
s_waitcnt lgkmcnt(4)
v_mfma_f32_16x16x32_bf16 v[64:67], v[32:35], a[88:91], v[64:67]
s_setprio 1
ds_read_b128 v[20:23], v1 offset:2048
v_mfma_f32_16x16x32_bf16 v[68:71], v[32:35], a[92:95], v[68:71]
s_setprio 0
s_waitcnt lgkmcnt(4)
v_mfma_f32_16x16x32_bf16 v[72:75], v[36:39], a[88:91], v[72:75]
s_setprio 1
ds_read_b128 v[24:27], v1 offset:4096
v_mfma_f32_16x16x32_bf16 v[76:79], v[36:39], a[92:95], v[76:79]
s_setprio 0
s_waitcnt lgkmcnt(4)
v_mfma_f32_16x16x32_bf16 v[80:83], v[40:43], a[88:91], v[80:83]
s_setprio 1
ds_read_b128 v[28:31], v1 offset:6144
v_mfma_f32_16x16x32_bf16 v[84:87], v[40:43], a[92:95], v[84:87]
s_setprio 0
s_waitcnt lgkmcnt(4)
v_mfma_f32_16x16x32_bf16 v[88:91], v[44:47], a[88:91], v[88:91]
s_setprio 1
ds_read_b128 v[32:35], v1 offset:8192
v_mfma_f32_16x16x32_bf16 v[92:95], v[44:47], a[92:95], v[92:95]
s_setprio 0
s_waitcnt lgkmcnt(4)
v_mfma_f32_16x16x32_bf16 v[48:51], v[16:19], a[96:99], v[48:51]
s_setprio 1
ds_read_b128 v[36:39], v1 offset:10240
v_mfma_f32_16x16x32_bf16 v[52:55], v[16:19], a[100:103], v[52:55]
s_setprio 0
s_waitcnt lgkmcnt(4)
v_mfma_f32_16x16x32_bf16 v[56:59], v[20:23], a[96:99], v[56:59]
s_setprio 1
ds_read_b128 v[40:43], v1 offset:1024
v_mfma_f32_16x16x32_bf16 v[60:63], v[20:23], a[100:103], v[60:63]
s_setprio 0
s_waitcnt lgkmcnt(4)
v_mfma_f32_16x16x32_bf16 v[64:67], v[24:27], a[96:99], v[64:67]
s_setprio 1
ds_read_b128 v[44:47], v1 offset:3072
v_mfma_f32_16x16x32_bf16 v[68:71], v[24:27], a[100:103], v[68:71]
s_setprio 0
s_waitcnt lgkmcnt(4)
v_mfma_f32_16x16x32_bf16 v[72:75], v[28:31], a[96:99], v[72:75]
s_setprio 1
ds_read_b128 v[16:19], v1 offset:5120
v_mfma_f32_16x16x32_bf16 v[76:79], v[28:31], a[100:103], v[76:79]
s_setprio 0
s_waitcnt lgkmcnt(4)
v_mfma_f32_16x16x32_bf16 v[80:83], v[32:35], a[96:99], v[80:83]
s_setprio 1
ds_read_b128 v[20:23], v1 offset:7168
v_mfma_f32_16x16x32_bf16 v[84:87], v[32:35], a[100:103], v[84:87]
s_setprio 0
s_waitcnt lgkmcnt(4)
v_mfma_f32_16x16x32_bf16 v[88:91], v[36:39], a[96:99], v[88:91]
s_setprio 1
ds_read_b128 v[24:27], v1 offset:9216
v_mfma_f32_16x16x32_bf16 v[92:95], v[36:39], a[100:103], v[92:95]
s_setprio 0
s_waitcnt vmcnt(3)
s_barrier
s_waitcnt lgkmcnt(4)
v_mfma_f32_16x16x32_bf16 v[48:51], v[40:43], a[104:107], v[48:51]
s_setprio 1
ds_read_b128 v[28:31], v1 offset:11264
v_mfma_f32_16x16x32_bf16 v[52:55], v[40:43], a[108:111], v[52:55]
s_setprio 0
s_waitcnt lgkmcnt(4)
v_mfma_f32_16x16x32_bf16 v[56:59], v[44:47], a[104:107], v[56:59]
s_setprio 1
v_add_u32 v1, 0x18000, v1
ds_read_b128 v[32:35], v1 offset:0
v_mfma_f32_16x16x32_bf16 v[60:63], v[44:47], a[108:111], v[60:63]
s_setprio 0
s_add_u32 s53, s53, 688128
s_add_u32 m0, s51, 0x20800
s_nop 0
buffer_load_dwordx4 v3, s[32:35], s53 offen offset:0 lds
buffer_load_dwordx4 v3, s[32:35], s53 offen offset:1024 lds
buffer_load_dwordx4 v3, s[32:35], s53 offen offset:2048 lds
s_waitcnt lgkmcnt(4)
v_mfma_f32_16x16x32_bf16 v[64:67], v[16:19], a[104:107], v[64:67]
s_setprio 1
ds_read_b128 v[36:39], v1 offset:2048
v_mfma_f32_16x16x32_bf16 v[68:71], v[16:19], a[108:111], v[68:71]
s_setprio 0
s_waitcnt lgkmcnt(4)
v_mfma_f32_16x16x32_bf16 v[72:75], v[20:23], a[104:107], v[72:75]
s_setprio 1
ds_read_b128 v[40:43], v1 offset:4096
v_mfma_f32_16x16x32_bf16 v[76:79], v[20:23], a[108:111], v[76:79]
s_setprio 0
s_waitcnt lgkmcnt(4)
v_mfma_f32_16x16x32_bf16 v[80:83], v[24:27], a[104:107], v[80:83]
s_setprio 1
ds_read_b128 v[44:47], v1 offset:6144
v_mfma_f32_16x16x32_bf16 v[84:87], v[24:27], a[108:111], v[84:87]
s_setprio 0
s_waitcnt lgkmcnt(4)
v_mfma_f32_16x16x32_bf16 v[88:91], v[28:31], a[104:107], v[88:91]
s_setprio 1
ds_read_b128 v[16:19], v1 offset:8192
v_mfma_f32_16x16x32_bf16 v[92:95], v[28:31], a[108:111], v[92:95]
s_setprio 0
s_waitcnt lgkmcnt(4)
v_mfma_f32_16x16x32_bf16 v[48:51], v[32:35], a[112:115], v[48:51]
s_setprio 1
ds_read_b128 v[20:23], v1 offset:10240
v_mfma_f32_16x16x32_bf16 v[52:55], v[32:35], a[116:119], v[52:55]
s_setprio 0
s_waitcnt lgkmcnt(4)
v_mfma_f32_16x16x32_bf16 v[56:59], v[36:39], a[112:115], v[56:59]
s_setprio 1
ds_read_b128 v[24:27], v1 offset:1024
v_mfma_f32_16x16x32_bf16 v[60:63], v[36:39], a[116:119], v[60:63]
s_setprio 0
s_waitcnt lgkmcnt(4)
v_mfma_f32_16x16x32_bf16 v[64:67], v[40:43], a[112:115], v[64:67]
s_setprio 1
ds_read_b128 v[28:31], v1 offset:3072
v_mfma_f32_16x16x32_bf16 v[68:71], v[40:43], a[116:119], v[68:71]
s_setprio 0
s_waitcnt lgkmcnt(4)
v_mfma_f32_16x16x32_bf16 v[72:75], v[44:47], a[112:115], v[72:75]
s_setprio 1
ds_read_b128 v[32:35], v1 offset:5120
v_mfma_f32_16x16x32_bf16 v[76:79], v[44:47], a[116:119], v[76:79]
s_setprio 0
s_waitcnt lgkmcnt(4)
v_mfma_f32_16x16x32_bf16 v[80:83], v[16:19], a[112:115], v[80:83]
s_setprio 1
ds_read_b128 v[36:39], v1 offset:7168
v_mfma_f32_16x16x32_bf16 v[84:87], v[16:19], a[116:119], v[84:87]
s_setprio 0
s_waitcnt lgkmcnt(4)
v_mfma_f32_16x16x32_bf16 v[88:91], v[20:23], a[112:115], v[88:91]
s_setprio 1
ds_read_b128 v[40:43], v1 offset:9216
v_mfma_f32_16x16x32_bf16 v[92:95], v[20:23], a[116:119], v[92:95]
s_setprio 0
s_waitcnt vmcnt(3)
s_barrier
s_waitcnt lgkmcnt(4)
v_mfma_f32_16x16x32_bf16 v[48:51], v[24:27], a[120:123], v[48:51]
s_setprio 1
ds_read_b128 v[44:47], v1 offset:11264
v_mfma_f32_16x16x32_bf16 v[52:55], v[24:27], a[124:127], v[52:55]
s_setprio 0
s_waitcnt lgkmcnt(4)
v_mfma_f32_16x16x32_bf16 v[56:59], v[28:31], a[120:123], v[56:59]
s_setprio 1
v_add_u32 v1, 0xffffa000, v1
ds_read_b128 v[16:19], v1 offset:0
v_mfma_f32_16x16x32_bf16 v[60:63], v[28:31], a[124:127], v[60:63]
s_setprio 0
s_waitcnt lgkmcnt(4)
v_mfma_f32_16x16x32_bf16 v[64:67], v[32:35], a[120:123], v[64:67]
s_setprio 1
ds_read_b128 v[20:23], v1 offset:2048
v_mfma_f32_16x16x32_bf16 v[68:71], v[32:35], a[124:127], v[68:71]
s_setprio 0
s_waitcnt lgkmcnt(4)
v_mfma_f32_16x16x32_bf16 v[72:75], v[36:39], a[120:123], v[72:75]
s_setprio 1
ds_read_b128 v[24:27], v1 offset:4096
v_mfma_f32_16x16x32_bf16 v[76:79], v[36:39], a[124:127], v[76:79]
s_setprio 0
s_waitcnt lgkmcnt(4)
v_mfma_f32_16x16x32_bf16 v[80:83], v[40:43], a[120:123], v[80:83]
s_setprio 1
ds_read_b128 v[28:31], v1 offset:6144
v_mfma_f32_16x16x32_bf16 v[84:87], v[40:43], a[124:127], v[84:87]
s_setprio 0
s_waitcnt lgkmcnt(4)
v_mfma_f32_16x16x32_bf16 v[88:91], v[44:47], a[120:123], v[88:91]
s_setprio 1
ds_read_b128 v[32:35], v1 offset:8192
v_mfma_f32_16x16x32_bf16 v[92:95], v[44:47], a[124:127], v[92:95]
s_setprio 0
s_waitcnt lgkmcnt(4)
v_mfma_f32_16x16x32_bf16 v[48:51], v[16:19], a[128:131], v[48:51]
s_setprio 1
ds_read_b128 v[36:39], v1 offset:10240
v_mfma_f32_16x16x32_bf16 v[52:55], v[16:19], a[132:135], v[52:55]
s_setprio 0
s_waitcnt lgkmcnt(4)
v_mfma_f32_16x16x32_bf16 v[56:59], v[20:23], a[128:131], v[56:59]
s_setprio 1
ds_read_b128 v[40:43], v1 offset:1024
v_mfma_f32_16x16x32_bf16 v[60:63], v[20:23], a[132:135], v[60:63]
s_setprio 0
s_waitcnt lgkmcnt(4)
v_mfma_f32_16x16x32_bf16 v[64:67], v[24:27], a[128:131], v[64:67]
s_setprio 1
ds_read_b128 v[44:47], v1 offset:3072
v_mfma_f32_16x16x32_bf16 v[68:71], v[24:27], a[132:135], v[68:71]
s_setprio 0
s_waitcnt lgkmcnt(4)
v_mfma_f32_16x16x32_bf16 v[72:75], v[28:31], a[128:131], v[72:75]
s_setprio 1
ds_read_b128 v[16:19], v1 offset:5120
v_mfma_f32_16x16x32_bf16 v[76:79], v[28:31], a[132:135], v[76:79]
s_setprio 0
s_waitcnt lgkmcnt(4)
v_mfma_f32_16x16x32_bf16 v[80:83], v[32:35], a[128:131], v[80:83]
s_setprio 1
ds_read_b128 v[20:23], v1 offset:7168
v_mfma_f32_16x16x32_bf16 v[84:87], v[32:35], a[132:135], v[84:87]
s_setprio 0
s_waitcnt lgkmcnt(4)
v_mfma_f32_16x16x32_bf16 v[88:91], v[36:39], a[128:131], v[88:91]
s_setprio 1
ds_read_b128 v[24:27], v1 offset:9216
v_mfma_f32_16x16x32_bf16 v[92:95], v[36:39], a[132:135], v[92:95]
s_setprio 0
s_waitcnt vmcnt(0)
s_barrier
s_waitcnt lgkmcnt(4)
v_mfma_f32_16x16x32_bf16 v[48:51], v[40:43], a[136:139], v[48:51]
s_setprio 1
ds_read_b128 v[28:31], v1 offset:11264
v_mfma_f32_16x16x32_bf16 v[52:55], v[40:43], a[140:143], v[52:55]
s_setprio 0
s_waitcnt lgkmcnt(4)
v_mfma_f32_16x16x32_bf16 v[56:59], v[44:47], a[136:139], v[56:59]
s_setprio 1
ds_read_b128 v[32:35], v1 offset:49152
v_mfma_f32_16x16x32_bf16 v[60:63], v[44:47], a[140:143], v[60:63]
s_setprio 0
s_waitcnt lgkmcnt(4)
v_mfma_f32_16x16x32_bf16 v[64:67], v[16:19], a[136:139], v[64:67]
s_setprio 1
ds_read_b128 v[36:39], v1 offset:51200
v_mfma_f32_16x16x32_bf16 v[68:71], v[16:19], a[140:143], v[68:71]
s_setprio 0
s_lshl_b32 s60, s3, 11
s_add_u32 s60, s60, 148480
s_cmp_eq_u32 s3, 7
s_cselect_b32 s60, 68096, s60
v_add_u32 v5, s60, v3
v_bfe_u32 v6, v3, 4, 4
v_lshrrev_b32 v7, 8, v3
v_mul_u32_u24 v8, 320, v7
v_lshl_add_u32 v8, v6, 2, v8
s_lshl_b32 s60, s7, 2
s_add_u32 s60, s60, s4
s_mul_i32 s60, s60, 1792
s_add_u32 s60, s60, 1280
v_mov_b32 v4, 0x7f000000
ds_read_b128 v[10:13], v5 offset:0
v_mov_b32 v9, v8
v_cmp_ge_u32 vcc, 1, v7
s_nop 1
v_cndmask_b32 v9, v4, v9, vcc
s_waitcnt lgkmcnt(0)
buffer_atomic_add_f32 v10, v9, s[40:43], s60 offen offset:0
v_mov_b32 v9, v8
v_cmp_ge_u32 vcc, 0, v7
s_nop 1
v_cndmask_b32 v9, v4, v9, vcc
buffer_atomic_add_f32 v11, v9, s[40:43], s60 offen offset:80
buffer_atomic_add_f32 v12, v9, s[40:43], s60 offen offset:160
buffer_atomic_add_f32 v13, v9, s[40:43], s60 offen offset:240
s_nop 1
ds_read_b128 v[10:13], v5 offset:1024
v_mov_b32 v9, v8
v_cmp_gt_u32 vcc, 4, v6
s_nop 1
v_cndmask_b32 v9, v4, v9, vcc
v_cmp_ge_u32 vcc, 1, v7
s_nop 1
v_cndmask_b32 v9, v4, v9, vcc
s_waitcnt lgkmcnt(0)
buffer_atomic_add_f32 v10, v9, s[40:43], s60 offen offset:64
v_mov_b32 v9, v8
v_cmp_gt_u32 vcc, 4, v6
s_nop 1
v_cndmask_b32 v9, v4, v9, vcc
v_cmp_ge_u32 vcc, 0, v7
s_nop 1
v_cndmask_b32 v9, v4, v9, vcc
buffer_atomic_add_f32 v11, v9, s[40:43], s60 offen offset:144
buffer_atomic_add_f32 v12, v9, s[40:43], s60 offen offset:224
buffer_atomic_add_f32 v13, v9, s[40:43], s60 offen offset:304
s_nop 1
v_mfma_f32_16x16x32_bf16 v[72:75], v[20:23], a[136:139], v[72:75]
s_setprio 1
ds_read_b128 v[40:43], v1 offset:53248
v_mfma_f32_16x16x32_bf16 v[76:79], v[20:23], a[140:143], v[76:79]
s_setprio 0
v_mfma_f32_16x16x32_bf16 v[80:83], v[24:27], a[136:139], v[80:83]
s_setprio 1
ds_read_b128 v[44:47], v1 offset:55296
v_mfma_f32_16x16x32_bf16 v[84:87], v[24:27], a[140:143], v[84:87]
s_setprio 0
v_mfma_f32_16x16x32_bf16 v[88:91], v[28:31], a[136:139], v[88:91]
s_setprio 1
ds_read_b128 v[16:19], v1 offset:57344
v_mfma_f32_16x16x32_bf16 v[92:95], v[28:31], a[140:143], v[92:95]
s_setprio 0
v_mfma_f32_16x16x32_bf16 v[48:51], v[32:35], a[144:147], v[48:51]
s_setprio 1
ds_read_b128 v[20:23], v1 offset:59392
v_mfma_f32_16x16x32_bf16 v[52:55], v[32:35], a[148:151], v[52:55]
s_setprio 0
v_mfma_f32_16x16x32_bf16 v[56:59], v[36:39], a[144:147], v[56:59]
s_setprio 1
ds_read_b128 v[24:27], v1 offset:50176
v_mfma_f32_16x16x32_bf16 v[60:63], v[36:39], a[148:151], v[60:63]
s_setprio 0
s_waitcnt lgkmcnt(4)
v_mfma_f32_16x16x32_bf16 v[64:67], v[40:43], a[144:147], v[64:67]
s_setprio 1
ds_read_b128 v[28:31], v1 offset:52224
v_mfma_f32_16x16x32_bf16 v[68:71], v[40:43], a[148:151], v[68:71]
s_setprio 0
s_waitcnt lgkmcnt(4)
v_mfma_f32_16x16x32_bf16 v[72:75], v[44:47], a[144:147], v[72:75]
s_setprio 1
ds_read_b128 v[32:35], v1 offset:54272
v_mfma_f32_16x16x32_bf16 v[76:79], v[44:47], a[148:151], v[76:79]
s_setprio 0
s_waitcnt lgkmcnt(4)
v_mfma_f32_16x16x32_bf16 v[80:83], v[16:19], a[144:147], v[80:83]
s_setprio 1
ds_read_b128 v[36:39], v1 offset:56320
v_mfma_f32_16x16x32_bf16 v[84:87], v[16:19], a[148:151], v[84:87]
s_setprio 0
s_waitcnt lgkmcnt(4)
v_mfma_f32_16x16x32_bf16 v[88:91], v[20:23], a[144:147], v[88:91]
s_setprio 1
ds_read_b128 v[40:43], v1 offset:58368
v_mfma_f32_16x16x32_bf16 v[92:95], v[20:23], a[148:151], v[92:95]
s_setprio 0
s_waitcnt lgkmcnt(4)
v_mfma_f32_16x16x32_bf16 v[48:51], v[24:27], a[152:155], v[48:51]
s_setprio 1
ds_read_b128 v[44:47], v1 offset:60416
v_mfma_f32_16x16x32_bf16 v[52:55], v[24:27], a[156:159], v[52:55]
s_setprio 0
s_waitcnt lgkmcnt(4)
v_mfma_f32_16x16x32_bf16 v[56:59], v[28:31], a[152:155], v[56:59]
s_setprio 1
v_mfma_f32_16x16x32_bf16 v[60:63], v[28:31], a[156:159], v[60:63]
s_setprio 0
s_waitcnt lgkmcnt(3)
v_mfma_f32_16x16x32_bf16 v[64:67], v[32:35], a[152:155], v[64:67]
s_setprio 1
v_mfma_f32_16x16x32_bf16 v[68:71], v[32:35], a[156:159], v[68:71]
s_setprio 0
s_waitcnt lgkmcnt(2)
v_mfma_f32_16x16x32_bf16 v[72:75], v[36:39], a[152:155], v[72:75]
s_setprio 1
v_mfma_f32_16x16x32_bf16 v[76:79], v[36:39], a[156:159], v[76:79]
s_setprio 0
s_waitcnt lgkmcnt(1)
v_mfma_f32_16x16x32_bf16 v[80:83], v[40:43], a[152:155], v[80:83]
s_setprio 1
v_mfma_f32_16x16x32_bf16 v[84:87], v[40:43], a[156:159], v[84:87]
s_setprio 0
s_waitcnt lgkmcnt(0)
v_mfma_f32_16x16x32_bf16 v[88:91], v[44:47], a[152:155], v[88:91]
s_setprio 1
v_mfma_f32_16x16x32_bf16 v[92:95], v[44:47], a[156:159], v[92:95]
s_setprio 0
s_nop 5
s_lshl_b32 s60, s56, 10
s_add_u32 s60, s60, s54
s_add_u32 s60, s60, 40960
v_pk_mul_f32 v[48:49], v[48:49], s[82:83]
v_pk_mul_f32 v[50:51], v[50:51], s[82:83]
v_exp_f32 v48, v48
v_exp_f32 v49, v49
v_exp_f32 v50, v50
v_exp_f32 v51, v51
s_nop 0
v_pk_add_f32 v[48:49], v[48:49], s[84:85]
v_pk_add_f32 v[50:51], v[50:51], s[84:85]
v_rcp_f32 v48, v48
v_rcp_f32 v49, v49
v_rcp_f32 v50, v50
v_rcp_f32 v51, v51
s_nop 0
v_pk_mul_f32 v[56:57], v[56:57], v[48:49]
v_pk_mul_f32 v[58:59], v[58:59], v[50:51]
v_pk_mul_f32 v[52:53], v[52:53], s[82:83]
v_pk_mul_f32 v[54:55], v[54:55], s[82:83]
v_exp_f32 v52, v52
v_exp_f32 v53, v53
v_exp_f32 v54, v54
v_exp_f32 v55, v55
s_nop 0
v_pk_add_f32 v[52:53], v[52:53], s[84:85]
v_pk_add_f32 v[54:55], v[54:55], s[84:85]
v_rcp_f32 v52, v52
v_rcp_f32 v53, v53
v_rcp_f32 v54, v54
v_rcp_f32 v55, v55
s_nop 0
v_pk_mul_f32 v[60:61], v[60:61], v[52:53]
v_pk_mul_f32 v[62:63], v[62:63], v[54:55]
v_cvt_pk_bf16_f32 v20, v56, v57
v_cvt_pk_bf16_f32 v21, v58, v59
v_cvt_pk_bf16_f32 v22, v60, v61
v_cvt_pk_bf16_f32 v23, v62, v63
s_nop 1
v_permlane16_swap_b32 v20, v22
v_permlane16_swap_b32 v21, v23
s_nop 0
buffer_store_dwordx4 v[20:23], v3, s[36:39], s60 offen offset:0 sc1
v_pk_mul_f32 v[64:65], v[64:65], s[82:83]
v_pk_mul_f32 v[66:67], v[66:67], s[82:83]
v_exp_f32 v64, v64
v_exp_f32 v65, v65
v_exp_f32 v66, v66
v_exp_f32 v67, v67
s_nop 0
v_pk_add_f32 v[64:65], v[64:65], s[84:85]
v_pk_add_f32 v[66:67], v[66:67], s[84:85]
v_rcp_f32 v64, v64
v_rcp_f32 v65, v65
v_rcp_f32 v66, v66
v_rcp_f32 v67, v67
s_nop 0
v_pk_mul_f32 v[72:73], v[72:73], v[64:65]
v_pk_mul_f32 v[74:75], v[74:75], v[66:67]
v_pk_mul_f32 v[68:69], v[68:69], s[82:83]
v_pk_mul_f32 v[70:71], v[70:71], s[82:83]
v_exp_f32 v68, v68
v_exp_f32 v69, v69
v_exp_f32 v70, v70
v_exp_f32 v71, v71
s_nop 0
v_pk_add_f32 v[68:69], v[68:69], s[84:85]
v_pk_add_f32 v[70:71], v[70:71], s[84:85]
v_rcp_f32 v68, v68
v_rcp_f32 v69, v69
v_rcp_f32 v70, v70
v_rcp_f32 v71, v71
s_nop 0
v_pk_mul_f32 v[76:77], v[76:77], v[68:69]
v_pk_mul_f32 v[78:79], v[78:79], v[70:71]
v_cvt_pk_bf16_f32 v24, v72, v73
v_cvt_pk_bf16_f32 v25, v74, v75
v_cvt_pk_bf16_f32 v26, v76, v77
v_cvt_pk_bf16_f32 v27, v78, v79
s_nop 1
v_permlane16_swap_b32 v24, v26
v_permlane16_swap_b32 v25, v27
s_nop 0
buffer_store_dwordx4 v[24:27], v3, s[36:39], s60 offen offset:1024 sc1
v_pk_mul_f32 v[80:81], v[80:81], s[82:83]
v_pk_mul_f32 v[82:83], v[82:83], s[82:83]
v_exp_f32 v80, v80
v_exp_f32 v81, v81
v_exp_f32 v82, v82
v_exp_f32 v83, v83
s_nop 0
v_pk_add_f32 v[80:81], v[80:81], s[84:85]
v_pk_add_f32 v[82:83], v[82:83], s[84:85]
v_rcp_f32 v80, v80
v_rcp_f32 v81, v81
v_rcp_f32 v82, v82
v_rcp_f32 v83, v83
s_nop 0
v_pk_mul_f32 v[88:89], v[88:89], v[80:81]
v_pk_mul_f32 v[90:91], v[90:91], v[82:83]
v_pk_mul_f32 v[84:85], v[84:85], s[82:83]
v_pk_mul_f32 v[86:87], v[86:87], s[82:83]
v_exp_f32 v84, v84
v_exp_f32 v85, v85
v_exp_f32 v86, v86
v_exp_f32 v87, v87
s_nop 0
v_pk_add_f32 v[84:85], v[84:85], s[84:85]
v_pk_add_f32 v[86:87], v[86:87], s[84:85]
v_rcp_f32 v84, v84
v_rcp_f32 v85, v85
v_rcp_f32 v86, v86
v_rcp_f32 v87, v87
s_nop 0
v_pk_mul_f32 v[92:93], v[92:93], v[84:85]
v_pk_mul_f32 v[94:95], v[94:95], v[86:87]
v_cvt_pk_bf16_f32 v20, v88, v89
v_cvt_pk_bf16_f32 v21, v90, v91
v_cvt_pk_bf16_f32 v22, v92, v93
v_cvt_pk_bf16_f32 v23, v94, v95
s_nop 1
v_permlane16_swap_b32 v20, v22
v_permlane16_swap_b32 v21, v23
s_nop 0
buffer_store_dwordx4 v[20:23], v3, s[36:39], s60 offen offset:2048 sc1
s_branch k1_kernel_end
k1_kernel_end:
s_endpgm
.set CODE_BYTES_K1, k1_kernel_end - k1_kernel
.p2align 8
.globl k2_kernel
.type k2_kernel,@function
k2_kernel:
s_cmp_ge_u32 s2, 256
s_cbranch_scc1 k2_kernel_end
s_load_dwordx2 s[4:5], s[0:1], 0
s_load_dwordx2 s[6:7], s[0:1], 56
s_load_dwordx2 s[8:9], s[0:1], 72
s_getpc_b64 s[40:41]
k2_kernel_pc:
s_mov_b32 s42, k2_kernel_tabend - k2_kernel_pc
s_mov_b32 s43, 0x20000
v_lshlrev_b32 v1, 7, v0
buffer_load_dword v175, v1, s[40:43], 0 offen
v_and_b32 v1, 63, v0
v_lshrrev_b32 v2, 6, v0
v_and_b32 v3, 15, v1
v_lshrrev_b32 v4, 4, v1
v_readfirstlane_b32 s3, v2
v_lshrrev_b32 v5, 1, v4
v_lshlrev_b32 v5, 10, v5
v_and_b32 v6, 1, v4
v_lshlrev_b32 v6, 9, v6
v_lshlrev_b32 v7, 4, v3
v_add3_u32 v5, v5, v6, v7
v_lshlrev_b32 v6, 4, v1
v_add_u32 v7, 0x1000, v6
s_and_b32 s10, s2, 7
s_lshr_b32 s11, s2, 3
s_lshr_b32 s12, s10, 1
s_lshl_b32 s12, s12, 3
s_and_b32 s13, s11, 7
s_add_u32 s12, s12, s13
s_and_b32 s13, s10, 1
s_lshl_b32 s13, s13, 2
s_lshr_b32 s14, s11, 3
s_add_u32 s13, s13, s14
s_and_b32 s44, s3, 3
s_mul_i32 s14, s44, 13
s_min_u32 s15, s44, 2
s_add_u32 s14, s14, s15
s_cmp_lt_u32 s44, 2
s_cselect_b32 s45, 14, 13
s_add_u32 s46, s12, s13
s_and_b32 s46, s46, 3
s_mul_i32 s46, s46, 0
s_mul_i32 s22, s12, 296
s_lshl_b32 s22, s22, 10
s_lshl_b32 s23, s14, 11
s_add_u32 s23, s23, 40960
s_add_u32 s23, s23, s22
s_mul_i32 s15, s44, 10240
s_add_u32 s22, s22, s15
s_add_u32 s15, s44, 0
s_bitcmp1_b32 s15, 1
s_cselect_b32 s53, 151552, 0
s_bitcmp1_b32 s15, 0
s_cselect_b32 s15, 0x100, 0
s_add_u32 s15, s15, s53
s_add_u32 s16, s23, s15
s_add_u32 s48, s22, s15
s_add_u32 s15, s44, 1
s_bitcmp1_b32 s15, 1
s_cselect_b32 s53, 151552, 0
s_bitcmp1_b32 s15, 0
s_cselect_b32 s15, 0x100, 0
s_add_u32 s15, s15, s53
s_add_u32 s17, s23, s15
s_add_u32 s49, s22, s15
s_add_u32 s15, s44, 2
s_bitcmp1_b32 s15, 1
s_cselect_b32 s53, 151552, 0
s_bitcmp1_b32 s15, 0
s_cselect_b32 s15, 0x100, 0
s_add_u32 s15, s15, s53
s_add_u32 s18, s23, s15
s_add_u32 s50, s22, s15
s_add_u32 s15, s44, 3
s_bitcmp1_b32 s15, 1
s_cselect_b32 s53, 151552, 0
s_bitcmp1_b32 s15, 0
s_cselect_b32 s15, 0x100, 0
s_add_u32 s15, s15, s53
s_add_u32 s19, s23, s15
s_add_u32 s51, s22, s15
s_add_u32 s20, s14, 20
s_mul_i32 s20, s20, 40
s_mul_i32 s15, s13, 5
s_add_u32 s20, s20, s15
s_lshl_b32 s20, s20, 10
s_mul_i32 s21, s44, 200
s_add_u32 s21, s21, s15
s_lshl_b32 s21, s21, 10
s_lshl_b32 s15, s12, 6
s_lshl_b32 s22, s44, 4
s_add_u32 s15, s15, s22
v_add_u32 v8, s15, v3
s_movk_i32 s15, 1280
v_mul_lo_u32 v8, v8, s15
s_mul_i32 s15, s13, 160
v_lshlrev_b32 v9, 3, v4
v_add3_u32 v8, v8, v9, s15
s_mul_i32 s52, s44, 19968
s_mul_i32 s15, s44, 20480
s_add_u32 s15, s15, 79872
v_add_u32 v20, s15, v6
s_waitcnt lgkmcnt(0)
s_mov_b32 s24, s8
s_mov_b32 s25, s9
s_mov_b32 s26, 0x940000
s_mov_b32 s27, 0x20000
s_add_u32 s28, s8, 0xa00000
s_addc_u32 s29, s9, 0
s_mov_b32 s30, 0x30c000
s_mov_b32 s31, 0x20000
s_mov_b32 s32, s4
s_mov_b32 s33, s5
s_mov_b32 s34, 0x280000
s_mov_b32 s35, 0x20000
s_mov_b32 s36, s6
s_mov_b32 s37, s7
s_mov_b32 s38, 0x280000
s_mov_b32 s39, 0x20000
s_add_u32 s56, s8, 0xe00000
s_addc_u32 s57, s9, 0
s_mov_b32 s58, 0xe000
s_mov_b32 s59, 0x20000
s_cmp_lt_u32 s3, 4
s_cbranch_scc0 k2_kernel_H
s_mov_b32 s47, s46
s_setprio 3
s_lshl_b32 s22, s47, 11
s_mul_i32 s23, s47, 40960
v_add_u32 v21, s22, v5
v_add_u32 v22, s23, v6
v_add_u32 v23, 0x1000, v22
buffer_load_dwordx4 v[24:27], v21, s[24:27], s16 offen
buffer_load_dwordx4 v[40:43], v22, s[28:31], s20 offen
buffer_load_dwordx4 v[28:31], v21, s[24:27], s17 offen
buffer_load_dwordx4 v[44:47], v22, s[28:31], s20 offen offset:1024
buffer_load_dwordx4 v[32:35], v21, s[24:27], s18 offen
buffer_load_dwordx4 v[48:51], v22, s[28:31], s20 offen offset:2048
buffer_load_dwordx4 v[36:39], v21, s[24:27], s19 offen
buffer_load_dwordx4 v[52:55], v22, s[28:31], s20 offen offset:3072
buffer_load_dwordx4 v[56:59], v23, s[28:31], s20 offen
s_add_u32 s47, s47, 1
s_cmp_ge_u32 s47, s45
s_cselect_b32 s47, 0, s47
s_lshl_b32 s22, s47, 11
s_mul_i32 s23, s47, 40960
v_add_u32 v21, s22, v5
v_add_u32 v22, s23, v6
v_add_u32 v23, 0x1000, v22
buffer_load_dwordx4 v[60:63], v21, s[24:27], s16 offen
buffer_load_dwordx4 v[76:79], v22, s[28:31], s20 offen
buffer_load_dwordx4 v[64:67], v21, s[24:27], s17 offen
buffer_load_dwordx4 v[80:83], v22, s[28:31], s20 offen offset:1024
buffer_load_dwordx4 v[68:71], v21, s[24:27], s18 offen
buffer_load_dwordx4 v[84:87], v22, s[28:31], s20 offen offset:2048
buffer_load_dwordx4 v[72:75], v21, s[24:27], s19 offen
buffer_load_dwordx4 v[88:91], v22, s[28:31], s20 offen offset:3072
buffer_load_dwordx4 v[92:95], v23, s[28:31], s20 offen
s_add_u32 s47, s47, 1
s_cmp_ge_u32 s47, s45
s_cselect_b32 s47, 0, s47
s_lshl_b32 s22, s47, 11
s_mul_i32 s23, s47, 40960
v_add_u32 v21, s22, v5
v_add_u32 v22, s23, v6
v_add_u32 v23, 0x1000, v22
buffer_load_dwordx4 v[96:99], v21, s[24:27], s16 offen
buffer_load_dwordx4 v[112:115], v22, s[28:31], s20 offen
buffer_load_dwordx4 v[100:103], v21, s[24:27], s17 offen
buffer_load_dwordx4 v[116:119], v22, s[28:31], s20 offen offset:1024
buffer_load_dwordx4 v[104:107], v21, s[24:27], s18 offen
buffer_load_dwordx4 v[120:123], v22, s[28:31], s20 offen offset:2048
buffer_load_dwordx4 v[108:111], v21, s[24:27], s19 offen
buffer_load_dwordx4 v[124:127], v22, s[28:31], s20 offen offset:3072
buffer_load_dwordx4 v[128:131], v23, s[28:31], s20 offen
s_add_u32 s47, s47, 1
s_cmp_ge_u32 s47, s45
s_cselect_b32 s47, 0, s47
s_lshl_b32 s22, s47, 11
s_mul_i32 s23, s47, 40960
v_add_u32 v21, s22, v5
v_add_u32 v22, s23, v6
v_add_u32 v23, 0x1000, v22
buffer_load_dwordx4 v[132:135], v21, s[24:27], s16 offen
buffer_load_dwordx4 v[148:151], v22, s[28:31], s20 offen
buffer_load_dwordx4 v[136:139], v21, s[24:27], s17 offen
buffer_load_dwordx4 v[152:155], v22, s[28:31], s20 offen offset:1024
buffer_load_dwordx4 v[140:143], v21, s[24:27], s18 offen
buffer_load_dwordx4 v[156:159], v22, s[28:31], s20 offen offset:2048
buffer_load_dwordx4 v[144:147], v21, s[24:27], s19 offen
buffer_load_dwordx4 v[160:163], v22, s[28:31], s20 offen offset:3072
buffer_load_dwordx4 v[164:167], v23, s[28:31], s20 offen
s_add_u32 s47, s47, 1
s_cmp_ge_u32 s47, s45
s_cselect_b32 s47, 0, s47
s_setprio 0
buffer_load_dwordx2 v[10:11], v8, s[32:35], 0 offen offset:0
buffer_load_dwordx2 v[12:13], v8, s[32:35], 0 offen offset:32
buffer_load_dwordx2 v[14:15], v8, s[32:35], 0 offen offset:64
buffer_load_dwordx2 v[16:17], v8, s[32:35], 0 offen offset:96
buffer_load_dwordx2 v[18:19], v8, s[32:35], 0 offen offset:128
s_waitcnt vmcnt(32)
v_mfma_f32_16x16x32_bf16 a[0:3], v[40:43], v[24:27], 0
v_mfma_f32_16x16x32_bf16 a[4:7], v[40:43], v[28:31], 0
v_mfma_f32_16x16x32_bf16 a[8:11], v[40:43], v[32:35], 0
v_mfma_f32_16x16x32_bf16 a[12:15], v[40:43], v[36:39], 0
v_mfma_f32_16x16x32_bf16 a[16:19], v[44:47], v[24:27], 0
v_mfma_f32_16x16x32_bf16 a[20:23], v[44:47], v[28:31], 0
v_mfma_f32_16x16x32_bf16 a[24:27], v[44:47], v[32:35], 0
v_mfma_f32_16x16x32_bf16 a[28:31], v[44:47], v[36:39], 0
v_mfma_f32_16x16x32_bf16 a[32:35], v[48:51], v[24:27], 0
v_mfma_f32_16x16x32_bf16 a[36:39], v[48:51], v[28:31], 0
v_mfma_f32_16x16x32_bf16 a[40:43], v[48:51], v[32:35], 0
v_mfma_f32_16x16x32_bf16 a[44:47], v[48:51], v[36:39], 0
v_mfma_f32_16x16x32_bf16 a[48:51], v[52:55], v[24:27], 0
v_mfma_f32_16x16x32_bf16 a[52:55], v[52:55], v[28:31], 0
v_mfma_f32_16x16x32_bf16 a[56:59], v[52:55], v[32:35], 0
v_mfma_f32_16x16x32_bf16 a[60:63], v[52:55], v[36:39], 0
v_mfma_f32_16x16x32_bf16 a[64:67], v[56:59], v[24:27], 0
v_mfma_f32_16x16x32_bf16 a[68:71], v[56:59], v[28:31], 0
v_mfma_f32_16x16x32_bf16 a[72:75], v[56:59], v[32:35], 0
v_mfma_f32_16x16x32_bf16 a[76:79], v[56:59], v[36:39], 0
s_lshl_b32 s22, s47, 11
s_mul_i32 s23, s47, 40960
v_add_u32 v21, s22, v5
v_add_u32 v22, s23, v6
v_add_u32 v23, 0x1000, v22
buffer_load_dwordx4 v[24:27], v21, s[24:27], s16 offen
buffer_load_dwordx4 v[40:43], v22, s[28:31], s20 offen
buffer_load_dwordx4 v[28:31], v21, s[24:27], s17 offen
buffer_load_dwordx4 v[44:47], v22, s[28:31], s20 offen offset:1024
buffer_load_dwordx4 v[32:35], v21, s[24:27], s18 offen
buffer_load_dwordx4 v[48:51], v22, s[28:31], s20 offen offset:2048
buffer_load_dwordx4 v[36:39], v21, s[24:27], s19 offen
buffer_load_dwordx4 v[52:55], v22, s[28:31], s20 offen offset:3072
buffer_load_dwordx4 v[56:59], v23, s[28:31], s20 offen
s_add_u32 s47, s47, 1
s_cmp_ge_u32 s47, s45
s_cselect_b32 s47, 0, s47
s_waitcnt vmcnt(32)
v_mfma_f32_16x16x32_bf16 a[0:3], v[76:79], v[60:63], a[0:3]
v_mfma_f32_16x16x32_bf16 a[4:7], v[76:79], v[64:67], a[4:7]
v_mfma_f32_16x16x32_bf16 a[8:11], v[76:79], v[68:71], a[8:11]
v_mfma_f32_16x16x32_bf16 a[12:15], v[76:79], v[72:75], a[12:15]
v_mfma_f32_16x16x32_bf16 a[16:19], v[80:83], v[60:63], a[16:19]
v_mfma_f32_16x16x32_bf16 a[20:23], v[80:83], v[64:67], a[20:23]
v_mfma_f32_16x16x32_bf16 a[24:27], v[80:83], v[68:71], a[24:27]
v_mfma_f32_16x16x32_bf16 a[28:31], v[80:83], v[72:75], a[28:31]
v_mfma_f32_16x16x32_bf16 a[32:35], v[84:87], v[60:63], a[32:35]
v_mfma_f32_16x16x32_bf16 a[36:39], v[84:87], v[64:67], a[36:39]
v_mfma_f32_16x16x32_bf16 a[40:43], v[84:87], v[68:71], a[40:43]
v_mfma_f32_16x16x32_bf16 a[44:47], v[84:87], v[72:75], a[44:47]
v_mfma_f32_16x16x32_bf16 a[48:51], v[88:91], v[60:63], a[48:51]
v_mfma_f32_16x16x32_bf16 a[52:55], v[88:91], v[64:67], a[52:55]
v_mfma_f32_16x16x32_bf16 a[56:59], v[88:91], v[68:71], a[56:59]
v_mfma_f32_16x16x32_bf16 a[60:63], v[88:91], v[72:75], a[60:63]
v_mfma_f32_16x16x32_bf16 a[64:67], v[92:95], v[60:63], a[64:67]
v_mfma_f32_16x16x32_bf16 a[68:71], v[92:95], v[64:67], a[68:71]
v_mfma_f32_16x16x32_bf16 a[72:75], v[92:95], v[68:71], a[72:75]
v_mfma_f32_16x16x32_bf16 a[76:79], v[92:95], v[72:75], a[76:79]
s_lshl_b32 s22, s47, 11
s_mul_i32 s23, s47, 40960
v_add_u32 v21, s22, v5
v_add_u32 v22, s23, v6
v_add_u32 v23, 0x1000, v22
buffer_load_dwordx4 v[60:63], v21, s[24:27], s16 offen
buffer_load_dwordx4 v[76:79], v22, s[28:31], s20 offen
buffer_load_dwordx4 v[64:67], v21, s[24:27], s17 offen
buffer_load_dwordx4 v[80:83], v22, s[28:31], s20 offen offset:1024
buffer_load_dwordx4 v[68:71], v21, s[24:27], s18 offen
buffer_load_dwordx4 v[84:87], v22, s[28:31], s20 offen offset:2048
buffer_load_dwordx4 v[72:75], v21, s[24:27], s19 offen
buffer_load_dwordx4 v[88:91], v22, s[28:31], s20 offen offset:3072
buffer_load_dwordx4 v[92:95], v23, s[28:31], s20 offen
s_add_u32 s47, s47, 1
s_cmp_ge_u32 s47, s45
s_cselect_b32 s47, 0, s47
s_waitcnt vmcnt(32)
v_mfma_f32_16x16x32_bf16 a[0:3], v[112:115], v[96:99], a[0:3]
v_mfma_f32_16x16x32_bf16 a[4:7], v[112:115], v[100:103], a[4:7]
v_mfma_f32_16x16x32_bf16 a[8:11], v[112:115], v[104:107], a[8:11]
v_mfma_f32_16x16x32_bf16 a[12:15], v[112:115], v[108:111], a[12:15]
v_mfma_f32_16x16x32_bf16 a[16:19], v[116:119], v[96:99], a[16:19]
v_mfma_f32_16x16x32_bf16 a[20:23], v[116:119], v[100:103], a[20:23]
v_mfma_f32_16x16x32_bf16 a[24:27], v[116:119], v[104:107], a[24:27]
v_mfma_f32_16x16x32_bf16 a[28:31], v[116:119], v[108:111], a[28:31]
v_mfma_f32_16x16x32_bf16 a[32:35], v[120:123], v[96:99], a[32:35]
v_mfma_f32_16x16x32_bf16 a[36:39], v[120:123], v[100:103], a[36:39]
v_mfma_f32_16x16x32_bf16 a[40:43], v[120:123], v[104:107], a[40:43]
v_mfma_f32_16x16x32_bf16 a[44:47], v[120:123], v[108:111], a[44:47]
v_mfma_f32_16x16x32_bf16 a[48:51], v[124:127], v[96:99], a[48:51]
v_mfma_f32_16x16x32_bf16 a[52:55], v[124:127], v[100:103], a[52:55]
v_mfma_f32_16x16x32_bf16 a[56:59], v[124:127], v[104:107], a[56:59]
v_mfma_f32_16x16x32_bf16 a[60:63], v[124:127], v[108:111], a[60:63]
v_mfma_f32_16x16x32_bf16 a[64:67], v[128:131], v[96:99], a[64:67]
v_mfma_f32_16x16x32_bf16 a[68:71], v[128:131], v[100:103], a[68:71]
v_mfma_f32_16x16x32_bf16 a[72:75], v[128:131], v[104:107], a[72:75]
v_mfma_f32_16x16x32_bf16 a[76:79], v[128:131], v[108:111], a[76:79]
s_lshl_b32 s22, s47, 11
s_mul_i32 s23, s47, 40960
v_add_u32 v21, s22, v5
v_add_u32 v22, s23, v6
v_add_u32 v23, 0x1000, v22
buffer_load_dwordx4 v[96:99], v21, s[24:27], s16 offen
buffer_load_dwordx4 v[112:115], v22, s[28:31], s20 offen
buffer_load_dwordx4 v[100:103], v21, s[24:27], s17 offen
buffer_load_dwordx4 v[116:119], v22, s[28:31], s20 offen offset:1024
buffer_load_dwordx4 v[104:107], v21, s[24:27], s18 offen
buffer_load_dwordx4 v[120:123], v22, s[28:31], s20 offen offset:2048
buffer_load_dwordx4 v[108:111], v21, s[24:27], s19 offen
buffer_load_dwordx4 v[124:127], v22, s[28:31], s20 offen offset:3072
buffer_load_dwordx4 v[128:131], v23, s[28:31], s20 offen
s_add_u32 s47, s47, 1
s_cmp_ge_u32 s47, s45
s_cselect_b32 s47, 0, s47
s_waitcnt vmcnt(32)
v_mfma_f32_16x16x32_bf16 a[0:3], v[148:151], v[132:135], a[0:3]
v_mfma_f32_16x16x32_bf16 a[4:7], v[148:151], v[136:139], a[4:7]
v_mfma_f32_16x16x32_bf16 a[8:11], v[148:151], v[140:143], a[8:11]
v_mfma_f32_16x16x32_bf16 a[12:15], v[148:151], v[144:147], a[12:15]
v_mfma_f32_16x16x32_bf16 a[16:19], v[152:155], v[132:135], a[16:19]
v_mfma_f32_16x16x32_bf16 a[20:23], v[152:155], v[136:139], a[20:23]
v_mfma_f32_16x16x32_bf16 a[24:27], v[152:155], v[140:143], a[24:27]
v_mfma_f32_16x16x32_bf16 a[28:31], v[152:155], v[144:147], a[28:31]
v_mfma_f32_16x16x32_bf16 a[32:35], v[156:159], v[132:135], a[32:35]
v_mfma_f32_16x16x32_bf16 a[36:39], v[156:159], v[136:139], a[36:39]
v_mfma_f32_16x16x32_bf16 a[40:43], v[156:159], v[140:143], a[40:43]
v_mfma_f32_16x16x32_bf16 a[44:47], v[156:159], v[144:147], a[44:47]
v_mfma_f32_16x16x32_bf16 a[48:51], v[160:163], v[132:135], a[48:51]
v_mfma_f32_16x16x32_bf16 a[52:55], v[160:163], v[136:139], a[52:55]
v_mfma_f32_16x16x32_bf16 a[56:59], v[160:163], v[140:143], a[56:59]
v_mfma_f32_16x16x32_bf16 a[60:63], v[160:163], v[144:147], a[60:63]
v_mfma_f32_16x16x32_bf16 a[64:67], v[164:167], v[132:135], a[64:67]
v_mfma_f32_16x16x32_bf16 a[68:71], v[164:167], v[136:139], a[68:71]
v_mfma_f32_16x16x32_bf16 a[72:75], v[164:167], v[140:143], a[72:75]
v_mfma_f32_16x16x32_bf16 a[76:79], v[164:167], v[144:147], a[76:79]
s_lshl_b32 s22, s47, 11
s_mul_i32 s23, s47, 40960
v_add_u32 v21, s22, v5
v_add_u32 v22, s23, v6
v_add_u32 v23, 0x1000, v22
buffer_load_dwordx4 v[132:135], v21, s[24:27], s16 offen
buffer_load_dwordx4 v[148:151], v22, s[28:31], s20 offen
buffer_load_dwordx4 v[136:139], v21, s[24:27], s17 offen
buffer_load_dwordx4 v[152:155], v22, s[28:31], s20 offen offset:1024
buffer_load_dwordx4 v[140:143], v21, s[24:27], s18 offen
buffer_load_dwordx4 v[156:159], v22, s[28:31], s20 offen offset:2048
buffer_load_dwordx4 v[144:147], v21, s[24:27], s19 offen
buffer_load_dwordx4 v[160:163], v22, s[28:31], s20 offen offset:3072
buffer_load_dwordx4 v[164:167], v23, s[28:31], s20 offen
s_add_u32 s47, s47, 1
s_cmp_ge_u32 s47, s45
s_cselect_b32 s47, 0, s47
s_waitcnt vmcnt(27)
v_mfma_f32_16x16x32_bf16 a[0:3], v[40:43], v[24:27], a[0:3]
v_mfma_f32_16x16x32_bf16 a[4:7], v[40:43], v[28:31], a[4:7]
v_mfma_f32_16x16x32_bf16 a[8:11], v[40:43], v[32:35], a[8:11]
v_mfma_f32_16x16x32_bf16 a[12:15], v[40:43], v[36:39], a[12:15]
v_mfma_f32_16x16x32_bf16 a[16:19], v[44:47], v[24:27], a[16:19]
v_mfma_f32_16x16x32_bf16 a[20:23], v[44:47], v[28:31], a[20:23]
v_mfma_f32_16x16x32_bf16 a[24:27], v[44:47], v[32:35], a[24:27]
v_mfma_f32_16x16x32_bf16 a[28:31], v[44:47], v[36:39], a[28:31]
v_mfma_f32_16x16x32_bf16 a[32:35], v[48:51], v[24:27], a[32:35]
v_mfma_f32_16x16x32_bf16 a[36:39], v[48:51], v[28:31], a[36:39]
v_mfma_f32_16x16x32_bf16 a[40:43], v[48:51], v[32:35], a[40:43]
v_mfma_f32_16x16x32_bf16 a[44:47], v[48:51], v[36:39], a[44:47]
v_mfma_f32_16x16x32_bf16 a[48:51], v[52:55], v[24:27], a[48:51]
v_mfma_f32_16x16x32_bf16 a[52:55], v[52:55], v[28:31], a[52:55]
v_mfma_f32_16x16x32_bf16 a[56:59], v[52:55], v[32:35], a[56:59]
v_mfma_f32_16x16x32_bf16 a[60:63], v[52:55], v[36:39], a[60:63]
v_mfma_f32_16x16x32_bf16 a[64:67], v[56:59], v[24:27], a[64:67]
v_mfma_f32_16x16x32_bf16 a[68:71], v[56:59], v[28:31], a[68:71]
v_mfma_f32_16x16x32_bf16 a[72:75], v[56:59], v[32:35], a[72:75]
v_mfma_f32_16x16x32_bf16 a[76:79], v[56:59], v[36:39], a[76:79]
s_lshl_b32 s22, s47, 11
s_mul_i32 s23, s47, 40960
v_add_u32 v21, s22, v5
v_add_u32 v22, s23, v6
v_add_u32 v23, 0x1000, v22
buffer_load_dwordx4 v[24:27], v21, s[24:27], s16 offen
buffer_load_dwordx4 v[40:43], v22, s[28:31], s20 offen
buffer_load_dwordx4 v[28:31], v21, s[24:27], s17 offen
buffer_load_dwordx4 v[44:47], v22, s[28:31], s20 offen offset:1024
buffer_load_dwordx4 v[32:35], v21, s[24:27], s18 offen
buffer_load_dwordx4 v[48:51], v22, s[28:31], s20 offen offset:2048
buffer_load_dwordx4 v[36:39], v21, s[24:27], s19 offen
buffer_load_dwordx4 v[52:55], v22, s[28:31], s20 offen offset:3072
buffer_load_dwordx4 v[56:59], v23, s[28:31], s20 offen
s_add_u32 s47, s47, 1
s_cmp_ge_u32 s47, s45
s_cselect_b32 s47, 0, s47
s_waitcnt vmcnt(27)
v_mfma_f32_16x16x32_bf16 a[0:3], v[76:79], v[60:63], a[0:3]
v_mfma_f32_16x16x32_bf16 a[4:7], v[76:79], v[64:67], a[4:7]
v_mfma_f32_16x16x32_bf16 a[8:11], v[76:79], v[68:71], a[8:11]
v_mfma_f32_16x16x32_bf16 a[12:15], v[76:79], v[72:75], a[12:15]
v_mfma_f32_16x16x32_bf16 a[16:19], v[80:83], v[60:63], a[16:19]
v_mfma_f32_16x16x32_bf16 a[20:23], v[80:83], v[64:67], a[20:23]
v_mfma_f32_16x16x32_bf16 a[24:27], v[80:83], v[68:71], a[24:27]
v_mfma_f32_16x16x32_bf16 a[28:31], v[80:83], v[72:75], a[28:31]
v_mfma_f32_16x16x32_bf16 a[32:35], v[84:87], v[60:63], a[32:35]
v_mfma_f32_16x16x32_bf16 a[36:39], v[84:87], v[64:67], a[36:39]
v_mfma_f32_16x16x32_bf16 a[40:43], v[84:87], v[68:71], a[40:43]
v_mfma_f32_16x16x32_bf16 a[44:47], v[84:87], v[72:75], a[44:47]
v_mfma_f32_16x16x32_bf16 a[48:51], v[88:91], v[60:63], a[48:51]
v_mfma_f32_16x16x32_bf16 a[52:55], v[88:91], v[64:67], a[52:55]
v_mfma_f32_16x16x32_bf16 a[56:59], v[88:91], v[68:71], a[56:59]
v_mfma_f32_16x16x32_bf16 a[60:63], v[88:91], v[72:75], a[60:63]
v_mfma_f32_16x16x32_bf16 a[64:67], v[92:95], v[60:63], a[64:67]
v_mfma_f32_16x16x32_bf16 a[68:71], v[92:95], v[64:67], a[68:71]
v_mfma_f32_16x16x32_bf16 a[72:75], v[92:95], v[68:71], a[72:75]
v_mfma_f32_16x16x32_bf16 a[76:79], v[92:95], v[72:75], a[76:79]
s_lshl_b32 s22, s47, 11
s_mul_i32 s23, s47, 40960
v_add_u32 v21, s22, v5
v_add_u32 v22, s23, v6
v_add_u32 v23, 0x1000, v22
buffer_load_dwordx4 v[60:63], v21, s[24:27], s16 offen
buffer_load_dwordx4 v[76:79], v22, s[28:31], s20 offen
buffer_load_dwordx4 v[64:67], v21, s[24:27], s17 offen
buffer_load_dwordx4 v[80:83], v22, s[28:31], s20 offen offset:1024
buffer_load_dwordx4 v[68:71], v21, s[24:27], s18 offen
buffer_load_dwordx4 v[84:87], v22, s[28:31], s20 offen offset:2048
buffer_load_dwordx4 v[72:75], v21, s[24:27], s19 offen
buffer_load_dwordx4 v[88:91], v22, s[28:31], s20 offen offset:3072
buffer_load_dwordx4 v[92:95], v23, s[28:31], s20 offen
s_add_u32 s47, s47, 1
s_cmp_ge_u32 s47, s45
s_cselect_b32 s47, 0, s47
s_waitcnt vmcnt(27)
v_mfma_f32_16x16x32_bf16 a[0:3], v[112:115], v[96:99], a[0:3]
v_mfma_f32_16x16x32_bf16 a[4:7], v[112:115], v[100:103], a[4:7]
v_mfma_f32_16x16x32_bf16 a[8:11], v[112:115], v[104:107], a[8:11]
v_mfma_f32_16x16x32_bf16 a[12:15], v[112:115], v[108:111], a[12:15]
v_mfma_f32_16x16x32_bf16 a[16:19], v[116:119], v[96:99], a[16:19]
v_mfma_f32_16x16x32_bf16 a[20:23], v[116:119], v[100:103], a[20:23]
v_mfma_f32_16x16x32_bf16 a[24:27], v[116:119], v[104:107], a[24:27]
v_mfma_f32_16x16x32_bf16 a[28:31], v[116:119], v[108:111], a[28:31]
v_mfma_f32_16x16x32_bf16 a[32:35], v[120:123], v[96:99], a[32:35]
v_mfma_f32_16x16x32_bf16 a[36:39], v[120:123], v[100:103], a[36:39]
v_mfma_f32_16x16x32_bf16 a[40:43], v[120:123], v[104:107], a[40:43]
v_mfma_f32_16x16x32_bf16 a[44:47], v[120:123], v[108:111], a[44:47]
v_mfma_f32_16x16x32_bf16 a[48:51], v[124:127], v[96:99], a[48:51]
v_mfma_f32_16x16x32_bf16 a[52:55], v[124:127], v[100:103], a[52:55]
v_mfma_f32_16x16x32_bf16 a[56:59], v[124:127], v[104:107], a[56:59]
v_mfma_f32_16x16x32_bf16 a[60:63], v[124:127], v[108:111], a[60:63]
v_mfma_f32_16x16x32_bf16 a[64:67], v[128:131], v[96:99], a[64:67]
v_mfma_f32_16x16x32_bf16 a[68:71], v[128:131], v[100:103], a[68:71]
v_mfma_f32_16x16x32_bf16 a[72:75], v[128:131], v[104:107], a[72:75]
v_mfma_f32_16x16x32_bf16 a[76:79], v[128:131], v[108:111], a[76:79]
s_lshl_b32 s22, s47, 11
s_mul_i32 s23, s47, 40960
v_add_u32 v21, s22, v5
v_add_u32 v22, s23, v6
v_add_u32 v23, 0x1000, v22
buffer_load_dwordx4 v[96:99], v21, s[24:27], s16 offen
buffer_load_dwordx4 v[112:115], v22, s[28:31], s20 offen
buffer_load_dwordx4 v[100:103], v21, s[24:27], s17 offen
buffer_load_dwordx4 v[116:119], v22, s[28:31], s20 offen offset:1024
buffer_load_dwordx4 v[104:107], v21, s[24:27], s18 offen
buffer_load_dwordx4 v[120:123], v22, s[28:31], s20 offen offset:2048
buffer_load_dwordx4 v[108:111], v21, s[24:27], s19 offen
buffer_load_dwordx4 v[124:127], v22, s[28:31], s20 offen offset:3072
buffer_load_dwordx4 v[128:131], v23, s[28:31], s20 offen
s_add_u32 s47, s47, 1
s_cmp_ge_u32 s47, s45
s_cselect_b32 s47, 0, s47
s_waitcnt vmcnt(27)
v_mfma_f32_16x16x32_bf16 a[0:3], v[148:151], v[132:135], a[0:3]
v_mfma_f32_16x16x32_bf16 a[4:7], v[148:151], v[136:139], a[4:7]
v_mfma_f32_16x16x32_bf16 a[8:11], v[148:151], v[140:143], a[8:11]
v_mfma_f32_16x16x32_bf16 a[12:15], v[148:151], v[144:147], a[12:15]
v_mfma_f32_16x16x32_bf16 a[16:19], v[152:155], v[132:135], a[16:19]
v_mfma_f32_16x16x32_bf16 a[20:23], v[152:155], v[136:139], a[20:23]
v_mfma_f32_16x16x32_bf16 a[24:27], v[152:155], v[140:143], a[24:27]
v_mfma_f32_16x16x32_bf16 a[28:31], v[152:155], v[144:147], a[28:31]
v_mfma_f32_16x16x32_bf16 a[32:35], v[156:159], v[132:135], a[32:35]
v_mfma_f32_16x16x32_bf16 a[36:39], v[156:159], v[136:139], a[36:39]
v_mfma_f32_16x16x32_bf16 a[40:43], v[156:159], v[140:143], a[40:43]
v_mfma_f32_16x16x32_bf16 a[44:47], v[156:159], v[144:147], a[44:47]
v_mfma_f32_16x16x32_bf16 a[48:51], v[160:163], v[132:135], a[48:51]
v_mfma_f32_16x16x32_bf16 a[52:55], v[160:163], v[136:139], a[52:55]
v_mfma_f32_16x16x32_bf16 a[56:59], v[160:163], v[140:143], a[56:59]
v_mfma_f32_16x16x32_bf16 a[60:63], v[160:163], v[144:147], a[60:63]
v_mfma_f32_16x16x32_bf16 a[64:67], v[164:167], v[132:135], a[64:67]
v_mfma_f32_16x16x32_bf16 a[68:71], v[164:167], v[136:139], a[68:71]
v_mfma_f32_16x16x32_bf16 a[72:75], v[164:167], v[140:143], a[72:75]
v_mfma_f32_16x16x32_bf16 a[76:79], v[164:167], v[144:147], a[76:79]
s_lshl_b32 s22, s47, 11
s_mul_i32 s23, s47, 40960
v_add_u32 v21, s22, v5
v_add_u32 v22, s23, v6
v_add_u32 v23, 0x1000, v22
buffer_load_dwordx4 v[132:135], v21, s[24:27], s16 offen
buffer_load_dwordx4 v[148:151], v22, s[28:31], s20 offen
buffer_load_dwordx4 v[136:139], v21, s[24:27], s17 offen
buffer_load_dwordx4 v[152:155], v22, s[28:31], s20 offen offset:1024
buffer_load_dwordx4 v[140:143], v21, s[24:27], s18 offen
buffer_load_dwordx4 v[156:159], v22, s[28:31], s20 offen offset:2048
buffer_load_dwordx4 v[144:147], v21, s[24:27], s19 offen
buffer_load_dwordx4 v[160:163], v22, s[28:31], s20 offen offset:3072
buffer_load_dwordx4 v[164:167], v23, s[28:31], s20 offen
s_add_u32 s47, s47, 1
s_cmp_ge_u32 s47, s45
s_cselect_b32 s47, 0, s47
s_waitcnt vmcnt(27)
v_mfma_f32_16x16x32_bf16 a[0:3], v[40:43], v[24:27], a[0:3]
v_mfma_f32_16x16x32_bf16 a[4:7], v[40:43], v[28:31], a[4:7]
v_mfma_f32_16x16x32_bf16 a[8:11], v[40:43], v[32:35], a[8:11]
v_mfma_f32_16x16x32_bf16 a[12:15], v[40:43], v[36:39], a[12:15]
v_mfma_f32_16x16x32_bf16 a[16:19], v[44:47], v[24:27], a[16:19]
v_mfma_f32_16x16x32_bf16 a[20:23], v[44:47], v[28:31], a[20:23]
v_mfma_f32_16x16x32_bf16 a[24:27], v[44:47], v[32:35], a[24:27]
v_mfma_f32_16x16x32_bf16 a[28:31], v[44:47], v[36:39], a[28:31]
v_mfma_f32_16x16x32_bf16 a[32:35], v[48:51], v[24:27], a[32:35]
v_mfma_f32_16x16x32_bf16 a[36:39], v[48:51], v[28:31], a[36:39]
v_mfma_f32_16x16x32_bf16 a[40:43], v[48:51], v[32:35], a[40:43]
v_mfma_f32_16x16x32_bf16 a[44:47], v[48:51], v[36:39], a[44:47]
v_mfma_f32_16x16x32_bf16 a[48:51], v[52:55], v[24:27], a[48:51]
v_mfma_f32_16x16x32_bf16 a[52:55], v[52:55], v[28:31], a[52:55]
v_mfma_f32_16x16x32_bf16 a[56:59], v[52:55], v[32:35], a[56:59]
v_mfma_f32_16x16x32_bf16 a[60:63], v[52:55], v[36:39], a[60:63]
v_mfma_f32_16x16x32_bf16 a[64:67], v[56:59], v[24:27], a[64:67]
v_mfma_f32_16x16x32_bf16 a[68:71], v[56:59], v[28:31], a[68:71]
v_mfma_f32_16x16x32_bf16 a[72:75], v[56:59], v[32:35], a[72:75]
v_mfma_f32_16x16x32_bf16 a[76:79], v[56:59], v[36:39], a[76:79]
s_lshl_b32 s22, s47, 11
s_mul_i32 s23, s47, 40960
v_add_u32 v21, s22, v5
v_add_u32 v22, s23, v6
v_add_u32 v23, 0x1000, v22
buffer_load_dwordx4 v[24:27], v21, s[24:27], s16 offen
buffer_load_dwordx4 v[40:43], v22, s[28:31], s20 offen
buffer_load_dwordx4 v[28:31], v21, s[24:27], s17 offen
buffer_load_dwordx4 v[44:47], v22, s[28:31], s20 offen offset:1024
buffer_load_dwordx4 v[32:35], v21, s[24:27], s18 offen
buffer_load_dwordx4 v[48:51], v22, s[28:31], s20 offen offset:2048
buffer_load_dwordx4 v[36:39], v21, s[24:27], s19 offen
buffer_load_dwordx4 v[52:55], v22, s[28:31], s20 offen offset:3072
buffer_load_dwordx4 v[56:59], v23, s[28:31], s20 offen
s_add_u32 s47, s47, 1
s_cmp_ge_u32 s47, s45
s_cselect_b32 s47, 0, s47
s_waitcnt vmcnt(27)
v_mfma_f32_16x16x32_bf16 a[0:3], v[76:79], v[60:63], a[0:3]
v_mfma_f32_16x16x32_bf16 a[4:7], v[76:79], v[64:67], a[4:7]
v_mfma_f32_16x16x32_bf16 a[8:11], v[76:79], v[68:71], a[8:11]
v_mfma_f32_16x16x32_bf16 a[12:15], v[76:79], v[72:75], a[12:15]
v_mfma_f32_16x16x32_bf16 a[16:19], v[80:83], v[60:63], a[16:19]
v_mfma_f32_16x16x32_bf16 a[20:23], v[80:83], v[64:67], a[20:23]
v_mfma_f32_16x16x32_bf16 a[24:27], v[80:83], v[68:71], a[24:27]
v_mfma_f32_16x16x32_bf16 a[28:31], v[80:83], v[72:75], a[28:31]
v_mfma_f32_16x16x32_bf16 a[32:35], v[84:87], v[60:63], a[32:35]
v_mfma_f32_16x16x32_bf16 a[36:39], v[84:87], v[64:67], a[36:39]
v_mfma_f32_16x16x32_bf16 a[40:43], v[84:87], v[68:71], a[40:43]
v_mfma_f32_16x16x32_bf16 a[44:47], v[84:87], v[72:75], a[44:47]
v_mfma_f32_16x16x32_bf16 a[48:51], v[88:91], v[60:63], a[48:51]
v_mfma_f32_16x16x32_bf16 a[52:55], v[88:91], v[64:67], a[52:55]
v_mfma_f32_16x16x32_bf16 a[56:59], v[88:91], v[68:71], a[56:59]
v_mfma_f32_16x16x32_bf16 a[60:63], v[88:91], v[72:75], a[60:63]
v_mfma_f32_16x16x32_bf16 a[64:67], v[92:95], v[60:63], a[64:67]
v_mfma_f32_16x16x32_bf16 a[68:71], v[92:95], v[64:67], a[68:71]
v_mfma_f32_16x16x32_bf16 a[72:75], v[92:95], v[68:71], a[72:75]
v_mfma_f32_16x16x32_bf16 a[76:79], v[92:95], v[72:75], a[76:79]
s_lshl_b32 s22, s47, 11
s_mul_i32 s23, s47, 40960
s_cmp_lt_u32 s44, 2
s_cselect_b32 s22, s22, 0x7f000000
s_cselect_b32 s23, s23, 0x7f000000
v_add_u32 v21, s22, v5
v_add_u32 v22, s23, v6
v_add_u32 v23, 0x1000, v22
buffer_load_dwordx4 v[60:63], v21, s[24:27], s16 offen
buffer_load_dwordx4 v[76:79], v22, s[28:31], s20 offen
buffer_load_dwordx4 v[64:67], v21, s[24:27], s17 offen
buffer_load_dwordx4 v[80:83], v22, s[28:31], s20 offen offset:1024
buffer_load_dwordx4 v[68:71], v21, s[24:27], s18 offen
buffer_load_dwordx4 v[84:87], v22, s[28:31], s20 offen offset:2048
buffer_load_dwordx4 v[72:75], v21, s[24:27], s19 offen
buffer_load_dwordx4 v[88:91], v22, s[28:31], s20 offen offset:3072
buffer_load_dwordx4 v[92:95], v23, s[28:31], s20 offen
s_add_u32 s47, s47, 1
s_cmp_ge_u32 s47, s45
s_cselect_b32 s47, 0, s47
s_waitcnt vmcnt(27)
v_mfma_f32_16x16x32_bf16 a[0:3], v[112:115], v[96:99], a[0:3]
v_mfma_f32_16x16x32_bf16 a[4:7], v[112:115], v[100:103], a[4:7]
v_mfma_f32_16x16x32_bf16 a[8:11], v[112:115], v[104:107], a[8:11]
v_mfma_f32_16x16x32_bf16 a[12:15], v[112:115], v[108:111], a[12:15]
v_mfma_f32_16x16x32_bf16 a[16:19], v[116:119], v[96:99], a[16:19]
v_mfma_f32_16x16x32_bf16 a[20:23], v[116:119], v[100:103], a[20:23]
v_mfma_f32_16x16x32_bf16 a[24:27], v[116:119], v[104:107], a[24:27]
v_mfma_f32_16x16x32_bf16 a[28:31], v[116:119], v[108:111], a[28:31]
v_mfma_f32_16x16x32_bf16 a[32:35], v[120:123], v[96:99], a[32:35]
v_mfma_f32_16x16x32_bf16 a[36:39], v[120:123], v[100:103], a[36:39]
v_mfma_f32_16x16x32_bf16 a[40:43], v[120:123], v[104:107], a[40:43]
v_mfma_f32_16x16x32_bf16 a[44:47], v[120:123], v[108:111], a[44:47]
v_mfma_f32_16x16x32_bf16 a[48:51], v[124:127], v[96:99], a[48:51]
v_mfma_f32_16x16x32_bf16 a[52:55], v[124:127], v[100:103], a[52:55]
v_mfma_f32_16x16x32_bf16 a[56:59], v[124:127], v[104:107], a[56:59]
v_mfma_f32_16x16x32_bf16 a[60:63], v[124:127], v[108:111], a[60:63]
v_mfma_f32_16x16x32_bf16 a[64:67], v[128:131], v[96:99], a[64:67]
v_mfma_f32_16x16x32_bf16 a[68:71], v[128:131], v[100:103], a[68:71]
v_mfma_f32_16x16x32_bf16 a[72:75], v[128:131], v[104:107], a[72:75]
v_mfma_f32_16x16x32_bf16 a[76:79], v[128:131], v[108:111], a[76:79]
buffer_load_dwordx4 v[112:115], v6, s[28:31], s21 offen
buffer_load_dwordx4 v[116:119], v6, s[28:31], s21 offen offset:1024
buffer_load_dwordx4 v[120:123], v6, s[28:31], s21 offen offset:2048
buffer_load_dwordx4 v[124:127], v6, s[28:31], s21 offen offset:3072
buffer_load_dwordx4 v[128:131], v7, s[28:31], s21 offen
s_add_u32 s21, s21, 40960
s_waitcnt vmcnt(23)
v_mfma_f32_16x16x32_bf16 a[0:3], v[148:151], v[132:135], a[0:3]
v_mfma_f32_16x16x32_bf16 a[4:7], v[148:151], v[136:139], a[4:7]
v_mfma_f32_16x16x32_bf16 a[8:11], v[148:151], v[140:143], a[8:11]
v_mfma_f32_16x16x32_bf16 a[12:15], v[148:151], v[144:147], a[12:15]
v_mfma_f32_16x16x32_bf16 a[16:19], v[152:155], v[132:135], a[16:19]
v_mfma_f32_16x16x32_bf16 a[20:23], v[152:155], v[136:139], a[20:23]
v_mfma_f32_16x16x32_bf16 a[24:27], v[152:155], v[140:143], a[24:27]
v_mfma_f32_16x16x32_bf16 a[28:31], v[152:155], v[144:147], a[28:31]
v_mfma_f32_16x16x32_bf16 a[32:35], v[156:159], v[132:135], a[32:35]
v_mfma_f32_16x16x32_bf16 a[36:39], v[156:159], v[136:139], a[36:39]
v_mfma_f32_16x16x32_bf16 a[40:43], v[156:159], v[140:143], a[40:43]
v_mfma_f32_16x16x32_bf16 a[44:47], v[156:159], v[144:147], a[44:47]
v_mfma_f32_16x16x32_bf16 a[48:51], v[160:163], v[132:135], a[48:51]
v_mfma_f32_16x16x32_bf16 a[52:55], v[160:163], v[136:139], a[52:55]
v_mfma_f32_16x16x32_bf16 a[56:59], v[160:163], v[140:143], a[56:59]
v_mfma_f32_16x16x32_bf16 a[60:63], v[160:163], v[144:147], a[60:63]
v_mfma_f32_16x16x32_bf16 a[64:67], v[164:167], v[132:135], a[64:67]
v_mfma_f32_16x16x32_bf16 a[68:71], v[164:167], v[136:139], a[68:71]
v_mfma_f32_16x16x32_bf16 a[72:75], v[164:167], v[140:143], a[72:75]
v_mfma_f32_16x16x32_bf16 a[76:79], v[164:167], v[144:147], a[76:79]
buffer_load_dwordx4 v[148:151], v6, s[28:31], s21 offen
buffer_load_dwordx4 v[152:155], v6, s[28:31], s21 offen offset:1024
buffer_load_dwordx4 v[156:159], v6, s[28:31], s21 offen offset:2048
buffer_load_dwordx4 v[160:163], v6, s[28:31], s21 offen offset:3072
buffer_load_dwordx4 v[164:167], v7, s[28:31], s21 offen
s_add_u32 s21, s21, 40960
s_waitcnt vmcnt(19)
v_mfma_f32_16x16x32_bf16 a[0:3], v[40:43], v[24:27], a[0:3]
v_mfma_f32_16x16x32_bf16 a[4:7], v[40:43], v[28:31], a[4:7]
v_mfma_f32_16x16x32_bf16 a[8:11], v[40:43], v[32:35], a[8:11]
v_mfma_f32_16x16x32_bf16 a[12:15], v[40:43], v[36:39], a[12:15]
v_mfma_f32_16x16x32_bf16 a[16:19], v[44:47], v[24:27], a[16:19]
v_mfma_f32_16x16x32_bf16 a[20:23], v[44:47], v[28:31], a[20:23]
v_mfma_f32_16x16x32_bf16 a[24:27], v[44:47], v[32:35], a[24:27]
v_mfma_f32_16x16x32_bf16 a[28:31], v[44:47], v[36:39], a[28:31]
v_mfma_f32_16x16x32_bf16 a[32:35], v[48:51], v[24:27], a[32:35]
v_mfma_f32_16x16x32_bf16 a[36:39], v[48:51], v[28:31], a[36:39]
v_mfma_f32_16x16x32_bf16 a[40:43], v[48:51], v[32:35], a[40:43]
v_mfma_f32_16x16x32_bf16 a[44:47], v[48:51], v[36:39], a[44:47]
v_mfma_f32_16x16x32_bf16 a[48:51], v[52:55], v[24:27], a[48:51]
v_mfma_f32_16x16x32_bf16 a[52:55], v[52:55], v[28:31], a[52:55]
v_mfma_f32_16x16x32_bf16 a[56:59], v[52:55], v[32:35], a[56:59]
v_mfma_f32_16x16x32_bf16 a[60:63], v[52:55], v[36:39], a[60:63]
v_mfma_f32_16x16x32_bf16 a[64:67], v[56:59], v[24:27], a[64:67]
v_mfma_f32_16x16x32_bf16 a[68:71], v[56:59], v[28:31], a[68:71]
v_mfma_f32_16x16x32_bf16 a[72:75], v[56:59], v[32:35], a[72:75]
v_mfma_f32_16x16x32_bf16 a[76:79], v[56:59], v[36:39], a[76:79]
buffer_load_dwordx4 v[40:43], v6, s[28:31], s21 offen
buffer_load_dwordx4 v[44:47], v6, s[28:31], s21 offen offset:1024
buffer_load_dwordx4 v[48:51], v6, s[28:31], s21 offen offset:2048
buffer_load_dwordx4 v[52:55], v6, s[28:31], s21 offen offset:3072
buffer_load_dwordx4 v[56:59], v7, s[28:31], s21 offen
s_add_u32 s21, s21, 40960
s_waitcnt vmcnt(15)
v_mfma_f32_16x16x32_bf16 a[0:3], v[76:79], v[60:63], a[0:3]
v_mfma_f32_16x16x32_bf16 a[4:7], v[76:79], v[64:67], a[4:7]
v_mfma_f32_16x16x32_bf16 a[8:11], v[76:79], v[68:71], a[8:11]
v_mfma_f32_16x16x32_bf16 a[12:15], v[76:79], v[72:75], a[12:15]
v_mfma_f32_16x16x32_bf16 a[16:19], v[80:83], v[60:63], a[16:19]
v_mfma_f32_16x16x32_bf16 a[20:23], v[80:83], v[64:67], a[20:23]
v_mfma_f32_16x16x32_bf16 a[24:27], v[80:83], v[68:71], a[24:27]
v_mfma_f32_16x16x32_bf16 a[28:31], v[80:83], v[72:75], a[28:31]
v_mfma_f32_16x16x32_bf16 a[32:35], v[84:87], v[60:63], a[32:35]
v_mfma_f32_16x16x32_bf16 a[36:39], v[84:87], v[64:67], a[36:39]
v_mfma_f32_16x16x32_bf16 a[40:43], v[84:87], v[68:71], a[40:43]
v_mfma_f32_16x16x32_bf16 a[44:47], v[84:87], v[72:75], a[44:47]
v_mfma_f32_16x16x32_bf16 a[48:51], v[88:91], v[60:63], a[48:51]
v_mfma_f32_16x16x32_bf16 a[52:55], v[88:91], v[64:67], a[52:55]
v_mfma_f32_16x16x32_bf16 a[56:59], v[88:91], v[68:71], a[56:59]
v_mfma_f32_16x16x32_bf16 a[60:63], v[88:91], v[72:75], a[60:63]
v_mfma_f32_16x16x32_bf16 a[64:67], v[92:95], v[60:63], a[64:67]
v_mfma_f32_16x16x32_bf16 a[68:71], v[92:95], v[64:67], a[68:71]
v_mfma_f32_16x16x32_bf16 a[72:75], v[92:95], v[68:71], a[72:75]
v_mfma_f32_16x16x32_bf16 a[76:79], v[92:95], v[72:75], a[76:79]
buffer_load_dwordx4 v[76:79], v6, s[28:31], s21 offen
buffer_load_dwordx4 v[80:83], v6, s[28:31], s21 offen offset:1024
buffer_load_dwordx4 v[84:87], v6, s[28:31], s21 offen offset:2048
buffer_load_dwordx4 v[88:91], v6, s[28:31], s21 offen offset:3072
buffer_load_dwordx4 v[92:95], v7, s[28:31], s21 offen
s_add_u32 s21, s21, 40960
s_barrier
ds_read_b128 v[96:99], v20 offset:0
ds_read_b128 v[100:103], v20 offset:1024
ds_read_b128 v[104:107], v20 offset:2048
ds_read_b128 v[108:111], v20 offset:3072
s_waitcnt vmcnt(15)
s_waitcnt lgkmcnt(0)
v_mfma_f32_16x16x32_bf16 a[0:3], v[112:115], v[96:99], a[0:3]
v_mfma_f32_16x16x32_bf16 a[4:7], v[112:115], v[100:103], a[4:7]
v_mfma_f32_16x16x32_bf16 a[8:11], v[112:115], v[104:107], a[8:11]
v_mfma_f32_16x16x32_bf16 a[12:15], v[112:115], v[108:111], a[12:15]
v_mfma_f32_16x16x32_bf16 a[16:19], v[116:119], v[96:99], a[16:19]
v_mfma_f32_16x16x32_bf16 a[20:23], v[116:119], v[100:103], a[20:23]
v_mfma_f32_16x16x32_bf16 a[24:27], v[116:119], v[104:107], a[24:27]
v_mfma_f32_16x16x32_bf16 a[28:31], v[116:119], v[108:111], a[28:31]
v_mfma_f32_16x16x32_bf16 a[32:35], v[120:123], v[96:99], a[32:35]
v_mfma_f32_16x16x32_bf16 a[36:39], v[120:123], v[100:103], a[36:39]
v_mfma_f32_16x16x32_bf16 a[40:43], v[120:123], v[104:107], a[40:43]
v_mfma_f32_16x16x32_bf16 a[44:47], v[120:123], v[108:111], a[44:47]
v_mfma_f32_16x16x32_bf16 a[48:51], v[124:127], v[96:99], a[48:51]
v_mfma_f32_16x16x32_bf16 a[52:55], v[124:127], v[100:103], a[52:55]
v_mfma_f32_16x16x32_bf16 a[56:59], v[124:127], v[104:107], a[56:59]
v_mfma_f32_16x16x32_bf16 a[60:63], v[124:127], v[108:111], a[60:63]
v_mfma_f32_16x16x32_bf16 a[64:67], v[128:131], v[96:99], a[64:67]
v_mfma_f32_16x16x32_bf16 a[68:71], v[128:131], v[100:103], a[68:71]
v_mfma_f32_16x16x32_bf16 a[72:75], v[128:131], v[104:107], a[72:75]
v_mfma_f32_16x16x32_bf16 a[76:79], v[128:131], v[108:111], a[76:79]
buffer_load_dwordx4 v[112:115], v6, s[28:31], s21 offen
buffer_load_dwordx4 v[116:119], v6, s[28:31], s21 offen offset:1024
buffer_load_dwordx4 v[120:123], v6, s[28:31], s21 offen offset:2048
buffer_load_dwordx4 v[124:127], v6, s[28:31], s21 offen offset:3072
buffer_load_dwordx4 v[128:131], v7, s[28:31], s21 offen
s_add_u32 s21, s21, 40960
ds_read_b128 v[132:135], v20 offset:4096
ds_read_b128 v[136:139], v20 offset:5120
ds_read_b128 v[140:143], v20 offset:6144
ds_read_b128 v[144:147], v20 offset:7168
s_waitcnt vmcnt(15)
s_waitcnt lgkmcnt(0)
v_mfma_f32_16x16x32_bf16 a[0:3], v[148:151], v[132:135], a[0:3]
v_mfma_f32_16x16x32_bf16 a[4:7], v[148:151], v[136:139], a[4:7]
v_mfma_f32_16x16x32_bf16 a[8:11], v[148:151], v[140:143], a[8:11]
v_mfma_f32_16x16x32_bf16 a[12:15], v[148:151], v[144:147], a[12:15]
v_mfma_f32_16x16x32_bf16 a[16:19], v[152:155], v[132:135], a[16:19]
v_mfma_f32_16x16x32_bf16 a[20:23], v[152:155], v[136:139], a[20:23]
v_mfma_f32_16x16x32_bf16 a[24:27], v[152:155], v[140:143], a[24:27]
v_mfma_f32_16x16x32_bf16 a[28:31], v[152:155], v[144:147], a[28:31]
v_mfma_f32_16x16x32_bf16 a[32:35], v[156:159], v[132:135], a[32:35]
v_mfma_f32_16x16x32_bf16 a[36:39], v[156:159], v[136:139], a[36:39]
v_mfma_f32_16x16x32_bf16 a[40:43], v[156:159], v[140:143], a[40:43]
v_mfma_f32_16x16x32_bf16 a[44:47], v[156:159], v[144:147], a[44:47]
v_mfma_f32_16x16x32_bf16 a[48:51], v[160:163], v[132:135], a[48:51]
v_mfma_f32_16x16x32_bf16 a[52:55], v[160:163], v[136:139], a[52:55]
v_mfma_f32_16x16x32_bf16 a[56:59], v[160:163], v[140:143], a[56:59]
v_mfma_f32_16x16x32_bf16 a[60:63], v[160:163], v[144:147], a[60:63]
v_mfma_f32_16x16x32_bf16 a[64:67], v[164:167], v[132:135], a[64:67]
v_mfma_f32_16x16x32_bf16 a[68:71], v[164:167], v[136:139], a[68:71]
v_mfma_f32_16x16x32_bf16 a[72:75], v[164:167], v[140:143], a[72:75]
v_mfma_f32_16x16x32_bf16 a[76:79], v[164:167], v[144:147], a[76:79]
ds_read_b128 v[24:27], v20 offset:8192
ds_read_b128 v[28:31], v20 offset:9216
ds_read_b128 v[32:35], v20 offset:10240
ds_read_b128 v[36:39], v20 offset:11264
s_waitcnt vmcnt(10)
s_waitcnt lgkmcnt(0)
v_mfma_f32_16x16x32_bf16 a[0:3], v[40:43], v[24:27], a[0:3]
v_mfma_f32_16x16x32_bf16 a[4:7], v[40:43], v[28:31], a[4:7]
v_mfma_f32_16x16x32_bf16 a[8:11], v[40:43], v[32:35], a[8:11]
v_mfma_f32_16x16x32_bf16 a[12:15], v[40:43], v[36:39], a[12:15]
v_mfma_f32_16x16x32_bf16 a[16:19], v[44:47], v[24:27], a[16:19]
v_mfma_f32_16x16x32_bf16 a[20:23], v[44:47], v[28:31], a[20:23]
v_mfma_f32_16x16x32_bf16 a[24:27], v[44:47], v[32:35], a[24:27]
v_mfma_f32_16x16x32_bf16 a[28:31], v[44:47], v[36:39], a[28:31]
v_mfma_f32_16x16x32_bf16 a[32:35], v[48:51], v[24:27], a[32:35]
v_mfma_f32_16x16x32_bf16 a[36:39], v[48:51], v[28:31], a[36:39]
v_mfma_f32_16x16x32_bf16 a[40:43], v[48:51], v[32:35], a[40:43]
v_mfma_f32_16x16x32_bf16 a[44:47], v[48:51], v[36:39], a[44:47]
v_mfma_f32_16x16x32_bf16 a[48:51], v[52:55], v[24:27], a[48:51]
v_mfma_f32_16x16x32_bf16 a[52:55], v[52:55], v[28:31], a[52:55]
v_mfma_f32_16x16x32_bf16 a[56:59], v[52:55], v[32:35], a[56:59]
v_mfma_f32_16x16x32_bf16 a[60:63], v[52:55], v[36:39], a[60:63]
v_mfma_f32_16x16x32_bf16 a[64:67], v[56:59], v[24:27], a[64:67]
v_mfma_f32_16x16x32_bf16 a[68:71], v[56:59], v[28:31], a[68:71]
v_mfma_f32_16x16x32_bf16 a[72:75], v[56:59], v[32:35], a[72:75]
v_mfma_f32_16x16x32_bf16 a[76:79], v[56:59], v[36:39], a[76:79]
ds_read_b128 v[60:63], v20 offset:12288
ds_read_b128 v[64:67], v20 offset:13312
ds_read_b128 v[68:71], v20 offset:14336
ds_read_b128 v[72:75], v20 offset:15360
s_waitcnt vmcnt(5)
s_waitcnt lgkmcnt(0)
v_mfma_f32_16x16x32_bf16 a[0:3], v[76:79], v[60:63], a[0:3]
v_mfma_f32_16x16x32_bf16 a[4:7], v[76:79], v[64:67], a[4:7]
v_mfma_f32_16x16x32_bf16 a[8:11], v[76:79], v[68:71], a[8:11]
v_mfma_f32_16x16x32_bf16 a[12:15], v[76:79], v[72:75], a[12:15]
v_mfma_f32_16x16x32_bf16 a[16:19], v[80:83], v[60:63], a[16:19]
v_mfma_f32_16x16x32_bf16 a[20:23], v[80:83], v[64:67], a[20:23]
v_mfma_f32_16x16x32_bf16 a[24:27], v[80:83], v[68:71], a[24:27]
v_mfma_f32_16x16x32_bf16 a[28:31], v[80:83], v[72:75], a[28:31]
v_mfma_f32_16x16x32_bf16 a[32:35], v[84:87], v[60:63], a[32:35]
v_mfma_f32_16x16x32_bf16 a[36:39], v[84:87], v[64:67], a[36:39]
v_mfma_f32_16x16x32_bf16 a[40:43], v[84:87], v[68:71], a[40:43]
v_mfma_f32_16x16x32_bf16 a[44:47], v[84:87], v[72:75], a[44:47]
v_mfma_f32_16x16x32_bf16 a[48:51], v[88:91], v[60:63], a[48:51]
v_mfma_f32_16x16x32_bf16 a[52:55], v[88:91], v[64:67], a[52:55]
v_mfma_f32_16x16x32_bf16 a[56:59], v[88:91], v[68:71], a[56:59]
v_mfma_f32_16x16x32_bf16 a[60:63], v[88:91], v[72:75], a[60:63]
v_mfma_f32_16x16x32_bf16 a[64:67], v[92:95], v[60:63], a[64:67]
v_mfma_f32_16x16x32_bf16 a[68:71], v[92:95], v[64:67], a[68:71]
v_mfma_f32_16x16x32_bf16 a[72:75], v[92:95], v[68:71], a[72:75]
v_mfma_f32_16x16x32_bf16 a[76:79], v[92:95], v[72:75], a[76:79]
ds_read_b128 v[96:99], v20 offset:16384
ds_read_b128 v[100:103], v20 offset:17408
ds_read_b128 v[104:107], v20 offset:18432
ds_read_b128 v[108:111], v20 offset:19456
s_waitcnt vmcnt(0)
s_waitcnt lgkmcnt(0)
v_mfma_f32_16x16x32_bf16 a[0:3], v[112:115], v[96:99], a[0:3]
v_mfma_f32_16x16x32_bf16 a[4:7], v[112:115], v[100:103], a[4:7]
v_mfma_f32_16x16x32_bf16 a[8:11], v[112:115], v[104:107], a[8:11]
v_mfma_f32_16x16x32_bf16 a[12:15], v[112:115], v[108:111], a[12:15]
v_mfma_f32_16x16x32_bf16 a[16:19], v[116:119], v[96:99], a[16:19]
v_mfma_f32_16x16x32_bf16 a[20:23], v[116:119], v[100:103], a[20:23]
v_mfma_f32_16x16x32_bf16 a[24:27], v[116:119], v[104:107], a[24:27]
v_mfma_f32_16x16x32_bf16 a[28:31], v[116:119], v[108:111], a[28:31]
v_mfma_f32_16x16x32_bf16 a[32:35], v[120:123], v[96:99], a[32:35]
v_mfma_f32_16x16x32_bf16 a[36:39], v[120:123], v[100:103], a[36:39]
v_mfma_f32_16x16x32_bf16 a[40:43], v[120:123], v[104:107], a[40:43]
v_mfma_f32_16x16x32_bf16 a[44:47], v[120:123], v[108:111], a[44:47]
v_mfma_f32_16x16x32_bf16 a[48:51], v[124:127], v[96:99], a[48:51]
v_mfma_f32_16x16x32_bf16 a[52:55], v[124:127], v[100:103], a[52:55]
v_mfma_f32_16x16x32_bf16 a[56:59], v[124:127], v[104:107], a[56:59]
v_mfma_f32_16x16x32_bf16 a[60:63], v[124:127], v[108:111], a[60:63]
v_mfma_f32_16x16x32_bf16 a[64:67], v[128:131], v[96:99], a[64:67]
v_mfma_f32_16x16x32_bf16 a[68:71], v[128:131], v[100:103], a[68:71]
v_mfma_f32_16x16x32_bf16 a[72:75], v[128:131], v[104:107], a[72:75]
v_mfma_f32_16x16x32_bf16 a[76:79], v[128:131], v[108:111], a[76:79]
s_nop 5
s_barrier
s_add_u32 s15, s44, 1
s_and_b32 s15, s15, 3
s_mul_i32 s15, s15, 15360
s_add_u32 s15, s15, 0
v_add_u32 v169, s15, v6
ds_write_b128 v169, a[4:7] offset:0
ds_write_b128 v169, a[20:23] offset:1024
ds_write_b128 v169, a[36:39] offset:2048
ds_write_b128 v169, a[52:55] offset:3072
ds_write_b128 v169, a[68:71] offset:4096
s_add_u32 s15, s44, 2
s_and_b32 s15, s15, 3
s_mul_i32 s15, s15, 15360
s_add_u32 s15, s15, 5120
v_add_u32 v170, s15, v6
ds_write_b128 v170, a[8:11] offset:0
ds_write_b128 v170, a[24:27] offset:1024
ds_write_b128 v170, a[40:43] offset:2048
ds_write_b128 v170, a[56:59] offset:3072
ds_write_b128 v170, a[72:75] offset:4096
s_add_u32 s15, s44, 3
s_and_b32 s15, s15, 3
s_mul_i32 s15, s15, 15360
s_add_u32 s15, s15, 10240
v_add_u32 v171, s15, v6
ds_write_b128 v171, a[12:15] offset:0
ds_write_b128 v171, a[28:31] offset:1024
ds_write_b128 v171, a[44:47] offset:2048
ds_write_b128 v171, a[60:63] offset:3072
ds_write_b128 v171, a[76:79] offset:4096
v_accvgpr_read_b32 v84, a0
v_accvgpr_read_b32 v85, a1
v_accvgpr_read_b32 v86, a2
v_accvgpr_read_b32 v87, a3
v_accvgpr_read_b32 v88, a16
v_accvgpr_read_b32 v89, a17
v_accvgpr_read_b32 v90, a18
v_accvgpr_read_b32 v91, a19
v_accvgpr_read_b32 v92, a32
v_accvgpr_read_b32 v93, a33
v_accvgpr_read_b32 v94, a34
v_accvgpr_read_b32 v95, a35
v_accvgpr_read_b32 v96, a48
v_accvgpr_read_b32 v97, a49
v_accvgpr_read_b32 v98, a50
v_accvgpr_read_b32 v99, a51
v_accvgpr_read_b32 v100, a64
v_accvgpr_read_b32 v101, a65
v_accvgpr_read_b32 v102, a66
v_accvgpr_read_b32 v103, a67
s_mul_i32 s15, s44, 15360
v_add_u32 v168, s15, v6
s_waitcnt lgkmcnt(0)
s_barrier
ds_read_b128 v[24:27], v168 offset:0
ds_read_b128 v[28:31], v168 offset:1024
ds_read_b128 v[32:35], v168 offset:2048
ds_read_b128 v[36:39], v168 offset:3072
ds_read_b128 v[40:43], v168 offset:4096
ds_read_b128 v[44:47], v168 offset:5120
ds_read_b128 v[48:51], v168 offset:6144
ds_read_b128 v[52:55], v168 offset:7168
ds_read_b128 v[56:59], v168 offset:8192
ds_read_b128 v[60:63], v168 offset:9216
ds_read_b128 v[64:67], v168 offset:10240
ds_read_b128 v[68:71], v168 offset:11264
ds_read_b128 v[72:75], v168 offset:12288
ds_read_b128 v[76:79], v168 offset:13312
ds_read_b128 v[80:83], v168 offset:14336
v_lshlrev_b32 v104, 16, v10
v_and_b32 v105, 0xffff0000, v10
v_lshlrev_b32 v106, 16, v11
v_and_b32 v107, 0xffff0000, v11
v_add_f32 v84, v84, v104
v_add_f32 v85, v85, v105
v_add_f32 v86, v86, v106
v_add_f32 v87, v87, v107
v_lshlrev_b32 v104, 16, v12
v_and_b32 v105, 0xffff0000, v12
v_lshlrev_b32 v106, 16, v13
v_and_b32 v107, 0xffff0000, v13
v_add_f32 v88, v88, v104
v_add_f32 v89, v89, v105
v_add_f32 v90, v90, v106
v_add_f32 v91, v91, v107
v_lshlrev_b32 v104, 16, v14
v_and_b32 v105, 0xffff0000, v14
v_lshlrev_b32 v106, 16, v15
v_and_b32 v107, 0xffff0000, v15
v_add_f32 v92, v92, v104
v_add_f32 v93, v93, v105
v_add_f32 v94, v94, v106
v_add_f32 v95, v95, v107
v_lshlrev_b32 v104, 16, v16
v_and_b32 v105, 0xffff0000, v16
v_lshlrev_b32 v106, 16, v17
v_and_b32 v107, 0xffff0000, v17
v_add_f32 v96, v96, v104
v_add_f32 v97, v97, v105
v_add_f32 v98, v98, v106
v_add_f32 v99, v99, v107
v_lshlrev_b32 v104, 16, v18
v_and_b32 v105, 0xffff0000, v18
v_lshlrev_b32 v106, 16, v19
v_and_b32 v107, 0xffff0000, v19
v_add_f32 v100, v100, v104
v_add_f32 v101, v101, v105
v_add_f32 v102, v102, v106
v_add_f32 v103, v103, v107
s_waitcnt lgkmcnt(0)
v_add_f32 v24, v24, v44
v_add_f32 v64, v64, v84
v_add_f32 v25, v25, v45
v_add_f32 v65, v65, v85
v_add_f32 v26, v26, v46
v_add_f32 v66, v66, v86
v_add_f32 v27, v27, v47
v_add_f32 v67, v67, v87
v_add_f32 v24, v24, v64
v_add_f32 v25, v25, v65
v_add_f32 v26, v26, v66
v_add_f32 v27, v27, v67
v_cvt_pk_bf16_f32 v108, v24, v25
v_cvt_pk_bf16_f32 v109, v26, v27
buffer_store_dwordx2 v[108:109], v8, s[36:39], 0 offen offset:0
v_add_f32 v28, v28, v48
v_add_f32 v68, v68, v88
v_add_f32 v29, v29, v49
v_add_f32 v69, v69, v89
v_add_f32 v30, v30, v50
v_add_f32 v70, v70, v90
v_add_f32 v31, v31, v51
v_add_f32 v71, v71, v91
v_add_f32 v28, v28, v68
v_add_f32 v29, v29, v69
v_add_f32 v30, v30, v70
v_add_f32 v31, v31, v71
v_cvt_pk_bf16_f32 v110, v28, v29
v_cvt_pk_bf16_f32 v111, v30, v31
buffer_store_dwordx2 v[110:111], v8, s[36:39], 0 offen offset:32
v_add_f32 v32, v32, v52
v_add_f32 v72, v72, v92
v_add_f32 v33, v33, v53
v_add_f32 v73, v73, v93
v_add_f32 v34, v34, v54
v_add_f32 v74, v74, v94
v_add_f32 v35, v35, v55
v_add_f32 v75, v75, v95
v_add_f32 v32, v32, v72
v_add_f32 v33, v33, v73
v_add_f32 v34, v34, v74
v_add_f32 v35, v35, v75
v_cvt_pk_bf16_f32 v112, v32, v33
v_cvt_pk_bf16_f32 v113, v34, v35
buffer_store_dwordx2 v[112:113], v8, s[36:39], 0 offen offset:64
v_add_f32 v36, v36, v56
v_add_f32 v76, v76, v96
v_add_f32 v37, v37, v57
v_add_f32 v77, v77, v97
v_add_f32 v38, v38, v58
v_add_f32 v78, v78, v98
v_add_f32 v39, v39, v59
v_add_f32 v79, v79, v99
v_add_f32 v36, v36, v76
v_add_f32 v37, v37, v77
v_add_f32 v38, v38, v78
v_add_f32 v39, v39, v79
v_cvt_pk_bf16_f32 v114, v36, v37
v_cvt_pk_bf16_f32 v115, v38, v39
buffer_store_dwordx2 v[114:115], v8, s[36:39], 0 offen offset:96
v_add_f32 v40, v40, v60
v_add_f32 v80, v80, v100
v_add_f32 v41, v41, v61
v_add_f32 v81, v81, v101
v_add_f32 v42, v42, v62
v_add_f32 v82, v82, v102
v_add_f32 v43, v43, v63
v_add_f32 v83, v83, v103
v_add_f32 v40, v40, v80
v_add_f32 v41, v41, v81
v_add_f32 v42, v42, v82
v_add_f32 v43, v43, v83
v_cvt_pk_bf16_f32 v116, v40, v41
v_cvt_pk_bf16_f32 v117, v42, v43
buffer_store_dwordx2 v[116:117], v8, s[36:39], 0 offen offset:128
s_branch k2_kernel_end
k2_kernel_H:
s_setprio 1
v_cmp_le_u32 s[54:55], 1, v4
v_cmp_le_u32 s[60:61], 2, v4
v_cmp_le_u32 s[62:63], 3, v4
s_mul_i32 s53, s44, 14336
v_lshlrev_b32 v13, 2, v1
v_add_u32 v13, k2_kernel_tab - k2_kernel_pc, v13
buffer_load_dwordx4 v[24:27], v6, s[56:59], s53 offen offset:0
buffer_load_dword v80, v13, s[40:43], 0 offen offset:0
buffer_load_dwordx4 v[28:31], v6, s[56:59], s53 offen offset:1024
buffer_load_dword v81, v13, s[40:43], 0 offen offset:256
buffer_load_dwordx4 v[32:35], v6, s[56:59], s53 offen offset:2048
buffer_load_dword v82, v13, s[40:43], 0 offen offset:512
buffer_load_dwordx4 v[36:39], v6, s[56:59], s53 offen offset:3072
buffer_load_dword v83, v13, s[40:43], 0 offen offset:768
s_add_u32 s53, s53, 4096
buffer_load_dwordx4 v[40:43], v6, s[56:59], s53 offen offset:0
buffer_load_dword v84, v13, s[40:43], 0 offen offset:1024
buffer_load_dwordx4 v[44:47], v6, s[56:59], s53 offen offset:1024
buffer_load_dword v85, v13, s[40:43], 0 offen offset:1280
buffer_load_dwordx4 v[48:51], v6, s[56:59], s53 offen offset:2048
buffer_load_dword v86, v13, s[40:43], 0 offen offset:1536
buffer_load_dwordx4 v[52:55], v6, s[56:59], s53 offen offset:3072
buffer_load_dword v87, v13, s[40:43], 0 offen offset:1792
s_add_u32 s53, s53, 4096
buffer_load_dwordx4 v[56:59], v6, s[56:59], s53 offen offset:0
buffer_load_dword v88, v13, s[40:43], 0 offen offset:2048
buffer_load_dwordx4 v[60:63], v6, s[56:59], s53 offen offset:1024
buffer_load_dword v89, v13, s[40:43], 0 offen offset:2304
buffer_load_dwordx4 v[64:67], v6, s[56:59], s53 offen offset:2048
buffer_load_dword v90, v13, s[40:43], 0 offen offset:2560
buffer_load_dwordx4 v[68:71], v6, s[56:59], s53 offen offset:3072
buffer_load_dword v91, v13, s[40:43], 0 offen offset:2816
s_add_u32 s53, s53, 4096
buffer_load_dwordx4 v[72:75], v6, s[56:59], s53 offen offset:0
buffer_load_dword v92, v13, s[40:43], 0 offen offset:3072
buffer_load_dwordx4 v[76:79], v6, s[56:59], s53 offen offset:1024
buffer_load_dword v93, v13, s[40:43], 0 offen offset:3328
buffer_load_dwordx4 a[0:3], v5, s[24:27], s48 offen offset:0
buffer_load_dwordx4 a[4:7], v5, s[24:27], s49 offen offset:0
buffer_load_dwordx4 a[8:11], v5, s[24:27], s50 offen offset:0
buffer_load_dwordx4 a[12:15], v5, s[24:27], s51 offen offset:0
buffer_load_dwordx4 a[16:19], v5, s[24:27], s48 offen offset:2048
buffer_load_dwordx4 a[20:23], v5, s[24:27], s49 offen offset:2048
buffer_load_dwordx4 a[24:27], v5, s[24:27], s50 offen offset:2048
buffer_load_dwordx4 a[28:31], v5, s[24:27], s51 offen offset:2048
s_add_u32 s48, s48, 4096
s_add_u32 s49, s49, 4096
s_add_u32 s50, s50, 4096
s_add_u32 s51, s51, 4096
buffer_load_dwordx4 a[32:35], v5, s[24:27], s48 offen offset:0
buffer_load_dwordx4 a[36:39], v5, s[24:27], s49 offen offset:0
buffer_load_dwordx4 a[40:43], v5, s[24:27], s50 offen offset:0
buffer_load_dwordx4 a[44:47], v5, s[24:27], s51 offen offset:0
buffer_load_dwordx4 a[48:51], v5, s[24:27], s48 offen offset:2048
buffer_load_dwordx4 a[52:55], v5, s[24:27], s49 offen offset:2048
buffer_load_dwordx4 a[56:59], v5, s[24:27], s50 offen offset:2048
buffer_load_dwordx4 a[60:63], v5, s[24:27], s51 offen offset:2048
s_add_u32 s48, s48, 4096
s_add_u32 s49, s49, 4096
s_add_u32 s50, s50, 4096
s_add_u32 s51, s51, 4096
buffer_load_dwordx4 a[64:67], v5, s[24:27], s48 offen offset:0
buffer_load_dwordx4 a[68:71], v5, s[24:27], s49 offen offset:0
buffer_load_dwordx4 a[72:75], v5, s[24:27], s50 offen offset:0
buffer_load_dwordx4 a[76:79], v5, s[24:27], s51 offen offset:0
v_mov_b32 v16, 0
v_mov_b32 v17, 0
v_mov_b32 v18, 0
v_mov_b32 v19, 0
v_add_u32 v14, s52, v6
ds_write_b128 v14, v[16:19] offset:0
ds_write_b128 v14, v[16:19] offset:1024
ds_write_b128 v14, v[16:19] offset:2048
ds_write_b128 v14, v[16:19] offset:3072
ds_write_b128 v14, v[16:19] offset:4096
ds_write_b128 v14, v[16:19] offset:5120
ds_write_b128 v14, v[16:19] offset:6144
ds_write_b128 v14, v[16:19] offset:7168
ds_write_b128 v14, v[16:19] offset:8192
ds_write_b128 v14, v[16:19] offset:9216
ds_write_b128 v14, v[16:19] offset:10240
ds_write_b128 v14, v[16:19] offset:11264
ds_write_b128 v14, v[16:19] offset:12288
ds_write_b128 v14, v[16:19] offset:13312
ds_write_b128 v14, v[16:19] offset:14336
ds_write_b128 v14, v[16:19] offset:15360
ds_write_b128 v14, v[16:19] offset:16384
ds_write_b128 v14, v[16:19] offset:17408
ds_write_b128 v14, v[16:19] offset:18432
s_mov_b32 exec_hi, 0
ds_write_b128 v14, v[16:19] offset:19456
s_mov_b32 exec_hi, -1
v_and_b32 v15, 3, v1
v_lshlrev_b32 v15, 6, v15
v_lshl_add_u32 v15, v4, 4, v15
v_add_u32 v15, s52, v15
s_waitcnt vmcnt(20)
v_cvt_pk_bf16_f32 v24, v24, v25
v_cvt_pk_bf16_f32 v25, v26, v27
v_cmp_ne_u32 vcc, -1, v80
v_add_u32 v80, s52, v80
s_and_saveexec_b64 s[22:23], vcc
ds_write_b64 v80, v[24:25]
s_mov_b64 exec, s[22:23]
v_cvt_pk_bf16_f32 v28, v28, v29
v_cvt_pk_bf16_f32 v29, v30, v31
v_cmp_ne_u32 vcc, -1, v81
v_add_u32 v81, s52, v81
s_and_saveexec_b64 s[22:23], vcc
ds_write_b64 v81, v[28:29]
s_mov_b64 exec, s[22:23]
v_cvt_pk_bf16_f32 v32, v32, v33
v_cvt_pk_bf16_f32 v33, v34, v35
v_cmp_ne_u32 vcc, -1, v82
v_add_u32 v82, s52, v82
s_and_saveexec_b64 s[22:23], vcc
ds_write_b64 v82, v[32:33]
s_mov_b64 exec, s[22:23]
v_cvt_pk_bf16_f32 v36, v36, v37
v_cvt_pk_bf16_f32 v37, v38, v39
v_cmp_ne_u32 vcc, -1, v83
v_add_u32 v83, s52, v83
s_and_saveexec_b64 s[22:23], vcc
ds_write_b64 v83, v[36:37]
s_mov_b64 exec, s[22:23]
v_cvt_pk_bf16_f32 v40, v40, v41
v_cvt_pk_bf16_f32 v41, v42, v43
v_cmp_ne_u32 vcc, -1, v84
v_add_u32 v84, s52, v84
s_and_saveexec_b64 s[22:23], vcc
ds_write_b64 v84, v[40:41]
s_mov_b64 exec, s[22:23]
v_cvt_pk_bf16_f32 v44, v44, v45
v_cvt_pk_bf16_f32 v45, v46, v47
v_cmp_ne_u32 vcc, -1, v85
v_add_u32 v85, s52, v85
s_and_saveexec_b64 s[22:23], vcc
ds_write_b64 v85, v[44:45]
s_mov_b64 exec, s[22:23]
v_cvt_pk_bf16_f32 v48, v48, v49
v_cvt_pk_bf16_f32 v49, v50, v51
v_cmp_ne_u32 vcc, -1, v86
v_add_u32 v86, s52, v86
s_and_saveexec_b64 s[22:23], vcc
ds_write_b64 v86, v[48:49]
s_mov_b64 exec, s[22:23]
v_cvt_pk_bf16_f32 v52, v52, v53
v_cvt_pk_bf16_f32 v53, v54, v55
v_cmp_ne_u32 vcc, -1, v87
v_add_u32 v87, s52, v87
s_and_saveexec_b64 s[22:23], vcc
ds_write_b64 v87, v[52:53]
s_mov_b64 exec, s[22:23]
v_cvt_pk_bf16_f32 v56, v56, v57
v_cvt_pk_bf16_f32 v57, v58, v59
v_cmp_ne_u32 vcc, -1, v88
v_add_u32 v88, s52, v88
s_and_saveexec_b64 s[22:23], vcc
ds_write_b64 v88, v[56:57]
s_mov_b64 exec, s[22:23]
v_cvt_pk_bf16_f32 v60, v60, v61
v_cvt_pk_bf16_f32 v61, v62, v63
v_cmp_ne_u32 vcc, -1, v89
v_add_u32 v89, s52, v89
s_and_saveexec_b64 s[22:23], vcc
ds_write_b64 v89, v[60:61]
s_mov_b64 exec, s[22:23]
v_cvt_pk_bf16_f32 v64, v64, v65
v_cvt_pk_bf16_f32 v65, v66, v67
v_cmp_ne_u32 vcc, -1, v90
v_add_u32 v90, s52, v90
s_and_saveexec_b64 s[22:23], vcc
ds_write_b64 v90, v[64:65]
s_mov_b64 exec, s[22:23]
v_cvt_pk_bf16_f32 v68, v68, v69
v_cvt_pk_bf16_f32 v69, v70, v71
v_cmp_ne_u32 vcc, -1, v91
v_add_u32 v91, s52, v91
s_and_saveexec_b64 s[22:23], vcc
ds_write_b64 v91, v[68:69]
s_mov_b64 exec, s[22:23]
v_cvt_pk_bf16_f32 v72, v72, v73
v_cvt_pk_bf16_f32 v73, v74, v75
v_cmp_ne_u32 vcc, -1, v92
v_add_u32 v92, s52, v92
s_and_saveexec_b64 s[22:23], vcc
ds_write_b64 v92, v[72:73]
s_mov_b64 exec, s[22:23]
v_cvt_pk_bf16_f32 v76, v76, v77
v_cvt_pk_bf16_f32 v77, v78, v79
v_cmp_ne_u32 vcc, -1, v93
v_add_u32 v93, s52, v93
s_and_saveexec_b64 s[22:23], vcc
ds_write_b64 v93, v[76:77]
s_mov_b64 exec, s[22:23]
s_waitcnt lgkmcnt(0)
s_waitcnt vmcnt(0)
ds_read_b128 v[96:99], v15 offset:18432
ds_read_b128 v[100:103], v15 offset:18688
ds_read_b128 v[104:107], v15 offset:18944
s_waitcnt lgkmcnt(0)
v_mfma_f32_16x16x32_bf16 v[128:131], v[96:99], a[0:3], 0
v_mfma_f32_16x16x32_bf16 v[136:139], v[96:99], a[4:7], 0
v_mfma_f32_16x16x32_bf16 v[144:147], v[96:99], a[8:11], 0
v_mfma_f32_16x16x32_bf16 v[152:155], v[96:99], a[12:15], 0
v_mfma_f32_16x16x32_bf16 v[128:131], v[100:103], a[16:19], v[128:131]
v_mfma_f32_16x16x32_bf16 v[136:139], v[100:103], a[20:23], v[136:139]
v_mfma_f32_16x16x32_bf16 v[144:147], v[100:103], a[24:27], v[144:147]
v_mfma_f32_16x16x32_bf16 v[152:155], v[100:103], a[28:31], v[152:155]
v_mfma_f32_16x16x32_bf16 v[128:131], v[104:107], a[32:35], v[128:131]
v_mfma_f32_16x16x32_bf16 v[136:139], v[104:107], a[36:39], v[136:139]
v_mfma_f32_16x16x32_bf16 v[144:147], v[104:107], a[40:43], v[144:147]
v_mfma_f32_16x16x32_bf16 v[152:155], v[104:107], a[44:47], v[152:155]
ds_read_b128 v[96:99], v15 offset:19200
ds_read_b128 v[100:103], v15 offset:19456
ds_read_b128 v[104:107], v15 offset:19712
s_waitcnt lgkmcnt(0)
v_mfma_f32_16x16x32_bf16 v[132:135], v[96:99], a[32:35], 0
v_mfma_f32_16x16x32_bf16 v[140:143], v[96:99], a[36:39], 0
v_mfma_f32_16x16x32_bf16 v[148:151], v[96:99], a[40:43], 0
v_mfma_f32_16x16x32_bf16 v[156:159], v[96:99], a[44:47], 0
v_mfma_f32_16x16x32_bf16 v[132:135], v[100:103], a[48:51], v[132:135]
v_mfma_f32_16x16x32_bf16 v[140:143], v[100:103], a[52:55], v[140:143]
v_mfma_f32_16x16x32_bf16 v[148:151], v[100:103], a[56:59], v[148:151]
v_mfma_f32_16x16x32_bf16 v[156:159], v[100:103], a[60:63], v[156:159]
v_mfma_f32_16x16x32_bf16 v[132:135], v[104:107], a[64:67], v[132:135]
v_mfma_f32_16x16x32_bf16 v[140:143], v[104:107], a[68:71], v[140:143]
v_mfma_f32_16x16x32_bf16 v[148:151], v[104:107], a[72:75], v[148:151]
v_mfma_f32_16x16x32_bf16 v[156:159], v[104:107], a[76:79], v[156:159]
ds_read_b128 v[96:99], v14 offset:0
ds_read_b128 v[100:103], v14 offset:1024
ds_read_b128 v[104:107], v14 offset:2048
s_waitcnt lgkmcnt(0)
v_mfma_f32_16x16x32_bf16 v[24:27], v[96:99], a[0:3], 0
v_mfma_f32_16x16x32_bf16 v[32:35], v[96:99], a[4:7], 0
v_mfma_f32_16x16x32_bf16 v[40:43], v[96:99], a[8:11], 0
v_mfma_f32_16x16x32_bf16 v[48:51], v[96:99], a[12:15], 0
v_mfma_f32_16x16x32_bf16 v[28:31], v[100:103], a[0:3], 0
v_mfma_f32_16x16x32_bf16 v[36:39], v[100:103], a[4:7], 0
v_mfma_f32_16x16x32_bf16 v[44:47], v[100:103], a[8:11], 0
v_mfma_f32_16x16x32_bf16 v[52:55], v[100:103], a[12:15], 0
v_mfma_f32_16x16x32_bf16 v[28:31], v[104:107], a[16:19], v[28:31]
v_mfma_f32_16x16x32_bf16 v[36:39], v[104:107], a[20:23], v[36:39]
v_mfma_f32_16x16x32_bf16 v[44:47], v[104:107], a[24:27], v[44:47]
v_mfma_f32_16x16x32_bf16 v[52:55], v[104:107], a[28:31], v[52:55]
v_add_f32 v128, 0x358637bd, v128
v_add_f32 v129, 0x358637bd, v129
v_add_f32 v130, 0x358637bd, v130
v_add_f32 v131, 0x358637bd, v131
v_add_f32 v132, 0x358637bd, v132
v_add_f32 v133, 0x358637bd, v133
v_add_f32 v134, 0x358637bd, v134
v_add_f32 v135, 0x358637bd, v135
v_add_f32 v136, 0x358637bd, v136
v_add_f32 v137, 0x358637bd, v137
v_add_f32 v138, 0x358637bd, v138
v_add_f32 v139, 0x358637bd, v139
v_add_f32 v140, 0x358637bd, v140
v_add_f32 v141, 0x358637bd, v141
v_add_f32 v142, 0x358637bd, v142
v_add_f32 v143, 0x358637bd, v143
v_add_f32 v144, 0x358637bd, v144
v_add_f32 v145, 0x358637bd, v145
v_add_f32 v146, 0x358637bd, v146
v_add_f32 v147, 0x358637bd, v147
v_add_f32 v148, 0x358637bd, v148
v_add_f32 v149, 0x358637bd, v149
v_add_f32 v150, 0x358637bd, v150
v_add_f32 v151, 0x358637bd, v151
v_add_f32 v152, 0x358637bd, v152
v_add_f32 v153, 0x358637bd, v153
v_add_f32 v154, 0x358637bd, v154
v_add_f32 v155, 0x358637bd, v155
v_add_f32 v156, 0x358637bd, v156
v_add_f32 v157, 0x358637bd, v157
v_add_f32 v158, 0x358637bd, v158
v_add_f32 v159, 0x358637bd, v159
v_rcp_f32 v128, v128
v_rcp_f32 v129, v129
v_rcp_f32 v130, v130
v_rcp_f32 v131, v131
v_rcp_f32 v132, v132
v_rcp_f32 v133, v133
v_rcp_f32 v134, v134
v_rcp_f32 v135, v135
v_rcp_f32 v136, v136
v_rcp_f32 v137, v137
v_rcp_f32 v138, v138
v_rcp_f32 v139, v139
v_rcp_f32 v140, v140
v_rcp_f32 v141, v141
v_rcp_f32 v142, v142
v_rcp_f32 v143, v143
v_rcp_f32 v144, v144
v_rcp_f32 v145, v145
v_rcp_f32 v146, v146
v_rcp_f32 v147, v147
v_rcp_f32 v148, v148
v_rcp_f32 v149, v149
v_rcp_f32 v150, v150
v_rcp_f32 v151, v151
v_rcp_f32 v152, v152
v_rcp_f32 v153, v153
v_rcp_f32 v154, v154
v_rcp_f32 v155, v155
v_rcp_f32 v156, v156
v_rcp_f32 v157, v157
v_rcp_f32 v158, v158
v_rcp_f32 v159, v159
ds_read_b128 v[96:99], v14 offset:3072
ds_read_b128 v[100:103], v14 offset:4096
ds_read_b128 v[104:107], v14 offset:5120
ds_read_b128 v[108:111], v14 offset:6144
s_waitcnt lgkmcnt(0)
v_mfma_f32_16x16x32_bf16 v[56:59], v[96:99], a[0:3], 0
v_mfma_f32_16x16x32_bf16 v[64:67], v[96:99], a[4:7], 0
v_mfma_f32_16x16x32_bf16 v[72:75], v[96:99], a[8:11], 0
v_mfma_f32_16x16x32_bf16 v[80:83], v[96:99], a[12:15], 0
v_mfma_f32_16x16x32_bf16 v[56:59], v[100:103], a[16:19], v[56:59]
v_mfma_f32_16x16x32_bf16 v[64:67], v[100:103], a[20:23], v[64:67]
v_mfma_f32_16x16x32_bf16 v[72:75], v[100:103], a[24:27], v[72:75]
v_mfma_f32_16x16x32_bf16 v[80:83], v[100:103], a[28:31], v[80:83]
v_mfma_f32_16x16x32_bf16 v[60:63], v[104:107], a[16:19], 0
v_mfma_f32_16x16x32_bf16 v[68:71], v[104:107], a[20:23], 0
v_mfma_f32_16x16x32_bf16 v[76:79], v[104:107], a[24:27], 0
v_mfma_f32_16x16x32_bf16 v[84:87], v[104:107], a[28:31], 0
v_mfma_f32_16x16x32_bf16 v[60:63], v[108:111], a[32:35], v[60:63]
v_mfma_f32_16x16x32_bf16 v[68:71], v[108:111], a[36:39], v[68:71]
v_mfma_f32_16x16x32_bf16 v[76:79], v[108:111], a[40:43], v[76:79]
v_mfma_f32_16x16x32_bf16 v[84:87], v[108:111], a[44:47], v[84:87]
v_mul_f32 v24, v24, v128
v_mul_f32 v25, v25, v128
v_mul_f32 v26, v26, v128
v_mul_f32 v27, v27, v128
v_cvt_pk_bf16_f32 v112, v24, v25
v_cvt_pk_bf16_f32 v113, v26, v27
v_cndmask_b32 v16, v128, v129, s[54:55]
v_mul_f32 v28, v28, v16
v_mul_f32 v29, v29, v16
v_mul_f32 v30, v30, v16
v_mul_f32 v31, v31, v16
v_cvt_pk_bf16_f32 v114, v28, v29
v_cvt_pk_bf16_f32 v115, v30, v31
ds_write_b128 v20, v[112:115] offset:0
v_mul_f32 v32, v32, v136
v_mul_f32 v33, v33, v136
v_mul_f32 v34, v34, v136
v_mul_f32 v35, v35, v136
v_cvt_pk_bf16_f32 v116, v32, v33
v_cvt_pk_bf16_f32 v117, v34, v35
v_cndmask_b32 v16, v136, v137, s[54:55]
v_mul_f32 v36, v36, v16
v_mul_f32 v37, v37, v16
v_mul_f32 v38, v38, v16
v_mul_f32 v39, v39, v16
v_cvt_pk_bf16_f32 v118, v36, v37
v_cvt_pk_bf16_f32 v119, v38, v39
ds_write_b128 v20, v[116:119] offset:1024
v_mul_f32 v40, v40, v144
v_mul_f32 v41, v41, v144
v_mul_f32 v42, v42, v144
v_mul_f32 v43, v43, v144
v_cvt_pk_bf16_f32 v120, v40, v41
v_cvt_pk_bf16_f32 v121, v42, v43
v_cndmask_b32 v16, v144, v145, s[54:55]
v_mul_f32 v44, v44, v16
v_mul_f32 v45, v45, v16
v_mul_f32 v46, v46, v16
v_mul_f32 v47, v47, v16
v_cvt_pk_bf16_f32 v122, v44, v45
v_cvt_pk_bf16_f32 v123, v46, v47
ds_write_b128 v20, v[120:123] offset:2048
v_mul_f32 v48, v48, v152
v_mul_f32 v49, v49, v152
v_mul_f32 v50, v50, v152
v_mul_f32 v51, v51, v152
v_cvt_pk_bf16_f32 v124, v48, v49
v_cvt_pk_bf16_f32 v125, v50, v51
v_cndmask_b32 v16, v152, v153, s[54:55]
v_mul_f32 v52, v52, v16
v_mul_f32 v53, v53, v16
v_mul_f32 v54, v54, v16
v_mul_f32 v55, v55, v16
v_cvt_pk_bf16_f32 v126, v52, v53
v_cvt_pk_bf16_f32 v127, v54, v55
ds_write_b128 v20, v[124:127] offset:3072
ds_read_b128 v[96:99], v14 offset:7168
ds_read_b128 v[100:103], v14 offset:8192
ds_read_b128 v[104:107], v14 offset:9216
ds_read_b128 v[108:111], v14 offset:10240
s_waitcnt lgkmcnt(0)
v_mfma_f32_16x16x32_bf16 v[24:27], v[96:99], a[16:19], 0
v_mfma_f32_16x16x32_bf16 v[32:35], v[96:99], a[20:23], 0
v_mfma_f32_16x16x32_bf16 v[40:43], v[96:99], a[24:27], 0
v_mfma_f32_16x16x32_bf16 v[48:51], v[96:99], a[28:31], 0
v_mfma_f32_16x16x32_bf16 v[24:27], v[100:103], a[32:35], v[24:27]
v_mfma_f32_16x16x32_bf16 v[32:35], v[100:103], a[36:39], v[32:35]
v_mfma_f32_16x16x32_bf16 v[40:43], v[100:103], a[40:43], v[40:43]
v_mfma_f32_16x16x32_bf16 v[48:51], v[100:103], a[44:47], v[48:51]
v_mfma_f32_16x16x32_bf16 v[28:31], v[104:107], a[32:35], 0
v_mfma_f32_16x16x32_bf16 v[36:39], v[104:107], a[36:39], 0
v_mfma_f32_16x16x32_bf16 v[44:47], v[104:107], a[40:43], 0
v_mfma_f32_16x16x32_bf16 v[52:55], v[104:107], a[44:47], 0
v_mfma_f32_16x16x32_bf16 v[28:31], v[108:111], a[48:51], v[28:31]
v_mfma_f32_16x16x32_bf16 v[36:39], v[108:111], a[52:55], v[36:39]
v_mfma_f32_16x16x32_bf16 v[44:47], v[108:111], a[56:59], v[44:47]
v_mfma_f32_16x16x32_bf16 v[52:55], v[108:111], a[60:63], v[52:55]
v_cndmask_b32 v16, v129, v130, s[60:61]
v_mul_f32 v56, v56, v16
v_mul_f32 v57, v57, v16
v_mul_f32 v58, v58, v16
v_mul_f32 v59, v59, v16
v_cvt_pk_bf16_f32 v112, v56, v57
v_cvt_pk_bf16_f32 v113, v58, v59
v_cndmask_b32 v16, v130, v131, s[62:63]
v_mul_f32 v60, v60, v16
v_mul_f32 v61, v61, v16
v_mul_f32 v62, v62, v16
v_mul_f32 v63, v63, v16
v_cvt_pk_bf16_f32 v114, v60, v61
v_cvt_pk_bf16_f32 v115, v62, v63
ds_write_b128 v20, v[112:115] offset:4096
v_cndmask_b32 v16, v137, v138, s[60:61]
v_mul_f32 v64, v64, v16
v_mul_f32 v65, v65, v16
v_mul_f32 v66, v66, v16
v_mul_f32 v67, v67, v16
v_cvt_pk_bf16_f32 v116, v64, v65
v_cvt_pk_bf16_f32 v117, v66, v67
v_cndmask_b32 v16, v138, v139, s[62:63]
v_mul_f32 v68, v68, v16
v_mul_f32 v69, v69, v16
v_mul_f32 v70, v70, v16
v_mul_f32 v71, v71, v16
v_cvt_pk_bf16_f32 v118, v68, v69
v_cvt_pk_bf16_f32 v119, v70, v71
ds_write_b128 v20, v[116:119] offset:5120
v_cndmask_b32 v16, v145, v146, s[60:61]
v_mul_f32 v72, v72, v16
v_mul_f32 v73, v73, v16
v_mul_f32 v74, v74, v16
v_mul_f32 v75, v75, v16
v_cvt_pk_bf16_f32 v120, v72, v73
v_cvt_pk_bf16_f32 v121, v74, v75
v_cndmask_b32 v16, v146, v147, s[62:63]
v_mul_f32 v76, v76, v16
v_mul_f32 v77, v77, v16
v_mul_f32 v78, v78, v16
v_mul_f32 v79, v79, v16
v_cvt_pk_bf16_f32 v122, v76, v77
v_cvt_pk_bf16_f32 v123, v78, v79
ds_write_b128 v20, v[120:123] offset:6144
v_cndmask_b32 v16, v153, v154, s[60:61]
v_mul_f32 v80, v80, v16
v_mul_f32 v81, v81, v16
v_mul_f32 v82, v82, v16
v_mul_f32 v83, v83, v16
v_cvt_pk_bf16_f32 v124, v80, v81
v_cvt_pk_bf16_f32 v125, v82, v83
v_cndmask_b32 v16, v154, v155, s[62:63]
v_mul_f32 v84, v84, v16
v_mul_f32 v85, v85, v16
v_mul_f32 v86, v86, v16
v_mul_f32 v87, v87, v16
v_cvt_pk_bf16_f32 v126, v84, v85
v_cvt_pk_bf16_f32 v127, v86, v87
ds_write_b128 v20, v[124:127] offset:7168
ds_read_b128 v[96:99], v14 offset:11264
ds_read_b128 v[100:103], v14 offset:12288
ds_read_b128 v[104:107], v14 offset:13312
ds_read_b128 v[108:111], v14 offset:14336
s_waitcnt lgkmcnt(0)
v_mfma_f32_16x16x32_bf16 v[56:59], v[96:99], a[32:35], 0
v_mfma_f32_16x16x32_bf16 v[64:67], v[96:99], a[36:39], 0
v_mfma_f32_16x16x32_bf16 v[72:75], v[96:99], a[40:43], 0
v_mfma_f32_16x16x32_bf16 v[80:83], v[96:99], a[44:47], 0
v_mfma_f32_16x16x32_bf16 v[56:59], v[100:103], a[48:51], v[56:59]
v_mfma_f32_16x16x32_bf16 v[64:67], v[100:103], a[52:55], v[64:67]
v_mfma_f32_16x16x32_bf16 v[72:75], v[100:103], a[56:59], v[72:75]
v_mfma_f32_16x16x32_bf16 v[80:83], v[100:103], a[60:63], v[80:83]
v_mfma_f32_16x16x32_bf16 v[60:63], v[104:107], a[48:51], 0
v_mfma_f32_16x16x32_bf16 v[68:71], v[104:107], a[52:55], 0
v_mfma_f32_16x16x32_bf16 v[76:79], v[104:107], a[56:59], 0
v_mfma_f32_16x16x32_bf16 v[84:87], v[104:107], a[60:63], 0
v_mfma_f32_16x16x32_bf16 v[60:63], v[108:111], a[64:67], v[60:63]
v_mfma_f32_16x16x32_bf16 v[68:71], v[108:111], a[68:71], v[68:71]
v_mfma_f32_16x16x32_bf16 v[76:79], v[108:111], a[72:75], v[76:79]
v_mfma_f32_16x16x32_bf16 v[84:87], v[108:111], a[76:79], v[84:87]
v_mul_f32 v24, v24, v131
v_mul_f32 v25, v25, v131
v_mul_f32 v26, v26, v131
v_mul_f32 v27, v27, v131
v_cvt_pk_bf16_f32 v112, v24, v25
v_cvt_pk_bf16_f32 v113, v26, v27
v_mul_f32 v28, v28, v132
v_mul_f32 v29, v29, v132
v_mul_f32 v30, v30, v132
v_mul_f32 v31, v31, v132
v_cvt_pk_bf16_f32 v114, v28, v29
v_cvt_pk_bf16_f32 v115, v30, v31
ds_write_b128 v20, v[112:115] offset:8192
v_mul_f32 v32, v32, v139
v_mul_f32 v33, v33, v139
v_mul_f32 v34, v34, v139
v_mul_f32 v35, v35, v139
v_cvt_pk_bf16_f32 v116, v32, v33
v_cvt_pk_bf16_f32 v117, v34, v35
v_mul_f32 v36, v36, v140
v_mul_f32 v37, v37, v140
v_mul_f32 v38, v38, v140
v_mul_f32 v39, v39, v140
v_cvt_pk_bf16_f32 v118, v36, v37
v_cvt_pk_bf16_f32 v119, v38, v39
ds_write_b128 v20, v[116:119] offset:9216
v_mul_f32 v40, v40, v147
v_mul_f32 v41, v41, v147
v_mul_f32 v42, v42, v147
v_mul_f32 v43, v43, v147
v_cvt_pk_bf16_f32 v120, v40, v41
v_cvt_pk_bf16_f32 v121, v42, v43
v_mul_f32 v44, v44, v148
v_mul_f32 v45, v45, v148
v_mul_f32 v46, v46, v148
v_mul_f32 v47, v47, v148
v_cvt_pk_bf16_f32 v122, v44, v45
v_cvt_pk_bf16_f32 v123, v46, v47
ds_write_b128 v20, v[120:123] offset:10240
v_mul_f32 v48, v48, v155
v_mul_f32 v49, v49, v155
v_mul_f32 v50, v50, v155
v_mul_f32 v51, v51, v155
v_cvt_pk_bf16_f32 v124, v48, v49
v_cvt_pk_bf16_f32 v125, v50, v51
v_mul_f32 v52, v52, v156
v_mul_f32 v53, v53, v156
v_mul_f32 v54, v54, v156
v_mul_f32 v55, v55, v156
v_cvt_pk_bf16_f32 v126, v52, v53
v_cvt_pk_bf16_f32 v127, v54, v55
ds_write_b128 v20, v[124:127] offset:11264
ds_read_b128 v[96:99], v14 offset:15360
ds_read_b128 v[100:103], v14 offset:16384
ds_read_b128 v[104:107], v14 offset:17408
s_waitcnt lgkmcnt(0)
v_mfma_f32_16x16x32_bf16 v[24:27], v[96:99], a[48:51], 0
v_mfma_f32_16x16x32_bf16 v[32:35], v[96:99], a[52:55], 0
v_mfma_f32_16x16x32_bf16 v[40:43], v[96:99], a[56:59], 0
v_mfma_f32_16x16x32_bf16 v[48:51], v[96:99], a[60:63], 0
v_mfma_f32_16x16x32_bf16 v[24:27], v[100:103], a[64:67], v[24:27]
v_mfma_f32_16x16x32_bf16 v[32:35], v[100:103], a[68:71], v[32:35]
v_mfma_f32_16x16x32_bf16 v[40:43], v[100:103], a[72:75], v[40:43]
v_mfma_f32_16x16x32_bf16 v[48:51], v[100:103], a[76:79], v[48:51]
v_mfma_f32_16x16x32_bf16 v[28:31], v[104:107], a[64:67], 0
v_mfma_f32_16x16x32_bf16 v[36:39], v[104:107], a[68:71], 0
v_mfma_f32_16x16x32_bf16 v[44:47], v[104:107], a[72:75], 0
v_mfma_f32_16x16x32_bf16 v[52:55], v[104:107], a[76:79], 0
v_cndmask_b32 v16, v132, v133, s[54:55]
v_mul_f32 v56, v56, v16
v_mul_f32 v57, v57, v16
v_mul_f32 v58, v58, v16
v_mul_f32 v59, v59, v16
v_cvt_pk_bf16_f32 v112, v56, v57
v_cvt_pk_bf16_f32 v113, v58, v59
v_cndmask_b32 v16, v133, v134, s[60:61]
v_mul_f32 v60, v60, v16
v_mul_f32 v61, v61, v16
v_mul_f32 v62, v62, v16
v_mul_f32 v63, v63, v16
v_cvt_pk_bf16_f32 v114, v60, v61
v_cvt_pk_bf16_f32 v115, v62, v63
ds_write_b128 v20, v[112:115] offset:12288
v_cndmask_b32 v16, v140, v141, s[54:55]
v_mul_f32 v64, v64, v16
v_mul_f32 v65, v65, v16
v_mul_f32 v66, v66, v16
v_mul_f32 v67, v67, v16
v_cvt_pk_bf16_f32 v116, v64, v65
v_cvt_pk_bf16_f32 v117, v66, v67
v_cndmask_b32 v16, v141, v142, s[60:61]
v_mul_f32 v68, v68, v16
v_mul_f32 v69, v69, v16
v_mul_f32 v70, v70, v16
v_mul_f32 v71, v71, v16
v_cvt_pk_bf16_f32 v118, v68, v69
v_cvt_pk_bf16_f32 v119, v70, v71
ds_write_b128 v20, v[116:119] offset:13312
v_cndmask_b32 v16, v148, v149, s[54:55]
v_mul_f32 v72, v72, v16
v_mul_f32 v73, v73, v16
v_mul_f32 v74, v74, v16
v_mul_f32 v75, v75, v16
v_cvt_pk_bf16_f32 v120, v72, v73
v_cvt_pk_bf16_f32 v121, v74, v75
v_cndmask_b32 v16, v149, v150, s[60:61]
v_mul_f32 v76, v76, v16
v_mul_f32 v77, v77, v16
v_mul_f32 v78, v78, v16
v_mul_f32 v79, v79, v16
v_cvt_pk_bf16_f32 v122, v76, v77
v_cvt_pk_bf16_f32 v123, v78, v79
ds_write_b128 v20, v[120:123] offset:14336
v_cndmask_b32 v16, v156, v157, s[54:55]
v_mul_f32 v80, v80, v16
v_mul_f32 v81, v81, v16
v_mul_f32 v82, v82, v16
v_mul_f32 v83, v83, v16
v_cvt_pk_bf16_f32 v124, v80, v81
v_cvt_pk_bf16_f32 v125, v82, v83
v_cndmask_b32 v16, v157, v158, s[60:61]
v_mul_f32 v84, v84, v16
v_mul_f32 v85, v85, v16
v_mul_f32 v86, v86, v16
v_mul_f32 v87, v87, v16
v_cvt_pk_bf16_f32 v126, v84, v85
v_cvt_pk_bf16_f32 v127, v86, v87
ds_write_b128 v20, v[124:127] offset:15360
s_nop 7
v_cndmask_b32 v16, v134, v135, s[62:63]
v_mul_f32 v24, v24, v16
v_mul_f32 v25, v25, v16
v_mul_f32 v26, v26, v16
v_mul_f32 v27, v27, v16
v_cvt_pk_bf16_f32 v112, v24, v25
v_cvt_pk_bf16_f32 v113, v26, v27
v_mul_f32 v28, v28, v135
v_mul_f32 v29, v29, v135
v_mul_f32 v30, v30, v135
v_mul_f32 v31, v31, v135
v_cvt_pk_bf16_f32 v114, v28, v29
v_cvt_pk_bf16_f32 v115, v30, v31
ds_write_b128 v20, v[112:115] offset:16384
v_cndmask_b32 v16, v142, v143, s[62:63]
v_mul_f32 v32, v32, v16
v_mul_f32 v33, v33, v16
v_mul_f32 v34, v34, v16
v_mul_f32 v35, v35, v16
v_cvt_pk_bf16_f32 v116, v32, v33
v_cvt_pk_bf16_f32 v117, v34, v35
v_mul_f32 v36, v36, v143
v_mul_f32 v37, v37, v143
v_mul_f32 v38, v38, v143
v_mul_f32 v39, v39, v143
v_cvt_pk_bf16_f32 v118, v36, v37
v_cvt_pk_bf16_f32 v119, v38, v39
ds_write_b128 v20, v[116:119] offset:17408
v_cndmask_b32 v16, v150, v151, s[62:63]
v_mul_f32 v40, v40, v16
v_mul_f32 v41, v41, v16
v_mul_f32 v42, v42, v16
v_mul_f32 v43, v43, v16
v_cvt_pk_bf16_f32 v120, v40, v41
v_cvt_pk_bf16_f32 v121, v42, v43
v_mul_f32 v44, v44, v151
v_mul_f32 v45, v45, v151
v_mul_f32 v46, v46, v151
v_mul_f32 v47, v47, v151
v_cvt_pk_bf16_f32 v122, v44, v45
v_cvt_pk_bf16_f32 v123, v46, v47
ds_write_b128 v20, v[120:123] offset:18432
v_cndmask_b32 v16, v158, v159, s[62:63]
v_mul_f32 v48, v48, v16
v_mul_f32 v49, v49, v16
v_mul_f32 v50, v50, v16
v_mul_f32 v51, v51, v16
v_cvt_pk_bf16_f32 v124, v48, v49
v_cvt_pk_bf16_f32 v125, v50, v51
v_mul_f32 v52, v52, v159
v_mul_f32 v53, v53, v159
v_mul_f32 v54, v54, v159
v_mul_f32 v55, v55, v159
v_cvt_pk_bf16_f32 v126, v52, v53
v_cvt_pk_bf16_f32 v127, v54, v55
ds_write_b128 v20, v[124:127] offset:19456
s_waitcnt lgkmcnt(0)
s_barrier
s_barrier
s_barrier
k2_kernel_end:
s_endpgm
.p2align 2
k2_kernel_tab:
.long 0x0,0x8,0x100,0x108,0x200,0x10,0x18,0x110
.long 0x118,0x210,0x20,0x28,0x120,0x128,0x220,0x30
.long 0x38,0x130,0x138,0x230,0x40,0x48,0x140,0x148
.long 0x240,0x50,0x58,0x150,0x158,0x250,0x60,0x68
.long 0x160,0x168,0x260,0x70,0x78,0x170,0x178,0x270
.long 0x80,0x88,0x180,0x188,0x280,0x90,0x98,0x190
.long 0x198,0x290,0xa0,0xa8,0x1a0,0x1a8,0x2a0,0xb0
.long 0xb8,0x1b0,0x1b8,0x2b0,0xc0,0xc8,0x1c0,0x1c8
.long 0x2c0,0xd0,0xd8,0x1d0,0x1d8,0x2d0,0xe0,0xe8
.long 0x1e0,0x1e8,0x2e0,0xf0,0xf8,0x1f0,0x1f8,0x2f0
.long 0x400,0x408,0x500,0x508,0x600,0x410,0x418,0x510
.long 0x518,0x610,0x420,0x428,0x520,0x528,0x620,0x430
.long 0x438,0x530,0x538,0x630,0x4800,0x4808,0x4810,0x4818
.long 0x4820,0xffffffff,0xffffffff,0xffffffff,0xffffffff,0xffffffff,0xffffffff,0xffffffff
.long 0x648,0x740,0x748,0x840,0x848,0x658,0x750,0x758
.long 0x850,0x858,0x668,0x760,0x768,0x860,0x868,0x678
.long 0x770,0x778,0x870,0x878,0x688,0x780,0x788,0x880
.long 0x888,0x698,0x790,0x798,0x890,0x898,0x6a8,0x7a0
.long 0x7a8,0x8a0,0x8a8,0x6b8,0x7b0,0x7b8,0x8b0,0x8b8
.long 0x6c8,0x7c0,0x7c8,0x8c0,0x8c8,0x6d8,0x7d0,0x7d8
.long 0x8d0,0x8d8,0x6e8,0x7e0,0x7e8,0x8e0,0x8e8,0x6f8
.long 0x7f0,0x7f8,0x8f0,0x8f8,0xe08,0xf00,0xf08,0x1000
.long 0x1008,0xe18,0xf10,0xf18,0x1010,0x1018,0xe28,0xf20
.long 0xf28,0x1020,0x1028,0xe38,0xf30,0xf38,0x1030,0x1038
.long 0xe48,0xf40,0xf48,0x1040,0x1048,0xe58,0xf50,0xf58
.long 0x1050,0x1058,0xe68,0xf60,0xf68,0x1060,0x1068,0xe78
.long 0xf70,0xf78,0x1070,0x1078,0x4868,0x4870,0x4878,0x4940
.long 0x4948,0xffffffff,0xffffffff,0xffffffff,0xffffffff,0xffffffff,0xffffffff,0xffffffff
.long 0x1180,0x1188,0x1280,0x1288,0x1380,0x1190,0x1198,0x1290
.long 0x1298,0x1390,0x11a0,0x11a8,0x12a0,0x12a8,0x13a0,0x11b0
.long 0x11b8,0x12b0,0x12b8,0x13b0,0x11c0,0x11c8,0x12c0,0x12c8
.long 0x13c0,0x11d0,0x11d8,0x12d0,0x12d8,0x13d0,0x11e0,0x11e8
.long 0x12e0,0x12e8,0x13e0,0x11f0,0x11f8,0x12f0,0x12f8,0x13f0
.long 0x1500,0x1508,0x1600,0x1608,0x1700,0x1510,0x1518,0x1610
.long 0x1618,0x1710,0x1520,0x1528,0x1620,0x1628,0x1720,0x1530
.long 0x1538,0x1630,0x1638,0x1730,0x1540,0x1548,0x1640,0x1648
.long 0x1740,0x1550,0x1558,0x1650,0x1658,0x1750,0x1560,0x1568
.long 0x1660,0x1668,0x1760,0x1570,0x1578,0x1670,0x1678,0x1770
.long 0x1580,0x1588,0x1680,0x1688,0x1780,0x1590,0x1598,0x1690
.long 0x1698,0x1790,0x15a0,0x15a8,0x16a0,0x16a8,0x17a0,0x15b0
.long 0x15b8,0x16b0,0x16b8,0x17b0,0x4990,0x4998,0x49a0,0x49a8
.long 0x49b0,0xffffffff,0xffffffff,0xffffffff,0xffffffff,0xffffffff,0xffffffff,0xffffffff
.long 0x17c8,0x18c0,0x18c8,0x19c0,0x19c8,0x17d8,0x18d0,0x18d8
.long 0x19d0,0x19d8,0x17e8,0x18e0,0x18e8,0x19e0,0x19e8,0x17f8
.long 0x18f0,0x18f8,0x19f0,0x19f8,0x1f08,0x2000,0x2008,0x2100
.long 0x2108,0x1f18,0x2010,0x2018,0x2110,0x2118,0x1f28,0x2020
.long 0x2028,0x2120,0x2128,0x1f38,0x2030,0x2038,0x2130,0x2138
.long 0x1f48,0x2040,0x2048,0x2140,0x2148,0x1f58,0x2050,0x2058
.long 0x2150,0x2158,0x1f68,0x2060,0x2068,0x2160,0x2168,0x1f78
.long 0x2070,0x2078,0x2170,0x2178,0x1f88,0x2080,0x2088,0x2180
.long 0x2188,0x1f98,0x2090,0x2098,0x2190,0x2198,0x1fa8,0x20a0
.long 0x20a8,0x21a0,0x21a8,0x1fb8,0x20b0,0x20b8,0x21b0,0x21b8
.long 0x1fc8,0x20c0,0x20c8,0x21c0,0x21c8,0x1fd8,0x20d0,0x20d8
.long 0x21d0,0x21d8,0x1fe8,0x20e0,0x20e8,0x21e0,0x21e8,0x1ff8
.long 0x20f0,0x20f8,0x21f0,0x21f8,0x49f8,0x4ac0,0x4ac8,0x4ad0
.long 0x4ad8,0xffffffff,0xffffffff,0xffffffff,0xffffffff,0xffffffff,0xffffffff,0xffffffff
.long 0x2600,0x2608,0x2700,0x2708,0x2800,0x2610,0x2618,0x2710
.long 0x2718,0x2810,0x2620,0x2628,0x2720,0x2728,0x2820,0x2630
.long 0x2638,0x2730,0x2738,0x2830,0x2640,0x2648,0x2740,0x2748
.long 0x2840,0x2650,0x2658,0x2750,0x2758,0x2850,0x2660,0x2668
.long 0x2760,0x2768,0x2860,0x2670,0x2678,0x2770,0x2778,0x2870
.long 0x2680,0x2688,0x2780,0x2788,0x2880,0x2690,0x2698,0x2790
.long 0x2798,0x2890,0x26a0,0x26a8,0x27a0,0x27a8,0x28a0,0x26b0
.long 0x26b8,0x27b0,0x27b8,0x28b0,0x26c0,0x26c8,0x27c0,0x27c8
.long 0x28c0,0x26d0,0x26d8,0x27d0,0x27d8,0x28d0,0x26e0,0x26e8
.long 0x27e0,0x27e8,0x28e0,0x26f0,0x26f8,0x27f0,0x27f8,0x28f0
.long 0x2e00,0x2e08,0x2f00,0x2f08,0x3000,0x2e10,0x2e18,0x2f10
.long 0x2f18,0x3010,0x2e20,0x2e28,0x2f20,0x2f28,0x3020,0x2e30
.long 0x2e38,0x2f30,0x2f38,0x3030,0x4b20,0x4b28,0x4b30,0x4b38
.long 0x4c00,0xffffffff,0xffffffff,0xffffffff,0xffffffff,0xffffffff,0xffffffff,0xffffffff
.long 0x3048,0x3140,0x3148,0x3240,0x3248,0x3058,0x3150,0x3158
.long 0x3250,0x3258,0x3068,0x3160,0x3168,0x3260,0x3268,0x3078
.long 0x3170,0x3178,0x3270,0x3278,0x3088,0x3180,0x3188,0x3280
.long 0x3288,0x3098,0x3190,0x3198,0x3290,0x3298,0x30a8,0x31a0
.long 0x31a8,0x32a0,0x32a8,0x30b8,0x31b0,0x31b8,0x32b0,0x32b8
.long 0x30c8,0x31c0,0x31c8,0x32c0,0x32c8,0x30d8,0x31d0,0x31d8
.long 0x32d0,0x32d8,0x30e8,0x31e0,0x31e8,0x32e0,0x32e8,0x30f8
.long 0x31f0,0x31f8,0x32f0,0x32f8,0x3408,0x3500,0x3508,0x3600
.long 0x3608,0x3418,0x3510,0x3518,0x3610,0x3618,0x3428,0x3520
.long 0x3528,0x3620,0x3628,0x3438,0x3530,0x3538,0x3630,0x3638
.long 0x3448,0x3540,0x3548,0x3640,0x3648,0x3458,0x3550,0x3558
.long 0x3650,0x3658,0x3468,0x3560,0x3568,0x3660,0x3668,0x3478
.long 0x3570,0x3578,0x3670,0x3678,0x4c48,0x4c50,0x4c58,0x4c60
.long 0x4c68,0xffffffff,0xffffffff,0xffffffff,0xffffffff,0xffffffff,0xffffffff,0xffffffff
.long 0x3780,0x3788,0x3880,0x3888,0x3980,0x3790,0x3798,0x3890
.long 0x3898,0x3990,0x37a0,0x37a8,0x38a0,0x38a8,0x39a0,0x37b0
.long 0x37b8,0x38b0,0x38b8,0x39b0,0x37c0,0x37c8,0x38c0,0x38c8
.long 0x39c0,0x37d0,0x37d8,0x38d0,0x38d8,0x39d0,0x37e0,0x37e8
.long 0x38e0,0x38e8,0x39e0,0x37f0,0x37f8,0x38f0,0x38f8,0x39f0
.long 0x3f00,0x3f08,0x4000,0x4008,0x4100,0x3f10,0x3f18,0x4010
.long 0x4018,0x4110,0x3f20,0x3f28,0x4020,0x4028,0x4120,0x3f30
.long 0x3f38,0x4030,0x4038,0x4130,0x3f40,0x3f48,0x4040,0x4048
.long 0x4140,0x3f50,0x3f58,0x4050,0x4058,0x4150,0x3f60,0x3f68
.long 0x4060,0x4068,0x4160,0x3f70,0x3f78,0x4070,0x4078,0x4170
.long 0x3f80,0x3f88,0x4080,0x4088,0x4180,0x3f90,0x3f98,0x4090
.long 0x4098,0x4190,0x3fa0,0x3fa8,0x40a0,0x40a8,0x41a0,0x3fb0
.long 0x3fb8,0x40b0,0x40b8,0x41b0,0x4cb0,0x4cb8,0x4d80,0x4d88
.long 0x4d90,0xffffffff,0xffffffff,0xffffffff,0xffffffff,0xffffffff,0xffffffff,0xffffffff
.long 0x41c8,0x42c0,0x42c8,0x43c0,0x43c8,0x41d8,0x42d0,0x42d8
.long 0x43d0,0x43d8,0x41e8,0x42e0,0x42e8,0x43e0,0x43e8,0x41f8
.long 0x42f0,0x42f8,0x43f0,0x43f8,0x4508,0x4600,0x4608,0x4700
.long 0x4708,0x4518,0x4610,0x4618,0x4710,0x4718,0x4528,0x4620
.long 0x4628,0x4720,0x4728,0x4538,0x4630,0x4638,0x4730,0x4738
.long 0x4548,0x4640,0x4648,0x4740,0x4748,0x4558,0x4650,0x4658
.long 0x4750,0x4758,0x4568,0x4660,0x4668,0x4760,0x4768,0x4578
.long 0x4670,0x4678,0x4770,0x4778,0x4588,0x4680,0x4688,0x4780
.long 0x4788,0x4598,0x4690,0x4698,0x4790,0x4798,0x45a8,0x46a0
.long 0x46a8,0x47a0,0x47a8,0x45b8,0x46b0,0x46b8,0x47b0,0x47b8
.long 0x45c8,0x46c0,0x46c8,0x47c0,0x47c8,0x45d8,0x46d0,0x46d8
.long 0x47d0,0x47d8,0x45e8,0x46e0,0x46e8,0x47e0,0x47e8,0x45f8
.long 0x46f0,0x46f8,0x47f0,0x47f8,0x4dd8,0x4de0,0x4de8,0x4df0
.long 0x4df8,0xffffffff,0xffffffff,0xffffffff,0xffffffff,0xffffffff,0xffffffff,0xffffffff
k2_kernel_tabend:
code_end_all:
.set CODE_BYTES_ALL, code_end_all - k0_kernel - 256
.set CODE_BYTES_ALL2, code_end_all - k1_kernel
.fill 64, 4, 0xBF800000
.section .rodata,"a"
.p2align 6
.amdhsa_kernel k0_kernel
  .amdhsa_next_free_vgpr 96
  .amdhsa_next_free_sgpr 96
  .amdhsa_accum_offset 96
  .amdhsa_group_segment_fixed_size 0
  .amdhsa_kernarg_size 80
  .amdhsa_user_sgpr_count 2
  .amdhsa_user_sgpr_kernarg_segment_ptr 1
  .amdhsa_system_sgpr_workgroup_id_x 1
.end_amdhsa_kernel
.p2align 6
.amdhsa_kernel k1_kernel
  .amdhsa_next_free_vgpr 256
  .amdhsa_next_free_sgpr 102
  .amdhsa_accum_offset 96
  .amdhsa_group_segment_fixed_size 0
  .amdhsa_kernarg_size 80
  .amdhsa_user_sgpr_count 2
  .amdhsa_user_sgpr_kernarg_segment_ptr 1
  .amdhsa_system_sgpr_workgroup_id_x 1
.end_amdhsa_kernel
.p2align 6
.amdhsa_kernel k2_kernel
  .amdhsa_next_free_vgpr 256
  .amdhsa_next_free_sgpr 102
  .amdhsa_accum_offset 176
  .amdhsa_group_segment_fixed_size 0
  .amdhsa_kernarg_size 80
  .amdhsa_user_sgpr_count 2
  .amdhsa_user_sgpr_kernarg_segment_ptr 1
  .amdhsa_system_sgpr_workgroup_id_x 1
.end_amdhsa_kernel
```
